```python
import torch

def _softmax(x, axis=-1):
    return torch.softmax(x, dim=axis)

def _gelu(x):
    return torch.nn.functional.gelu(x, approximate='tanh')

def _silu(x):
    return torch.nn.functional.silu(x)

def _sigmoid(x):
    return torch.sigmoid(x)

def _layernorm(x, axis=-1, eps=1e-05):
    m = x.mean(dim=axis, keepdim=True)
    v = x.var(dim=axis, keepdim=True, unbiased=False)
    return (x - m) / torch.sqrt(v + eps)

def _scatter_add(tgt, idx, src, axis=0):
    return tgt.clone().index_add_(axis, idx, src)

def _segment_sum(src, seg, n):
    out = torch.zeros((n,) + src.shape[1:], dtype=src.dtype)
    return out.index_add_(0, seg, src)

def _pad(x, pw):
    flat = tuple((v for pair in reversed(pw) for v in pair))
    return torch.nn.functional.pad(x, flat)
kernel_name = 'adaLN_cond__sliding_local_dilated__mixer_channel_mlp__prompt'

def setup_inputs():

    _w = lambda a: (lambda t: t.to(torch.bfloat16) if t.is_floating_point() else t)(torch.as_tensor(a))

    def _A_setup():
        B, S, D = (1, 2048, 512)
        return {'x': _w((lambda *s: torch.randn(*s, dtype=torch.bfloat16) * 0.05)(B, S, D)), 'wqkv': _w((lambda *s: torch.randn(*s, dtype=torch.bfloat16) * 0.05)(D, 3 * D)), 'wo': _w((lambda *s: torch.randn(*s, dtype=torch.bfloat16) * 0.05)(D, D))}
    _A_in = _A_setup()

    def _B_setup():
        B, S, D, F = (1, 2048, 512, 1792)
        return {'x': _w((lambda *s: torch.randn(*s, dtype=torch.bfloat16) * 0.05)(B, S, D)), 'w1': _w((lambda *s: torch.randn(*s, dtype=torch.bfloat16) * 3.2)(D, F) * D ** (-0.5)), 'b1': _w((lambda *s: torch.randn(*s, dtype=torch.bfloat16) * 1.6)(F)), 'w2': _w((lambda *s: torch.randn(*s, dtype=torch.bfloat16) * 3.2)(F, D) * F ** (-0.5)), 'b2': _w((lambda *s: torch.randn(*s, dtype=torch.bfloat16) * 3.2)(D))}
    _B_in = _B_setup()
    return {'A_x': _A_in['x'], 'A_wqkv': _A_in['wqkv'], 'A_wo': _A_in['wo'], 'B_x': _B_in['x'], 'B_w1': _B_in['w1'], 'B_b1': _B_in['b1'], 'B_w2': _B_in['w2'], 'B_b2': _B_in['b2'], 'c': _w((lambda *s: torch.randn(*s, dtype=torch.bfloat16) * 0.2)(1, 512) * 8.0), 'w_mod': _w((lambda *s: torch.randn(*s, dtype=torch.bfloat16) * 0.2)(512, 6 * 512) * 512 ** (-0.5) * 8.0)}

def reference(A_x, A_wqkv, A_wo, B_x, B_w1, B_b1, B_w2, B_b2, c, w_mod):

    def _A_ref(x, wqkv, wo):
        B, S, D = x.shape
        H = 32
        Dh = D // H
        W, dil = (8, 2)
        qkv = (lambda x, *d: x.permute(*d))((x @ wqkv).reshape(B, S, 3, H, Dh), 2, 0, 3, 1, 4)
        q, k, v = (qkv[0], qkv[1], qkv[2])
        scale = Dh ** (-0.5)
        pos = torch.arange(S)
        off = torch.arange(W) * dil
        idx = pos[:, None] - off[None, :]
        mask = idx >= 0
        idx_c = torch.where(mask, idx, 0).reshape(-1)
        kg = k[:, :, idx_c, :].reshape(B, H, S, W, Dh)
        vg = v[:, :, idx_c, :].reshape(B, H, S, W, Dh)
        logits = torch.einsum('bhsd,bhswd->bhsw', q, kg) * scale
        logits = torch.where(mask[None, None, :, :], logits, -1000000000.0)
        attn = _softmax(logits, axis=-1)
        o = torch.einsum('bhsw,bhswd->bhsd', attn, vg)
        return (lambda x, *d: x.permute(*d))(o, 0, 2, 1, 3).reshape(B, S, D) @ wo

    def _B_ref(x, w1, b1, w2, b2):
        y = _layernorm(x, axis=-1)
        h = _gelu(torch.einsum('bsd,df->bsf', y, w1) + b1)
        return torch.einsum('bsf,fd->bsd', h, w2) + b2
    x = A_x
    mod = (_silu(c) @ w_mod).reshape(c.shape[0], 6, 1, -1)
    sa, ca, ga, sb, cb, gb = (mod[:, 0].clone(), mod[:, 1].clone(), mod[:, 2].clone(), mod[:, 3].clone(), mod[:, 4].clone(), mod[:, 5].clone())
    h = _layernorm(x, axis=-1) * (1 + ca) + sa
    x = x + ga * _A_ref(h, A_wqkv, A_wo)
    h = _layernorm(x, axis=-1) * (1 + cb) + sb
    x = x + gb * _B_ref(h, B_w1, B_b1, B_w2, B_b2)
    return x
```

```asm
; @launch grid=(256,1,1) block=(256,1,1) lds=163840
.amdgcn_target "amdgcn-amd-amdhsa--gfx950"
.text
.globl adaLN_cond__sliding_local_dilated__mixer_channel_mlp__prompt_kernel
.p2align 8
.type adaLN_cond__sliding_local_dilated__mixer_channel_mlp__prompt_kernel,@function
adaLN_cond__sliding_local_dilated__mixer_channel_mlp__prompt_kernel:
	s_cmp_ge_u32 s2, 256
	s_cbranch_scc1 END
	s_load_dwordx2 s[44:45], s[0:1], 96
	s_load_dwordx2 s[32:33], s[0:1], 64
	s_load_dwordx2 s[36:37], s[0:1], 72
	s_load_dwordx2 s[4:5], s[0:1], 0
	s_load_dwordx2 s[8:9], s[0:1], 8
	s_load_dwordx2 s[12:13], s[0:1], 16
	s_load_dwordx2 s[16:17], s[0:1], 32
	s_load_dwordx2 s[20:21], s[0:1], 40
	s_load_dwordx2 s[24:25], s[0:1], 48
	s_load_dwordx2 s[28:29], s[0:1], 56
	s_load_dwordx2 s[40:41], s[0:1], 80
	s_and_b32 s48, s2, 7
	s_lshr_b32 s49, s2, 3
	s_getpc_b64 s[54:55]
PCB:
	v_lshl_add_u32 v13, s49, 8, v0
	v_lshrrev_b32 v13, 4, v13
	v_lshlrev_b32 v13, 7, v13
	v_min_u32 v13, SLOW-PCB, v13
	global_load_dword v15, v13, s[54:55]
	v_lshrrev_b32 v1, 6, v0
	v_and_b32 v0, 63, v0
	s_getreg_b32 s69, hwreg(HW_REG_XCC_ID)
	v_readfirstlane_b32 s52, v1
	s_and_b32 s69, s69, 15
	s_lshr_b32 s54, s49, 3
	s_lshl_b32 s50, s48, 2
	s_add_u32 s50, s50, s54
	s_and_b32 s51, s49, 7
	s_lshl_b32 s59, s50, 6
	s_mov_b32 s67, 0xffff0000
	s_mov_b32 s2, 0
	s_mov_b32 s3, -1
	s_mov_b32 s46, 16777216
	s_mov_b32 s47, 0x00020000
	s_mov_b32 s34, 1024
	s_mov_b32 s35, 0x00020000
	s_mov_b32 s38, 3145728
	s_mov_b32 s39, 0x00020000
	v_lshlrev_b32 v5, 4, v0
	v_mov_b32 v10, 0
	s_lshr_b32 s54, s51, 1
	s_lshl_b32 s54, s54, 2
	s_lshr_b32 s54, 0x2130, s54
	s_and_b32 s54, s54, 3
	s_cmp_eq_u32 s54, 3
	s_cselect_b32 s56, 0x80000000, 0
	s_lshl_b32 s54, s54, 5
	s_and_b32 s55, s49, 24
	s_add_u32 s54, s54, s55
	s_add_u32 s54, s54, s48
	s_mul_i32 s55, s54, 43
	s_lshr_b32 s55, s55, 9
	s_mul_i32 s57, s55, 12
	s_sub_u32 s54, s54, s57
	s_lshl_b32 s55, s55, 2
	s_lshr_b32 s55, 0x1546723, s55
	s_and_b32 s55, s55, 7
	s_and_b32 s58, s54, 1
	s_lshr_b32 s54, s54, 1
	s_lshl_b32 s54, s54, 3
	s_add_u32 s54, s54, s55
	s_lshl_b32 s54, s54, 1
	s_and_b32 s55, s49, 1
	s_add_u32 s57, s54, s55
	s_mov_b32 s54, s58
	s_lshl_b32 s54, s54, 2
	s_add_u32 s54, s54, s52
	s_lshl_b32 s55, s54, 4
	v_lshrrev_b32 v241, 2, v0
	v_add_u32 v241, s55, v241
	v_lshlrev_b32 v242, 3, v241
	v_mul_u32_u24 v241, 24576, v241
	v_and_b32 v243, 3, v0
	v_lshl_add_u32 v241, v243, 4, v241
	s_lshl_b32 s54, s57, 6
	s_add_u32 s54, s54, s56
	v_add_u32 v241, s54, v241
	s_waitcnt lgkmcnt(0)
	buffer_load_dword v10, v10, s[44:47], 0 offen sc1
	buffer_load_dwordx2 v[216:217], v242, s[32:35], 0 offen
	buffer_load_dwordx4 v[200:203], v241, s[36:39], 0 offen
	s_mov_b32 s54, 6144
	buffer_load_dwordx4 v[204:207], v241, s[36:39], s54 offen
	s_mov_b32 s54, 12288
	buffer_load_dwordx4 v[208:211], v241, s[36:39], s54 offen
	s_mov_b32 s54, 18432
	buffer_load_dwordx4 v[212:215], v241, s[36:39], s54 offen
	s_mov_b32 s6, 2097152
	s_mov_b32 s7, 0x00020000
	s_mov_b32 s10, 1572864
	s_mov_b32 s11, 0x00020000
	s_mov_b32 s14, 524288
	s_mov_b32 s15, 0x00020000
	s_mov_b32 s18, 1835008
	s_mov_b32 s19, 0x00020000
	s_mov_b32 s22, 3584
	s_mov_b32 s23, 0x00020000
	s_mov_b32 s26, 1835008
	s_mov_b32 s27, 0x00020000
	s_mov_b32 s30, 1024
	s_mov_b32 s31, 0x00020000
	s_mov_b32 s42, 2097152
	s_mov_b32 s43, 0x00020000
	s_lshl_b32 s54, s49, 2
	s_add_u32 s54, s54, s52
	s_lshl_b32 s55, s54, 13
	v_lshl_add_u32 v14, v0, 7, s55
	s_mul_i32 s54, s54, 2176
	s_lshl_b32 s55, s48, 18
	s_add_u32 s54, s54, s55
	s_sub_u32 s54, s54, 16384
	v_min_u32 v13, 16, v0
	v_lshl_add_u32 v13, v13, 7, s54
	s_lshl_b32 s54, s48, 5
	s_add_u32 s54, s54, s49
	s_lshl_b32 s54, s54, 2
	s_add_u32 s54, s54, s52
	s_mul_i32 s55, s54, 1792
	v_min_u32 v253, 13, v0
	v_lshl_add_u32 v253, v253, 7, s55
	s_mul_i32 s55, s54, 1536
	v_min_u32 v255, 11, v0
	v_lshl_add_u32 v255, v255, 7, s55
	s_lshl_b32 s55, s54, 9
	v_and_b32 v254, 3, v0
	v_lshl_add_u32 v254, v254, 7, s55
	v_accvgpr_write_b32 a232, v253
	v_accvgpr_write_b32 a233, v254
	buffer_load_dword v15, v13, s[4:7], 0 offen
	buffer_load_dword v15, v255, s[8:11], 0 offen
	s_and_b32 s64, s50, 1
	s_lshl_b32 s54, s52, 2
	v_lshrrev_b32 v11, 4, v0
	v_add_u32 v11, s54, v11
	v_and_b32 v12, 15, v0
	v_and_b32 v16, 7, v11
	v_lshlrev_b32 v16, 1, v16
	v_lshrrev_b32 v13, 3, v11
	s_sub_u32 s54, s59, 16
	v_add3_u32 v16, v16, v13, s54
	s_lshl_b32 s54, s64, 9
	v_lshl_add_u32 v13, v12, 4, s54
	v_lshl_add_u32 v16, v16, 10, v13
	v_xor_b32 v18, 512, v16
	v_lshl_add_u32 v17, v11, 1, s59
	v_lshl_add_u32 v17, v17, 10, v13
	v_xor_b32 v19, 512, v17
	s_mov_b32 s65, 32768
	s_lshl_b32 s54, s57, 7
	buffer_load_dwordx4 v[96:99], v16, s[4:7], 0 offen offset:0
	s_add_u32 s54, s54, 262144
	s_add_u32 s54, s54, s56
	s_mul_i32 s55, s58, 12288
	s_add_u32 s54, s54, s55
	s_lshl_b32 s55, s52, 6
	v_add_u32 v243, s55, v0
	v_cmp_gt_u32 vcc, 8, v243
	v_lshl_add_u32 v242, v0, 4, s54
	v_bfrev_b32 v243, 1
	v_cndmask_b32 v244, v243, v242, vcc
	v_lshrrev_b32 v242, 4, v0
	v_and_b32 v243, 1, v242
	v_lshrrev_b32 v242, 1, v242
	v_lshl_add_u32 v242, v243, 1, v242
	v_and_b32 v243, 3, v0
	v_lshl_add_u32 v242, v243, 3, v242
	s_lshl_b32 s55, s52, 7
	s_add_u32 s55, s55, 161792
	v_lshl_add_u32 v245, v242, 2, s55
	v_and_b32 v242, 7, v0
	v_lshlrev_b32 v246, 4, v242
	v_add_u32 v246, 161792, v246
	v_lshrrev_b32 v20, 2, v0
	v_and_b32 v20, 4, v20
	buffer_load_dwordx4 v[100:103], v17, s[4:7], 0 offen offset:0
	v_and_b32 v192, 7, v0
	v_xor_b32 v192, v192, v20
	v_lshlrev_b32 v192, 4, v192
	v_lshrrev_b32 v20, 3, v0
	v_mul_u32_u24 v20, 3072, v20
	v_add_u32 v192, v192, v20
	s_lshl_b32 s66, s51, 7
	s_mul_i32 s55, s52, 98304
	s_add_u32 s54, s66, s55
	v_add_u32 v192, s54, v192
	s_mul_i32 s68, s52, 12416
	v_lshrrev_b32 v13, 2, v12
	v_and_b32 v20, 3, v12
	v_and_b32 v21, 7, v12
	v_xor_b32 v21, v21, v11
	v_lshlrev_b32 v21, 4, v21
	v_lshl_add_u32 v21, v20, 8, v21
	v_mul_u32_u24 v13, 5120, v13
	v_add_u32 v6, v13, v21
	v_add_u32 v6, 116480, v6
	v_lshrrev_b32 v13, 4, v0
	v_xor_b32 v20, v12, v13
	v_lshlrev_b32 v20, 4, v20
	v_lshl_add_u32 v7, v13, 8, v20
	v_add_u32 v7, 116480, v7
	buffer_load_dwordx4 v[104:107], v17, s[4:7], s65 offen offset:0
	v_xor_b32 v8, 64, v7
	s_lshl_b32 s54, s64, 10
	s_add_u32 s54, s54, 157696
	v_lshl_add_u32 v9, v12, 5, s54
	s_mul_i32 s64, s64, 786432
	v_mul_u32_u24 v22, 3104, v13
	v_bfe_u32 v20, v0, 1, 1
	v_lshl_add_u32 v20, s52, 1, v20
	v_lshrrev_b32 v21, 1, v0
	v_and_b32 v21, 4, v21
	v_xor_b32 v20, v20, v21
	v_lshlrev_b32 v20, 4, v20
	v_and_b32 v21, 1, v0
	v_lshl_add_u32 v20, v21, 3, v20
	v_bfe_u32 v21, v0, 2, 2
	v_lshl_add_u32 v20, v21, 7, v20
	v_add_u32 v193, v20, v22
	v_add_u32 v195, 50688, v193
	s_and_b32 s54, s52, 1
	s_lshl_b32 s54, s54, 5
	s_lshr_b32 s55, s52, 1
	s_add_u32 s54, s54, s55
	s_add_u32 s54, s54, s59
	v_lshl_add_u32 v4, v12, 1, s54
	v_lshlrev_b32 v4, 10, v4
	buffer_load_dwordx4 v[108:111], v17, s[4:7], 0 offen offset:1024
	v_lshl_add_u32 v4, v13, 3, v4
	s_cmp_ge_u32 s49, 14
	s_cselect_b32 s54, 14, 0
	s_cselect_b32 s55, 2, 0
	s_sub_u32 s60, s49, s54
	s_lshl_b32 s61, s48, 2
	s_add_u32 s61, s61, s55
	s_mul_i32 s0, s52, 10560
	s_add_u32 s0, s0, 72960
	v_lshrrev_b32 v20, 2, v0
	v_mul_u32_u24 v20, 3584, v20
	v_and_b32 v21, 3, v0
	v_lshl_add_u32 v20, v21, 4, v20
	s_lshl_b32 s54, s60, 8
	s_lshl_b32 s55, s52, 6
	s_add_u32 s54, s54, s55
	v_add_u32 v1, s54, v20
	v_add_u32 v2, 56320, v1
	v_and_b32 v20, 31, v0
	v_lshl_add_u32 v199, v20, 1, s54
	s_lshl_b32 s54, s48, 8
	s_add_u32 s54, s54, 4096
	v_lshl_add_u32 v197, v20, 3, s54
	v_lshrrev_b32 v22, 5, v0
	v_lshlrev_b32 v20, 8, v22
	v_lshl_add_u32 v20, v21, 3, v20
	v_bfe_u32 v21, v0, 2, 2
	v_lshl_add_u32 v20, v21, 6, v20
	v_bfe_u32 v21, v0, 4, 1
	v_lshl_add_u32 v20, v21, 5, v20
	v_add_u32 v3, s0, v20
	s_lshl_b32 s54, s52, 11
	s_add_u32 s54, s54, 266240
	v_add_u32 v198, s54, v5
	v_lshrrev_b32 v20, 2, v0
	v_and_b32 v20, 4, v20
	v_and_b32 v196, 7, v0
	v_xor_b32 v196, v196, v20
	v_lshlrev_b32 v196, 4, v196
	v_lshrrev_b32 v20, 3, v0
	v_mul_u32_u24 v20, 1024, v20
	v_add_u32 v196, v196, v20
	s_lshl_b32 s56, s52, 14
	s_add_u32 s55, s66, s56
	v_add_u32 v196, s55, v196
	v_add_u32 v194, 7136, v196
	s_mul_i32 s63, s52, 2112
	v_lshrrev_b32 v20, 4, v0
	v_and_b32 v21, 1, v20
	v_lshrrev_b32 v23, 1, v20
	v_and_b32 v24, 15, v0
	v_lshlrev_b32 v14, 14, v21
	v_lshl_add_u32 v14, v23, 8, v14
	v_lshl_add_u32 v14, v24, 4, v14
	s_lshl_b32 s54, s50, 16
	s_lshl_b32 s55, s51, 11
	s_add_u32 s54, s54, s55
	s_lshl_b32 s55, s52, 9
	s_add_u32 s54, s54, s55
	s_add_u32 s54, s54, 1048576
	v_add_u32 v14, s54, v14
	v_lshlrev_b32 v25, 10, v23
	v_lshl_add_u32 v25, v21, 9, v25
	v_lshl_add_u32 v25, v24, 4, v25
	s_lshr_b32 s55, s52, 1
	s_lshl_b32 s54, s50, 1
	s_add_u32 s54, s54, s55
	s_lshl_b32 s54, s54, 15
	s_lshl_b32 s55, s51, 12
	s_add_u32 s54, s54, s55
	s_and_b32 s55, s52, 1
	s_lshl_b32 s55, s55, 8
	s_add_u32 s54, s54, s55
	s_add_u32 s54, s54, 3145728
	v_add_u32 v25, s54, v25
	v_accvgpr_write_b32 a229, v25
	s_lshl_b32 s54, s50, 3
	s_add_u32 s54, s54, s51
	s_lshl_b32 s54, s54, 11
	s_lshl_b32 s55, s52, 8
	s_add_u32 s54, s54, s55
	s_add_u32 s54, s54, 524288
	v_lshl_add_u32 v25, v24, 4, s54
	v_lshl_add_u32 v25, v23, 10, v25
	v_accvgpr_write_b32 a230, v25
	s_lshl_b32 s54, s50, 7
	s_add_u32 s54, s54, 24576
	v_and_b32 v24, 1, v0
	v_lshl_add_u32 v25, v24, 12, s54
	s_lshl_b32 s54, s50, 9
	s_add_u32 s54, s54, 32768
	v_and_b32 v24, 3, v0
	v_lshl_add_u32 v24, v24, 7, s54
	v_cmp_gt_u32 vcc, 32, v0
	s_nop 1
	v_cndmask_b32 v25, v24, v25, vcc
	v_accvgpr_write_b32 a231, v25
	s_and_b32 s54, s50, 1
	s_lshl_b32 s54, s54, 9
	s_cmp_eq_u32 s52, 0
	s_cselect_b32 s55, 1024, 0
	s_add_u32 s54, s54, s55
	s_add_u32 s54, s54, 157696
	v_lshl_add_u32 v14, v12, 4, s54
	v_and_b32 v247, 15, v0
	v_lshrrev_b32 v248, 4, v0
	v_lshlrev_b32 v248, 2, v248
	v_sub_u32 v247, v247, v248
	v_mov_b32 v249, 0xf149f2ca
	s_cmp_eq_u32 s59, 0
	s_cselect_b32 s62, -100, 0
	s_mov_b32 s54, 0xffff
	v_subrev_u32 v250, 0, v247
	v_cmp_gt_u32 vcc, 8, v250
	s_nop 1
	v_cndmask_b32 v251, v249, 0, vcc
	v_accvgpr_write_b32 a192, v251
	v_mov_b32 v252, s54
	v_cndmask_b32 v252, 0, v252, vcc
	v_subrev_u32 v250, 1, v247
	v_cmp_gt_u32 vcc, 8, v250
	s_nop 1
	v_cndmask_b32 v251, v249, 0, vcc
	v_accvgpr_write_b32 a193, v251
	v_mov_b32 v251, s67
	v_cndmask_b32 v251, 0, v251, vcc
	v_or_b32 v251, v251, v252
	v_accvgpr_write_b32 a208, v251
	v_subrev_u32 v250, 2, v247
	v_cmp_gt_u32 vcc, 8, v250
	s_nop 1
	v_cndmask_b32 v251, v249, 0, vcc
	v_accvgpr_write_b32 a194, v251
	v_mov_b32 v252, s54
	v_cndmask_b32 v252, 0, v252, vcc
	v_subrev_u32 v250, 3, v247
	v_cmp_gt_u32 vcc, 8, v250
	s_nop 1
	v_cndmask_b32 v251, v249, 0, vcc
	v_accvgpr_write_b32 a195, v251
	v_mov_b32 v251, s67
	v_cndmask_b32 v251, 0, v251, vcc
	v_or_b32 v251, v251, v252
	v_accvgpr_write_b32 a209, v251
	v_subrev_u32 v250, 0, v247
	v_cmp_ge_i32 vcc, -9, v250
	s_nop 1
	v_cndmask_b32 v251, v249, 0, vcc
	v_accvgpr_write_b32 a196, v251
	v_mov_b32 v252, s54
	v_cndmask_b32 v252, 0, v252, vcc
	v_subrev_u32 v250, 1, v247
	v_cmp_ge_i32 vcc, -9, v250
	s_nop 1
	v_cndmask_b32 v251, v249, 0, vcc
	v_accvgpr_write_b32 a197, v251
	v_mov_b32 v251, s67
	v_cndmask_b32 v251, 0, v251, vcc
	v_or_b32 v251, v251, v252
	v_accvgpr_write_b32 a210, v251
	v_subrev_u32 v250, 2, v247
	v_cmp_ge_i32 vcc, -9, v250
	s_nop 1
	v_cndmask_b32 v251, v249, 0, vcc
	v_accvgpr_write_b32 a198, v251
	v_mov_b32 v252, s54
	v_cndmask_b32 v252, 0, v252, vcc
	v_subrev_u32 v250, 3, v247
	v_cmp_ge_i32 vcc, -9, v250
	s_nop 1
	v_cndmask_b32 v251, v249, 0, vcc
	v_accvgpr_write_b32 a199, v251
	v_mov_b32 v251, s67
	v_cndmask_b32 v251, 0, v251, vcc
	v_or_b32 v251, v251, v252
	v_accvgpr_write_b32 a211, v251
	v_subrev_u32 v250, 0, v247
	v_add_u32 v251, 0, v248
	v_cmp_gt_u32 vcc, 8, v251
	s_nop 1
	v_cndmask_b32 v250, 0, v250, vcc
	v_subrev_u32 v250, s62, v250
	v_cmp_ge_i32 vcc, -1, v250
	s_nop 1
	v_cndmask_b32 v251, v249, 0, vcc
	v_accvgpr_write_b32 a200, v251
	v_mov_b32 v252, s54
	v_cndmask_b32 v252, 0, v252, vcc
	v_subrev_u32 v250, 1, v247
	v_add_u32 v251, 1, v248
	v_cmp_gt_u32 vcc, 8, v251
	s_nop 1
	v_cndmask_b32 v250, 0, v250, vcc
	v_subrev_u32 v250, s62, v250
	v_cmp_ge_i32 vcc, -1, v250
	s_nop 1
	v_cndmask_b32 v251, v249, 0, vcc
	v_accvgpr_write_b32 a201, v251
	v_mov_b32 v251, s67
	v_cndmask_b32 v251, 0, v251, vcc
	v_or_b32 v251, v251, v252
	v_accvgpr_write_b32 a212, v251
	v_subrev_u32 v250, 2, v247
	v_add_u32 v251, 2, v248
	v_cmp_gt_u32 vcc, 8, v251
	s_nop 1
	v_cndmask_b32 v250, 0, v250, vcc
	v_subrev_u32 v250, s62, v250
	v_cmp_ge_i32 vcc, -1, v250
	s_nop 1
	v_cndmask_b32 v251, v249, 0, vcc
	v_accvgpr_write_b32 a202, v251
	v_mov_b32 v252, s54
	v_cndmask_b32 v252, 0, v252, vcc
	v_subrev_u32 v250, 3, v247
	v_add_u32 v251, 3, v248
	v_cmp_gt_u32 vcc, 8, v251
	s_nop 1
	v_cndmask_b32 v250, 0, v250, vcc
	v_subrev_u32 v250, s62, v250
	v_cmp_ge_i32 vcc, -1, v250
	s_nop 1
	v_cndmask_b32 v251, v249, 0, vcc
	v_accvgpr_write_b32 a203, v251
	v_mov_b32 v251, s67
	v_cndmask_b32 v251, 0, v251, vcc
	v_or_b32 v251, v251, v252
	v_accvgpr_write_b32 a213, v251
	v_subrev_u32 v250, 0, v247
	v_subrev_u32 v250, s62, v250
	v_cmp_ge_i32 vcc, -9, v250
	s_nop 1
	v_cndmask_b32 v251, v249, 0, vcc
	v_accvgpr_write_b32 a204, v251
	v_mov_b32 v252, s54
	v_cndmask_b32 v252, 0, v252, vcc
	v_subrev_u32 v250, 1, v247
	v_subrev_u32 v250, s62, v250
	v_cmp_ge_i32 vcc, -9, v250
	s_nop 1
	v_cndmask_b32 v251, v249, 0, vcc
	v_accvgpr_write_b32 a205, v251
	v_mov_b32 v251, s67
	v_cndmask_b32 v251, 0, v251, vcc
	v_or_b32 v251, v251, v252
	v_accvgpr_write_b32 a214, v251
	v_subrev_u32 v250, 2, v247
	v_subrev_u32 v250, s62, v250
	v_cmp_ge_i32 vcc, -9, v250
	s_nop 1
	v_cndmask_b32 v251, v249, 0, vcc
	v_accvgpr_write_b32 a206, v251
	v_mov_b32 v252, s54
	v_cndmask_b32 v252, 0, v252, vcc
	v_subrev_u32 v250, 3, v247
	v_subrev_u32 v250, s62, v250
	v_cmp_ge_i32 vcc, -9, v250
	s_nop 1
	v_cndmask_b32 v251, v249, 0, vcc
	v_accvgpr_write_b32 a207, v251
	v_mov_b32 v251, s67
	v_cndmask_b32 v251, 0, v251, vcc
	v_or_b32 v251, v251, v252
	v_accvgpr_write_b32 a215, v251
	s_lshl_b32 s56, s52, 5
	v_lshl_add_u32 v13, v22, 3, s56
	s_lshl_b32 s54, s48, 5
	s_add_u32 s54, s54, s49
	s_lshl_b32 s54, s54, 3
	s_add_u32 s54, s54, 4096
	v_mov_b32 v238, s69
	v_mov_b32 v240, s54
	s_lshl_b32 s56, s52, 10
	v_add_u32 v12, s56, v5
	s_cmp_ge_u32 s52, 2
	s_cselect_b32 s55, 20736, 0
	s_add_u32 s55, s55, 136960
	v_add_u32 v11, s55, v12
	s_waitcnt vmcnt(11)
	v_readfirstlane_b32 s53, v10
	v_add_u32 v10, 262144, v12
	v_add_u32 v12, 274432, v12
	s_mul_i32 s53, s53, 0x9e3779b1
	s_add_u32 s53, s53, 0x7f4a7c15
	s_waitcnt vmcnt(10)
	v_lshlrev_b32 v234, 16, v216
	v_and_b32 v235, s67, v216
	v_lshlrev_b32 v236, 16, v217
	v_and_b32 v237, s67, v217
	v_mul_f32 v218, 0xbfb8aa3b, v234
	v_mul_f32 v219, 0xbfb8aa3b, v235
	v_mul_f32 v220, 0xbfb8aa3b, v236
	v_mul_f32 v221, 0xbfb8aa3b, v237
	v_exp_f32 v218, v218
	v_exp_f32 v219, v219
	v_exp_f32 v220, v220
	v_exp_f32 v221, v221
	v_add_f32 v218, 1.0, v218
	v_add_f32 v219, 1.0, v219
	v_add_f32 v220, 1.0, v220
	v_add_f32 v221, 1.0, v221
	v_rcp_f32 v218, v218
	v_rcp_f32 v219, v219
	v_rcp_f32 v220, v220
	v_rcp_f32 v221, v221
	v_mul_f32 v234, v234, v218
	v_mul_f32 v235, v235, v219
	v_mul_f32 v236, v236, v220
	v_mul_f32 v237, v237, v221
	v_cvt_pk_bf16_f32 v218, v234, 0
	v_cvt_pk_bf16_f32 v219, 0, v234
	v_cvt_pk_bf16_f32 v220, v235, 0
	v_cvt_pk_bf16_f32 v221, 0, v235
	v_cvt_pk_bf16_f32 v222, v236, 0
	v_cvt_pk_bf16_f32 v223, 0, v236
	v_cvt_pk_bf16_f32 v224, v237, 0
	v_cvt_pk_bf16_f32 v225, 0, v237
	s_waitcnt vmcnt(9)
	v_dot2_f32_bf16 v226, v200, v218, 0
	v_dot2_f32_bf16 v227, v200, v219, 0
	v_dot2_f32_bf16 v228, v201, v218, 0
	v_dot2_f32_bf16 v229, v201, v219, 0
	v_dot2_f32_bf16 v230, v202, v218, 0
	v_dot2_f32_bf16 v231, v202, v219, 0
	v_dot2_f32_bf16 v232, v203, v218, 0
	v_dot2_f32_bf16 v233, v203, v219, 0
	s_waitcnt vmcnt(8)
	v_dot2_f32_bf16 v226, v204, v220, v226
	buffer_load_dwordx4 v[112:115], v17, s[4:7], s65 offen offset:1024
	v_dot2_f32_bf16 v227, v204, v221, v227
	v_dot2_f32_bf16 v228, v205, v220, v228
	v_dot2_f32_bf16 v229, v205, v221, v229
	v_dot2_f32_bf16 v230, v206, v220, v230
	v_dot2_f32_bf16 v231, v206, v221, v231
	v_dot2_f32_bf16 v232, v207, v220, v232
	v_dot2_f32_bf16 v233, v207, v221, v233
	s_waitcnt vmcnt(8)
	v_dot2_f32_bf16 v226, v208, v222, v226
	v_dot2_f32_bf16 v227, v208, v223, v227
	v_dot2_f32_bf16 v228, v209, v222, v228
	buffer_load_dwordx4 v[116:119], v16, s[4:7], 0 offen offset:256
	v_dot2_f32_bf16 v229, v209, v223, v229
	v_dot2_f32_bf16 v230, v210, v222, v230
	v_dot2_f32_bf16 v231, v210, v223, v231
	v_dot2_f32_bf16 v232, v211, v222, v232
	v_dot2_f32_bf16 v233, v211, v223, v233
	s_waitcnt vmcnt(8)
	v_dot2_f32_bf16 v226, v212, v224, v226
	v_dot2_f32_bf16 v227, v212, v225, v227
	v_dot2_f32_bf16 v228, v213, v224, v228
	v_dot2_f32_bf16 v229, v213, v225, v229
	v_dot2_f32_bf16 v230, v214, v224, v230
	v_dot2_f32_bf16 v231, v214, v225, v231
	buffer_load_dwordx4 v[120:123], v17, s[4:7], 0 offen offset:256
	v_dot2_f32_bf16 v232, v215, v224, v232
	v_dot2_f32_bf16 v233, v215, v225, v233
	v_permlane32_swap_b32 v226, v227
	v_permlane32_swap_b32 v228, v229
	v_permlane32_swap_b32 v230, v231
	v_permlane32_swap_b32 v232, v233
	v_add_f32 v226, v226, v227
	v_add_f32 v228, v228, v229
	v_add_f32 v230, v230, v231
	v_add_f32 v232, v232, v233
	buffer_load_dwordx4 v[124:127], v17, s[4:7], s65 offen offset:256
	v_permlane16_swap_b32 v226, v228
	v_permlane16_swap_b32 v230, v232
	v_add_f32 v226, v226, v228
	v_add_f32 v230, v230, v232
	s_nop 0
	v_add_f32_dpp v226, v226, v226 row_ror:8 row_mask:0xf bank_mask:0xf
	v_add_f32_dpp v230, v230, v230 row_ror:8 row_mask:0xf bank_mask:0xf
	s_nop 0
	v_add_f32_dpp v226, v226, v226 row_ror:4 row_mask:0xf bank_mask:0xf
	v_add_f32_dpp v230, v230, v230 row_ror:4 row_mask:0xf bank_mask:0xf
	ds_write2_b32 v245, v226, v230 offset1:4
	s_waitcnt lgkmcnt(0)
	s_barrier
	ds_read_b128 v[200:203], v246 offset:0
	ds_read_b128 v[204:207], v246 offset:128
	ds_read_b128 v[208:211], v246 offset:256
	ds_read_b128 v[212:215], v246 offset:384
	s_mov_b32 s54, 0x07060501
	s_mov_b32 s55, 0x07060502
	s_mov_b32 s56, 0x07060503
	s_waitcnt lgkmcnt(2)
	v_pk_add_f32 v[200:201], v[200:201], v[204:205]
	v_pk_add_f32 v[202:203], v[202:203], v[206:207]
	s_waitcnt lgkmcnt(0)
	v_pk_add_f32 v[208:209], v[208:209], v[212:213]
	v_pk_add_f32 v[210:211], v[210:211], v[214:215]
	v_pk_add_f32 v[200:201], v[200:201], v[208:209]
	v_pk_add_f32 v[202:203], v[202:203], v[210:211]
	v_add_u32 v203, 0x80, v203
	v_perm_b32 v200, v200, v203, s54
	v_perm_b32 v201, v201, v203, s55
	v_perm_b32 v202, v202, v203, s56
	v_mov_b32 v203, s53
	buffer_store_dwordx4 v[200:203], v244, s[44:47], 0 offen sc1
	v_mov_b32 v239, s53
	buffer_store_dwordx2 v[238:239], v240, s[44:47], 0 offen sc1
	s_mov_b32 s56, 0x3f803f80
	v_mov_b32 v176, 0
	v_mov_b32 v177, 0
	v_mov_b32 v178, 0
	v_mov_b32 v179, 0
	v_mov_b32 v180, 0
	v_mov_b32 v181, 0
	v_mov_b32 v182, 0
	v_mov_b32 v183, 0
	v_mov_b32 v184, 0
	v_mov_b32 v185, 0
	s_lshl_b32 s54, s52, 9
	s_add_u32 s54, s54, 157696
	v_lshl_add_u32 v216, v0, 3, s54
	s_lshl_b32 s54, s52, 4
	s_add_u32 s54, s54, 162304
	v_lshrrev_b32 v217, 4, v0
	v_lshl_add_u32 v217, v217, 2, s54
	buffer_load_dwordx4 v[128:131], v17, s[4:7], 0 offen offset:1280
	s_waitcnt vmcnt(10)
	v_dot2c_f32_bf16 v176, s56, v96
	v_dot2c_f32_bf16 v177, v96, v96
	s_waitcnt vmcnt(9)
	v_dot2c_f32_bf16 v178, s56, v100
	v_dot2c_f32_bf16 v179, v100, v100
	s_waitcnt vmcnt(8)
	v_dot2c_f32_bf16 v180, s56, v104
	v_dot2c_f32_bf16 v181, v104, v104
	s_waitcnt vmcnt(7)
	v_dot2c_f32_bf16 v182, s56, v108
	v_dot2c_f32_bf16 v183, v108, v108
	s_waitcnt vmcnt(6)
	v_dot2c_f32_bf16 v184, s56, v112
	v_dot2c_f32_bf16 v185, v112, v112
	v_dot2c_f32_bf16 v176, s56, v97
	v_dot2c_f32_bf16 v177, v97, v97
	v_dot2c_f32_bf16 v178, s56, v101
	v_dot2c_f32_bf16 v179, v101, v101
	v_dot2c_f32_bf16 v180, s56, v105
	buffer_load_dwordx4 v[132:135], v17, s[4:7], s65 offen offset:1280
	v_dot2c_f32_bf16 v181, v105, v105
	v_dot2c_f32_bf16 v182, s56, v109
	v_dot2c_f32_bf16 v183, v109, v109
	v_dot2c_f32_bf16 v184, s56, v113
	v_dot2c_f32_bf16 v185, v113, v113
	v_dot2c_f32_bf16 v176, s56, v98
	v_dot2c_f32_bf16 v177, v98, v98
	v_dot2c_f32_bf16 v178, s56, v102
	v_dot2c_f32_bf16 v179, v102, v102
	v_dot2c_f32_bf16 v180, s56, v106
	v_dot2c_f32_bf16 v181, v106, v106
	v_dot2c_f32_bf16 v182, s56, v110
	v_dot2c_f32_bf16 v183, v110, v110
	v_dot2c_f32_bf16 v184, s56, v114
	v_dot2c_f32_bf16 v185, v114, v114
	buffer_load_dwordx4 v[136:139], v18, s[4:7], 0 offen offset:0
	v_dot2c_f32_bf16 v176, s56, v99
	v_dot2c_f32_bf16 v177, v99, v99
	v_dot2c_f32_bf16 v178, s56, v103
	v_dot2c_f32_bf16 v179, v103, v103
	v_dot2c_f32_bf16 v180, s56, v107
	v_dot2c_f32_bf16 v181, v107, v107
	v_dot2c_f32_bf16 v182, s56, v111
	v_dot2c_f32_bf16 v183, v111, v111
	v_dot2c_f32_bf16 v184, s56, v115
	v_dot2c_f32_bf16 v185, v115, v115
	buffer_load_dwordx4 v[140:143], v19, s[4:7], 0 offen offset:0
	buffer_load_dwordx4 v[144:147], v19, s[4:7], s65 offen offset:0
	buffer_load_dwordx4 v[148:151], v19, s[4:7], 0 offen offset:1024
	buffer_load_dwordx4 v[152:155], v19, s[4:7], s65 offen offset:1024
	buffer_load_dwordx4 v[156:159], v18, s[4:7], 0 offen offset:256
	buffer_load_dwordx4 v[160:163], v19, s[4:7], 0 offen offset:256
	s_waitcnt vmcnt(13)
	v_dot2c_f32_bf16 v176, s56, v116
	v_dot2c_f32_bf16 v177, v116, v116
	s_waitcnt vmcnt(12)
	v_dot2c_f32_bf16 v178, s56, v120
	v_dot2c_f32_bf16 v179, v120, v120
	s_waitcnt vmcnt(11)
	v_dot2c_f32_bf16 v180, s56, v124
	v_dot2c_f32_bf16 v181, v124, v124
	s_waitcnt vmcnt(8)
	v_dot2c_f32_bf16 v182, s56, v128
	v_dot2c_f32_bf16 v183, v128, v128
	s_waitcnt vmcnt(7)
	v_dot2c_f32_bf16 v184, s56, v132
	v_dot2c_f32_bf16 v185, v132, v132
	v_dot2c_f32_bf16 v176, s56, v117
	v_dot2c_f32_bf16 v177, v117, v117
	v_dot2c_f32_bf16 v178, s56, v121
	v_dot2c_f32_bf16 v179, v121, v121
	v_dot2c_f32_bf16 v180, s56, v125
	buffer_load_dwordx4 v[164:167], v19, s[4:7], s65 offen offset:256
	v_dot2c_f32_bf16 v181, v125, v125
	v_dot2c_f32_bf16 v182, s56, v129
	v_dot2c_f32_bf16 v183, v129, v129
	v_dot2c_f32_bf16 v184, s56, v133
	v_dot2c_f32_bf16 v185, v133, v133
	v_dot2c_f32_bf16 v176, s56, v118
	v_dot2c_f32_bf16 v177, v118, v118
	v_dot2c_f32_bf16 v178, s56, v122
	v_dot2c_f32_bf16 v179, v122, v122
	v_dot2c_f32_bf16 v180, s56, v126
	v_dot2c_f32_bf16 v181, v126, v126
	v_dot2c_f32_bf16 v182, s56, v130
	v_dot2c_f32_bf16 v183, v130, v130
	v_dot2c_f32_bf16 v184, s56, v134
	v_dot2c_f32_bf16 v185, v134, v134
	buffer_load_dwordx4 v[168:171], v19, s[4:7], 0 offen offset:1280
	v_dot2c_f32_bf16 v176, s56, v119
	v_dot2c_f32_bf16 v177, v119, v119
	v_dot2c_f32_bf16 v178, s56, v123
	v_dot2c_f32_bf16 v179, v123, v123
	v_dot2c_f32_bf16 v180, s56, v127
	v_dot2c_f32_bf16 v181, v127, v127
	v_dot2c_f32_bf16 v182, s56, v131
	v_dot2c_f32_bf16 v183, v131, v131
	v_dot2c_f32_bf16 v184, s56, v135
	v_dot2c_f32_bf16 v185, v135, v135
	buffer_load_dwordx4 v[172:175], v19, s[4:7], s65 offen offset:1280
	s_add_u32 m0, s68, 0
	s_add_u32 s1, s64, 0
	buffer_load_dwordx4 v192, s[8:11], s1 offen offset:0 lds
	v_lshlrev_b32 v16, 16, v96
	v_and_b32 v17, s67, v96
	v_lshlrev_b32 v18, 16, v97
	v_and_b32 v19, s67, v97
	v_lshlrev_b32 v20, 16, v98
	v_and_b32 v21, s67, v98
	v_lshlrev_b32 v22, 16, v99
	v_and_b32 v23, s67, v99
	v_lshlrev_b32 v24, 16, v100
	v_and_b32 v25, s67, v100
	v_lshlrev_b32 v26, 16, v101
	v_and_b32 v27, s67, v101
	v_lshlrev_b32 v28, 16, v102
	v_and_b32 v29, s67, v102
	v_lshlrev_b32 v30, 16, v103
	buffer_load_dwordx4 v192, s[8:11], s1 offen offset:1024 lds
	v_and_b32 v31, s67, v103
	v_lshlrev_b32 v32, 16, v104
	v_and_b32 v33, s67, v104
	v_lshlrev_b32 v34, 16, v105
	v_and_b32 v35, s67, v105
	v_lshlrev_b32 v36, 16, v106
	v_and_b32 v37, s67, v106
	v_lshlrev_b32 v38, 16, v107
	v_and_b32 v39, s67, v107
	v_lshlrev_b32 v40, 16, v108
	v_and_b32 v41, s67, v108
	v_lshlrev_b32 v42, 16, v109
	v_and_b32 v43, s67, v109
	v_lshlrev_b32 v44, 16, v110
	v_and_b32 v45, s67, v110
	buffer_load_dwordx4 v192, s[8:11], s1 offen offset:2048 lds
	v_lshlrev_b32 v46, 16, v111
	v_and_b32 v47, s67, v111
	v_lshlrev_b32 v48, 16, v112
	v_and_b32 v49, s67, v112
	v_lshlrev_b32 v50, 16, v113
	v_and_b32 v51, s67, v113
	v_lshlrev_b32 v52, 16, v114
	v_and_b32 v53, s67, v114
	v_lshlrev_b32 v54, 16, v115
	v_and_b32 v55, s67, v115
	v_lshlrev_b32 v56, 16, v116
	v_and_b32 v57, s67, v116
	v_lshlrev_b32 v58, 16, v117
	v_and_b32 v59, s67, v117
	v_lshlrev_b32 v60, 16, v118
	s_add_u32 m0, s68, 3104
	s_add_u32 s1, s64, 24576
	buffer_load_dwordx4 v192, s[8:11], s1 offen offset:0 lds
	v_and_b32 v61, s67, v118
	v_lshlrev_b32 v62, 16, v119
	v_and_b32 v63, s67, v119
	v_lshlrev_b32 v64, 16, v120
	v_and_b32 v65, s67, v120
	v_lshlrev_b32 v66, 16, v121
	v_and_b32 v67, s67, v121
	v_lshlrev_b32 v68, 16, v122
	v_and_b32 v69, s67, v122
	v_lshlrev_b32 v70, 16, v123
	v_and_b32 v71, s67, v123
	v_lshlrev_b32 v72, 16, v124
	v_and_b32 v73, s67, v124
	v_lshlrev_b32 v74, 16, v125
	v_and_b32 v75, s67, v125
	buffer_load_dwordx4 v192, s[8:11], s1 offen offset:1024 lds
	v_lshlrev_b32 v76, 16, v126
	v_and_b32 v77, s67, v126
	v_lshlrev_b32 v78, 16, v127
	v_and_b32 v79, s67, v127
	v_lshlrev_b32 v80, 16, v128
	v_and_b32 v81, s67, v128
	v_lshlrev_b32 v82, 16, v129
	v_and_b32 v83, s67, v129
	v_lshlrev_b32 v84, 16, v130
	v_and_b32 v85, s67, v130
	v_lshlrev_b32 v86, 16, v131
	v_and_b32 v87, s67, v131
	v_lshlrev_b32 v88, 16, v132
	v_and_b32 v89, s67, v132
	v_lshlrev_b32 v90, 16, v133
	buffer_load_dwordx4 v192, s[8:11], s1 offen offset:2048 lds
	v_and_b32 v91, s67, v133
	v_lshlrev_b32 v92, 16, v134
	v_and_b32 v93, s67, v134
	v_lshlrev_b32 v94, 16, v135
	v_and_b32 v95, s67, v135
	s_waitcnt vmcnt(15)
	v_dot2c_f32_bf16 v176, s56, v136
	v_dot2c_f32_bf16 v177, v136, v136
	s_waitcnt vmcnt(14)
	v_dot2c_f32_bf16 v178, s56, v140
	v_dot2c_f32_bf16 v179, v140, v140
	s_waitcnt vmcnt(13)
	v_dot2c_f32_bf16 v180, s56, v144
	v_dot2c_f32_bf16 v181, v144, v144
	s_waitcnt vmcnt(12)
	v_dot2c_f32_bf16 v182, s56, v148
	v_dot2c_f32_bf16 v183, v148, v148
	s_waitcnt vmcnt(11)
	v_dot2c_f32_bf16 v184, s56, v152
	v_dot2c_f32_bf16 v185, v152, v152
	s_add_u32 m0, s68, 6208
	s_add_u32 s1, s64, 49152
	buffer_load_dwordx4 v192, s[8:11], s1 offen offset:0 lds
	v_dot2c_f32_bf16 v176, s56, v137
	v_dot2c_f32_bf16 v177, v137, v137
	v_dot2c_f32_bf16 v178, s56, v141
	v_dot2c_f32_bf16 v179, v141, v141
	v_dot2c_f32_bf16 v180, s56, v145
	v_dot2c_f32_bf16 v181, v145, v145
	v_dot2c_f32_bf16 v182, s56, v149
	v_dot2c_f32_bf16 v183, v149, v149
	v_dot2c_f32_bf16 v184, s56, v153
	v_dot2c_f32_bf16 v185, v153, v153
	v_dot2c_f32_bf16 v176, s56, v138
	v_dot2c_f32_bf16 v177, v138, v138
	v_dot2c_f32_bf16 v178, s56, v142
	v_dot2c_f32_bf16 v179, v142, v142
	v_dot2c_f32_bf16 v180, s56, v146
	buffer_load_dwordx4 v192, s[8:11], s1 offen offset:1024 lds
	v_dot2c_f32_bf16 v181, v146, v146
	v_dot2c_f32_bf16 v182, s56, v150
	v_dot2c_f32_bf16 v183, v150, v150
	v_dot2c_f32_bf16 v184, s56, v154
	v_dot2c_f32_bf16 v185, v154, v154
	v_dot2c_f32_bf16 v176, s56, v139
	v_dot2c_f32_bf16 v177, v139, v139
	v_dot2c_f32_bf16 v178, s56, v143
	v_dot2c_f32_bf16 v179, v143, v143
	v_dot2c_f32_bf16 v180, s56, v147
	v_dot2c_f32_bf16 v181, v147, v147
	v_dot2c_f32_bf16 v182, s56, v151
	v_dot2c_f32_bf16 v183, v151, v151
	v_dot2c_f32_bf16 v184, s56, v155
	v_dot2c_f32_bf16 v185, v155, v155
	buffer_load_dwordx4 v192, s[8:11], s1 offen offset:2048 lds
	v_lshlrev_b32 v96, 16, v136
	v_and_b32 v97, s67, v136
	v_lshlrev_b32 v98, 16, v137
	v_and_b32 v99, s67, v137
	v_lshlrev_b32 v100, 16, v138
	v_and_b32 v101, s67, v138
	v_lshlrev_b32 v102, 16, v139
	v_and_b32 v103, s67, v139
	v_lshlrev_b32 v104, 16, v140
	v_and_b32 v105, s67, v140
	v_lshlrev_b32 v106, 16, v141
	v_and_b32 v107, s67, v141
	v_lshlrev_b32 v108, 16, v142
	v_and_b32 v109, s67, v142
	v_lshlrev_b32 v110, 16, v143
	s_add_u32 m0, s68, 9312
	s_add_u32 s1, s64, 73728
	buffer_load_dwordx4 v192, s[8:11], s1 offen offset:0 lds
	v_and_b32 v111, s67, v143
	v_lshlrev_b32 v112, 16, v144
	v_and_b32 v113, s67, v144
	v_lshlrev_b32 v114, 16, v145
	v_and_b32 v115, s67, v145
	v_lshlrev_b32 v116, 16, v146
	v_and_b32 v117, s67, v146
	v_lshlrev_b32 v118, 16, v147
	v_and_b32 v119, s67, v147
	v_lshlrev_b32 v120, 16, v148
	v_and_b32 v121, s67, v148
	v_lshlrev_b32 v122, 16, v149
	v_and_b32 v123, s67, v149
	v_lshlrev_b32 v124, 16, v150
	v_and_b32 v125, s67, v150
	buffer_load_dwordx4 v192, s[8:11], s1 offen offset:1024 lds
	v_lshlrev_b32 v126, 16, v151
	v_and_b32 v127, s67, v151
	v_lshlrev_b32 v128, 16, v152
	v_and_b32 v129, s67, v152
	v_lshlrev_b32 v130, 16, v153
	v_and_b32 v131, s67, v153
	v_lshlrev_b32 v132, 16, v154
	v_and_b32 v133, s67, v154
	v_lshlrev_b32 v134, 16, v155
	v_and_b32 v135, s67, v155
	s_waitcnt vmcnt(15)
	v_dot2c_f32_bf16 v176, s56, v156
	v_dot2c_f32_bf16 v177, v156, v156
	s_waitcnt vmcnt(14)
	v_dot2c_f32_bf16 v178, s56, v160
	v_dot2c_f32_bf16 v179, v160, v160
	s_waitcnt vmcnt(13)
	v_dot2c_f32_bf16 v180, s56, v164
	buffer_load_dwordx4 v192, s[8:11], s1 offen offset:2048 lds
	v_dot2c_f32_bf16 v181, v164, v164
	s_waitcnt vmcnt(13)
	v_dot2c_f32_bf16 v182, s56, v168
	v_dot2c_f32_bf16 v183, v168, v168
	s_waitcnt vmcnt(12)
	v_dot2c_f32_bf16 v184, s56, v172
	v_dot2c_f32_bf16 v185, v172, v172
	v_dot2c_f32_bf16 v176, s56, v157
	v_dot2c_f32_bf16 v177, v157, v157
	v_dot2c_f32_bf16 v178, s56, v161
	v_dot2c_f32_bf16 v179, v161, v161
	v_dot2c_f32_bf16 v180, s56, v165
	v_dot2c_f32_bf16 v181, v165, v165
	v_dot2c_f32_bf16 v182, s56, v169
	v_dot2c_f32_bf16 v183, v169, v169
	v_dot2c_f32_bf16 v184, s56, v173
	v_dot2c_f32_bf16 v185, v173, v173
	s_add_u32 m0, s68, 50688
	s_add_u32 s1, s64, 393216
	buffer_load_dwordx4 v192, s[8:11], s1 offen offset:0 lds
	v_dot2c_f32_bf16 v176, s56, v158
	v_dot2c_f32_bf16 v177, v158, v158
	v_dot2c_f32_bf16 v178, s56, v162
	v_dot2c_f32_bf16 v179, v162, v162
	v_dot2c_f32_bf16 v180, s56, v166
	v_dot2c_f32_bf16 v181, v166, v166
	v_dot2c_f32_bf16 v182, s56, v170
	v_dot2c_f32_bf16 v183, v170, v170
	v_dot2c_f32_bf16 v184, s56, v174
	v_dot2c_f32_bf16 v185, v174, v174
	v_dot2c_f32_bf16 v176, s56, v159
	v_dot2c_f32_bf16 v177, v159, v159
	v_dot2c_f32_bf16 v178, s56, v163
	v_dot2c_f32_bf16 v179, v163, v163
	v_dot2c_f32_bf16 v180, s56, v167
	buffer_load_dwordx4 v192, s[8:11], s1 offen offset:1024 lds
	v_dot2c_f32_bf16 v181, v167, v167
	v_dot2c_f32_bf16 v182, s56, v171
	v_dot2c_f32_bf16 v183, v171, v171
	v_dot2c_f32_bf16 v184, s56, v175
	v_dot2c_f32_bf16 v185, v175, v175
	v_lshlrev_b32 v136, 16, v156
	v_and_b32 v137, s67, v156
	v_lshlrev_b32 v138, 16, v157
	v_and_b32 v139, s67, v157
	v_lshlrev_b32 v140, 16, v158
	v_and_b32 v141, s67, v158
	v_lshlrev_b32 v142, 16, v159
	v_and_b32 v143, s67, v159
	v_lshlrev_b32 v144, 16, v160
	v_and_b32 v145, s67, v160
	buffer_load_dwordx4 v192, s[8:11], s1 offen offset:2048 lds
	v_lshlrev_b32 v146, 16, v161
	v_and_b32 v147, s67, v161
	v_lshlrev_b32 v148, 16, v162
	v_and_b32 v149, s67, v162
	v_lshlrev_b32 v150, 16, v163
	v_and_b32 v151, s67, v163
	v_lshlrev_b32 v152, 16, v164
	v_and_b32 v153, s67, v164
	v_lshlrev_b32 v154, 16, v165
	v_and_b32 v155, s67, v165
	v_lshlrev_b32 v156, 16, v166
	v_and_b32 v157, s67, v166
	v_lshlrev_b32 v158, 16, v167
	v_and_b32 v159, s67, v167
	v_lshlrev_b32 v160, 16, v168
	s_add_u32 m0, s68, 53792
	s_add_u32 s1, s64, 417792
	buffer_load_dwordx4 v192, s[8:11], s1 offen offset:0 lds
	v_and_b32 v161, s67, v168
	v_lshlrev_b32 v162, 16, v169
	v_and_b32 v163, s67, v169
	v_lshlrev_b32 v164, 16, v170
	v_and_b32 v165, s67, v170
	v_lshlrev_b32 v166, 16, v171
	v_and_b32 v167, s67, v171
	v_lshlrev_b32 v168, 16, v172
	v_and_b32 v169, s67, v172
	v_lshlrev_b32 v170, 16, v173
	v_and_b32 v171, s67, v173
	v_lshlrev_b32 v172, 16, v174
	v_and_b32 v173, s67, v174
	v_lshlrev_b32 v174, 16, v175
	v_and_b32 v175, s67, v175
	buffer_load_dwordx4 v[208:211], v10, s[44:47], 0 offen sc1
	v_add_f32_dpp v176, v176, v176 row_ror:8 row_mask:0xf bank_mask:0xf
	v_add_f32_dpp v177, v177, v177 row_ror:8 row_mask:0xf bank_mask:0xf
	v_add_f32_dpp v178, v178, v178 row_ror:8 row_mask:0xf bank_mask:0xf
	v_add_f32_dpp v179, v179, v179 row_ror:8 row_mask:0xf bank_mask:0xf
	v_add_f32_dpp v180, v180, v180 row_ror:8 row_mask:0xf bank_mask:0xf
	v_add_f32_dpp v181, v181, v181 row_ror:8 row_mask:0xf bank_mask:0xf
	v_add_f32_dpp v182, v182, v182 row_ror:8 row_mask:0xf bank_mask:0xf
	v_add_f32_dpp v183, v183, v183 row_ror:8 row_mask:0xf bank_mask:0xf
	v_add_f32_dpp v184, v184, v184 row_ror:8 row_mask:0xf bank_mask:0xf
	v_add_f32_dpp v185, v185, v185 row_ror:8 row_mask:0xf bank_mask:0xf
	v_add_f32_dpp v176, v176, v176 row_ror:4 row_mask:0xf bank_mask:0xf
	v_add_f32_dpp v177, v177, v177 row_ror:4 row_mask:0xf bank_mask:0xf
	v_add_f32_dpp v178, v178, v178 row_ror:4 row_mask:0xf bank_mask:0xf
	v_add_f32_dpp v179, v179, v179 row_ror:4 row_mask:0xf bank_mask:0xf
	v_add_f32_dpp v180, v180, v180 row_ror:4 row_mask:0xf bank_mask:0xf
	buffer_load_dwordx4 v[212:215], v12, s[44:47], 0 offen sc1
	v_add_f32_dpp v181, v181, v181 row_ror:4 row_mask:0xf bank_mask:0xf
	v_add_f32_dpp v182, v182, v182 row_ror:4 row_mask:0xf bank_mask:0xf
	v_add_f32_dpp v183, v183, v183 row_ror:4 row_mask:0xf bank_mask:0xf
	v_add_f32_dpp v184, v184, v184 row_ror:4 row_mask:0xf bank_mask:0xf
	v_add_f32_dpp v185, v185, v185 row_ror:4 row_mask:0xf bank_mask:0xf
	v_add_f32_dpp v176, v176, v176 row_ror:2 row_mask:0xf bank_mask:0xf
	v_add_f32_dpp v177, v177, v177 row_ror:2 row_mask:0xf bank_mask:0xf
	v_add_f32_dpp v178, v178, v178 row_ror:2 row_mask:0xf bank_mask:0xf
	v_add_f32_dpp v179, v179, v179 row_ror:2 row_mask:0xf bank_mask:0xf
	v_add_f32_dpp v180, v180, v180 row_ror:2 row_mask:0xf bank_mask:0xf
	v_add_f32_dpp v181, v181, v181 row_ror:2 row_mask:0xf bank_mask:0xf
	v_add_f32_dpp v182, v182, v182 row_ror:2 row_mask:0xf bank_mask:0xf
	v_add_f32_dpp v183, v183, v183 row_ror:2 row_mask:0xf bank_mask:0xf
	v_add_f32_dpp v184, v184, v184 row_ror:2 row_mask:0xf bank_mask:0xf
	v_add_f32_dpp v185, v185, v185 row_ror:2 row_mask:0xf bank_mask:0xf
	buffer_load_dwordx4 v192, s[8:11], s1 offen offset:1024 lds
	v_add_f32_dpp v176, v176, v176 row_ror:1 row_mask:0xf bank_mask:0xf
	v_add_f32_dpp v177, v177, v177 row_ror:1 row_mask:0xf bank_mask:0xf
	v_add_f32_dpp v178, v178, v178 row_ror:1 row_mask:0xf bank_mask:0xf
	v_add_f32_dpp v179, v179, v179 row_ror:1 row_mask:0xf bank_mask:0xf
	v_add_f32_dpp v180, v180, v180 row_ror:1 row_mask:0xf bank_mask:0xf
	v_add_f32_dpp v181, v181, v181 row_ror:1 row_mask:0xf bank_mask:0xf
	v_add_f32_dpp v182, v182, v182 row_ror:1 row_mask:0xf bank_mask:0xf
	v_add_f32_dpp v183, v183, v183 row_ror:1 row_mask:0xf bank_mask:0xf
	v_add_f32_dpp v184, v184, v184 row_ror:1 row_mask:0xf bank_mask:0xf
	v_add_f32_dpp v185, v185, v185 row_ror:1 row_mask:0xf bank_mask:0xf
	s_mov_b32 s54, 0x3b000000
	s_mov_b32 s55, 0x3727c5ac
	v_mul_f32 v186, 0xbb000000, v176
	v_mul_f32 v187, 0xbb000000, v178
	v_mul_f32 v188, 0xbb000000, v180
	buffer_load_dwordx4 v192, s[8:11], s1 offen offset:2048 lds
	v_mul_f32 v189, 0xbb000000, v182
	v_mul_f32 v190, 0xbb000000, v184
	v_mul_f32 v176, v186, v186
	v_mul_f32 v178, v187, v187
	v_mul_f32 v180, v188, v188
	v_mul_f32 v182, v189, v189
	v_mul_f32 v184, v190, v190
	v_fma_f32 v176, v177, s54, -v176
	v_fma_f32 v178, v179, s54, -v178
	v_fma_f32 v180, v181, s54, -v180
	v_fma_f32 v182, v183, s54, -v182
	v_fma_f32 v184, v185, s54, -v184
	v_max_f32 v176, 0, v176
	v_max_f32 v178, 0, v178
	v_max_f32 v180, 0, v180
	v_max_f32 v182, 0, v182
	v_max_f32 v184, 0, v184
	v_add_f32 v176, s55, v176
	v_add_f32 v178, s55, v178
	v_add_f32 v180, s55, v180
	v_add_f32 v182, s55, v182
	v_add_f32 v184, s55, v184
	v_rsq_f32 v176, v176
	v_rsq_f32 v178, v178
	v_rsq_f32 v180, v180
	v_rsq_f32 v182, v182
	v_rsq_f32 v184, v184
	ds_write2_b32 v217, v186, v176 offset0:0 offset1:80
	ds_write2_b32 v217, v187, v178 offset0:16 offset1:96
	ds_write2_b32 v217, v188, v180 offset0:32 offset1:112
	ds_write2_b32 v217, v189, v182 offset0:48 offset1:128
	ds_write2_b32 v217, v190, v184 offset0:64 offset1:144
	s_cmp_ge_u32 s52, 2
	s_cselect_b32 s57, 1.0, 0
	s_waitcnt vmcnt(3)
	v_cmp_ne_u32 vcc, s53, v211
	s_waitcnt vmcnt(2)
	v_cmp_ne_u32 s[54:55], s53, v215
	s_or_b64 vcc, vcc, s[54:55]
	s_cbranch_vccz ok_1
	s_mov_b32 s58, 200000
poll_2:
	buffer_load_dwordx4 v[208:211], v10, s[44:47], 0 offen sc1
	buffer_load_dwordx4 v[212:215], v12, s[44:47], 0 offen sc1
	s_waitcnt vmcnt(0)
	v_cmp_ne_u32 vcc, s53, v211
	v_cmp_ne_u32 s[54:55], s53, v215
	s_or_b64 vcc, vcc, s[54:55]
	s_cbranch_vccz pdone_3
	s_sub_u32 s58, s58, 1
	s_cbranch_scc0 poll_2
pdone_3:
ok_1:
	s_mov_b32 s54, 0x04000c0c
	s_mov_b32 s55, 0x0302040c
	v_perm_b32 v211, v210, v209, s54
	v_perm_b32 v215, v214, v213, s54
	v_perm_b32 v211, v208, v211, s55
	v_perm_b32 v215, v212, v215, s55
	v_add_f32 v204, v208, v212
	v_add_f32 v205, v209, v213
	v_add_f32 v206, v210, v214
	v_add_f32 v207, v211, v215
	v_add_f32 v204, s57, v204
	v_add_f32 v205, s57, v205
	v_add_f32 v206, s57, v206
	v_add_f32 v207, s57, v207
	v_cvt_pk_bf16_f32 v200, v204, v205
	v_cvt_pk_bf16_f32 v201, v206, v207
	s_bitcmp0_b32 s52, 0
	s_cselect_b32 vcc_lo, 0xffff, 0
	s_mov_b32 vcc_hi, 0
	v_lshlrev_b32 v204, 16, v200
	v_and_b32 v205, s67, v200
	v_lshlrev_b32 v206, 16, v201
	v_and_b32 v207, s67, v201
	ds_write_b128 v11, v[204:207]
	ds_write_b64 v216, v[200:201]
	s_waitcnt lgkmcnt(0)
	s_barrier
	ds_read_b128 v[200:203], v9 offset:2048
	ds_read_b128 v[204:207], v9 offset:2064
	ds_read_b128 v[208:211], v14 offset:0
	ds_read_b128 v[176:179], v9 offset:2560
	ds_read_b128 v[180:183], v9 offset:2576
	ds_read_b128 v[184:187], v14 offset:256
	ds_read_b64_tr_b16 a[0:1], v193 offset:0
	ds_read_b64_tr_b16 a[2:3], v193 offset:512
	ds_read_b64_tr_b16 a[4:5], v193 offset:1024
	ds_read_b64_tr_b16 a[6:7], v193 offset:1536
	ds_read_b64_tr_b16 a[8:9], v193 offset:2048
	ds_read_b64_tr_b16 a[10:11], v193 offset:2560
	s_waitcnt lgkmcnt(11)
	v_pk_mul_f32 v[24:25], v[24:25], v[200:201]
	ds_read_b64_tr_b16 a[12:13], v193 offset:12416
	s_add_u32 m0, s68, 56896
	s_add_u32 s1, s64, 442368
	buffer_load_dwordx4 v192, s[8:11], s1 offen offset:0 lds
	v_pk_mul_f32 v[26:27], v[26:27], v[202:203]
	s_waitcnt lgkmcnt(11)
	v_pk_mul_f32 v[28:29], v[28:29], v[204:205]
	ds_read_b64_tr_b16 a[14:15], v193 offset:12928
	v_pk_mul_f32 v[30:31], v[30:31], v[206:207]
	v_cvt_pk_bf16_f32 v24, v24, v25
	ds_read_b64_tr_b16 a[16:17], v193 offset:13440
	v_cvt_pk_bf16_f32 v25, v26, v27
	v_cvt_pk_bf16_f32 v26, v28, v29
	v_cvt_pk_bf16_f32 v27, v30, v31
	ds_read_b64_tr_b16 a[18:19], v193 offset:13952
	ds_write_b128 v6, v[24:27] offset:1024
	buffer_load_dwordx4 v192, s[8:11], s1 offen offset:1024 lds
	v_pk_mul_f32 v[32:33], v[32:33], v[200:201]
	ds_read_b64_tr_b16 a[20:21], v193 offset:14464
	v_pk_mul_f32 v[34:35], v[34:35], v[202:203]
	v_pk_mul_f32 v[36:37], v[36:37], v[204:205]
	ds_read_b64_tr_b16 a[22:23], v193 offset:14976
	v_pk_mul_f32 v[38:39], v[38:39], v[206:207]
	v_cvt_pk_bf16_f32 v32, v32, v33
	v_cvt_pk_bf16_f32 v33, v34, v35
	ds_read_b64_tr_b16 a[24:25], v193 offset:24832
	v_cvt_pk_bf16_f32 v34, v36, v37
	v_cvt_pk_bf16_f32 v35, v38, v39
	ds_read_b64_tr_b16 a[26:27], v193 offset:25344
	buffer_load_dwordx4 v192, s[8:11], s1 offen offset:2048 lds
	ds_write_b128 v6, v[32:35] offset:2048
	v_pk_mul_f32 v[40:41], v[40:41], v[200:201]
	v_pk_mul_f32 v[42:43], v[42:43], v[202:203]
	ds_read_b64_tr_b16 a[28:29], v193 offset:25856
	v_pk_mul_f32 v[44:45], v[44:45], v[204:205]
	v_pk_mul_f32 v[46:47], v[46:47], v[206:207]
	ds_read_b64_tr_b16 a[30:31], v193 offset:26368
	v_cvt_pk_bf16_f32 v40, v40, v41
	v_cvt_pk_bf16_f32 v41, v42, v43
	ds_read_b64_tr_b16 a[32:33], v193 offset:26880
	v_cvt_pk_bf16_f32 v42, v44, v45
	s_add_u32 m0, s68, 60000
	s_add_u32 s1, s64, 466944
	buffer_load_dwordx4 v192, s[8:11], s1 offen offset:0 lds
	v_cvt_pk_bf16_f32 v43, v46, v47
	ds_write_b128 v6, v[40:43] offset:3072
	ds_read_b64_tr_b16 a[34:35], v193 offset:27392
	v_pk_mul_f32 v[48:49], v[48:49], v[200:201]
	v_pk_mul_f32 v[50:51], v[50:51], v[202:203]
	ds_read_b64_tr_b16 a[36:37], v193 offset:37248
	v_pk_mul_f32 v[52:53], v[52:53], v[204:205]
	v_pk_mul_f32 v[54:55], v[54:55], v[206:207]
	v_cvt_pk_bf16_f32 v48, v48, v49
	ds_read_b64_tr_b16 a[38:39], v193 offset:37760
	v_cvt_pk_bf16_f32 v49, v50, v51
	buffer_load_dwordx4 v192, s[8:11], s1 offen offset:1024 lds
	v_cvt_pk_bf16_f32 v50, v52, v53
	ds_read_b64_tr_b16 a[40:41], v193 offset:38272
	v_cvt_pk_bf16_f32 v51, v54, v55
	ds_write_b128 v6, v[48:51] offset:4096
	ds_read_b64_tr_b16 a[42:43], v193 offset:38784
	v_pk_mul_f32 v[16:17], v[16:17], v[200:201]
	v_pk_mul_f32 v[18:19], v[18:19], v[202:203]
	v_pk_mul_f32 v[20:21], v[20:21], v[204:205]
	ds_read_b64_tr_b16 a[44:45], v193 offset:39296
	v_pk_mul_f32 v[22:23], v[22:23], v[206:207]
	v_cvt_pk_bf16_f32 v16, v16, v17
	ds_read_b64_tr_b16 a[46:47], v193 offset:39808
	buffer_load_dwordx4 v192, s[8:11], s1 offen offset:2048 lds
	v_cvt_pk_bf16_f32 v17, v18, v19
	v_cvt_pk_bf16_f32 v18, v20, v21
	v_cvt_pk_bf16_f32 v19, v22, v23
	s_waitcnt lgkmcnt(15)
	v_cndmask_b32 v16, v16, v208, vcc
	v_cndmask_b32 v17, v17, v209, vcc
	v_cndmask_b32 v18, v18, v210, vcc
	v_cndmask_b32 v19, v19, v211, vcc
	ds_write_b128 v6, v[16:19] offset:0
	s_waitcnt lgkmcnt(0)
	s_barrier
	ds_read_b128 v[16:19], v7 offset:0
	ds_read_b128 v[20:23], v7 offset:1024
	ds_read_b128 v[24:27], v7 offset:2048
	ds_read_b128 v[28:31], v7 offset:3072
	ds_read_b128 v[32:35], v7 offset:4096
	s_waitcnt lgkmcnt(4)
	v_mfma_f32_16x16x32_bf16 v[216:219], a[4:7], v[16:19], 0
	ds_read_b128 v[36:39], v8 offset:5120
	v_mul_f32 v64, v64, v176
	v_mul_f32 v65, v65, v177
	v_mfma_f32_16x16x32_bf16 v[188:191], a[0:3], v[16:19], 0
	ds_read_b128 v[40:43], v8 offset:6144
	v_mul_f32 v66, v66, v178
	v_mul_f32 v67, v67, v179
	v_mfma_f32_16x16x32_bf16 v[236:239], v[16:19], a[8:11], 0
	v_mul_f32 v68, v68, v180
	s_add_u32 m0, s68, 0
	s_sub_u32 s1, 786432, s64
	buffer_load_dwordx4 v192, s[8:11], s1 offen offset:0 lds
	s_waitcnt lgkmcnt(5)
	v_mfma_f32_16x16x32_bf16 v[220:223], a[4:7], v[20:23], 0
	ds_read_b128 v[44:47], v8 offset:7168
	v_mul_f32 v69, v69, v181
	v_mul_f32 v70, v70, v182
	v_mfma_f32_16x16x32_bf16 v[200:203], a[0:3], v[20:23], 0
	v_mul_f32 v71, v71, v183
	v_mfma_f32_16x16x32_bf16 v[240:243], v[20:23], a[8:11], 0
	ds_read_b128 v[48:51], v8 offset:8192
	v_cvt_pk_bf16_f32 v64, v64, v65
	v_cvt_pk_bf16_f32 v65, v66, v67
	buffer_load_dwordx4 v192, s[8:11], s1 offen offset:1024 lds
	s_waitcnt lgkmcnt(6)
	v_mfma_f32_16x16x32_bf16 v[224:227], a[4:7], v[24:27], 0
	v_cvt_pk_bf16_f32 v66, v68, v69
	v_mfma_f32_16x16x32_bf16 v[204:207], a[0:3], v[24:27], 0
	ds_read_b128 v[52:55], v8 offset:9216
	v_cvt_pk_bf16_f32 v67, v70, v71
	ds_write_b128 v6, v[64:67] offset:21504
	v_mfma_f32_16x16x32_bf16 v[244:247], v[24:27], a[8:11], 0
	v_mul_f32 v72, v72, v176
	buffer_load_dwordx4 v192, s[8:11], s1 offen offset:2048 lds
	s_waitcnt lgkmcnt(7)
	v_mfma_f32_16x16x32_bf16 v[228:231], a[4:7], v[28:31], 0
	v_mul_f32 v73, v73, v177
	v_mul_f32 v74, v74, v178
	v_mfma_f32_16x16x32_bf16 v[208:211], a[0:3], v[28:31], 0
	v_mul_f32 v75, v75, v179
	v_mfma_f32_16x16x32_bf16 v[248:251], v[28:31], a[8:11], 0
	v_mul_f32 v76, v76, v180
	v_mul_f32 v77, v77, v181
	s_add_u32 m0, s68, 3104
	s_sub_u32 s1, 811008, s64
	buffer_load_dwordx4 v192, s[8:11], s1 offen offset:0 lds
	s_waitcnt lgkmcnt(6)
	v_mfma_f32_16x16x32_bf16 v[232:235], a[4:7], v[32:35], 0
	v_mul_f32 v78, v78, v182
	v_mfma_f32_16x16x32_bf16 v[212:215], a[0:3], v[32:35], 0
	v_mul_f32 v79, v79, v183
	v_cvt_pk_bf16_f32 v72, v72, v73
	v_mfma_f32_16x16x32_bf16 v[252:255], v[32:35], a[8:11], 0
	v_cvt_pk_bf16_f32 v73, v74, v75
	s_waitcnt lgkmcnt(1)
	v_mfma_f32_16x16x32_bf16 v[216:219], a[16:19], v[36:39], v[216:219]
	ds_read_b128 v[16:19], v7 offset:10240
	v_cvt_pk_bf16_f32 v74, v76, v77
	v_cvt_pk_bf16_f32 v75, v78, v79
	v_mfma_f32_16x16x32_bf16 v[188:191], a[12:15], v[36:39], v[188:191]
	ds_read_b128 v[20:23], v7 offset:11264
	ds_write_b128 v6, v[72:75] offset:22528
	v_mul_f32 v80, v80, v176
	v_mfma_f32_16x16x32_bf16 v[236:239], v[36:39], a[20:23], v[236:239]
	v_mul_f32 v81, v81, v177
	buffer_load_dwordx4 v192, s[8:11], s1 offen offset:1024 lds
	v_mfma_f32_16x16x32_bf16 v[220:223], a[16:19], v[40:43], v[220:223]
	ds_read_b128 v[24:27], v7 offset:12288
	v_mul_f32 v82, v82, v178
	v_mul_f32 v83, v83, v179
	v_mfma_f32_16x16x32_bf16 v[200:203], a[12:15], v[40:43], v[200:203]
	v_mul_f32 v84, v84, v180
	v_mfma_f32_16x16x32_bf16 v[240:243], v[40:43], a[20:23], v[240:243]
	ds_read_b128 v[28:31], v7 offset:13312
	v_mul_f32 v85, v85, v181
	v_mul_f32 v86, v86, v182
	buffer_load_dwordx4 v192, s[8:11], s1 offen offset:2048 lds
	v_mfma_f32_16x16x32_bf16 v[224:227], a[16:19], v[44:47], v[224:227]
	v_mul_f32 v87, v87, v183
	v_mfma_f32_16x16x32_bf16 v[204:207], a[12:15], v[44:47], v[204:207]
	ds_read_b128 v[32:35], v7 offset:14336
	v_cvt_pk_bf16_f32 v80, v80, v81
	v_cvt_pk_bf16_f32 v81, v82, v83
	v_mfma_f32_16x16x32_bf16 v[244:247], v[44:47], a[20:23], v[244:247]
	v_cvt_pk_bf16_f32 v82, v84, v85
	s_add_u32 m0, s68, 6208
	s_sub_u32 s1, 835584, s64
	buffer_load_dwordx4 v192, s[8:11], s1 offen offset:0 lds
	v_mfma_f32_16x16x32_bf16 v[228:231], a[16:19], v[48:51], v[228:231]
	v_cvt_pk_bf16_f32 v83, v86, v87
	ds_write_b128 v6, v[80:83] offset:23552
	v_mfma_f32_16x16x32_bf16 v[208:211], a[12:15], v[48:51], v[208:211]
	v_mul_f32 v88, v88, v176
	v_mfma_f32_16x16x32_bf16 v[248:251], v[48:51], a[20:23], v[248:251]
	v_mul_f32 v89, v89, v177
	v_mul_f32 v90, v90, v178
	buffer_load_dwordx4 v192, s[8:11], s1 offen offset:1024 lds
	v_mfma_f32_16x16x32_bf16 v[232:235], a[16:19], v[52:55], v[232:235]
	v_mul_f32 v91, v91, v179
	v_mfma_f32_16x16x32_bf16 v[212:215], a[12:15], v[52:55], v[212:215]
	v_mul_f32 v92, v92, v180
	v_mul_f32 v93, v93, v181
	v_mfma_f32_16x16x32_bf16 v[252:255], v[52:55], a[20:23], v[252:255]
	v_mul_f32 v94, v94, v182
	s_waitcnt lgkmcnt(1)
	s_waitcnt vmcnt(8)
	s_barrier
	v_mfma_f32_16x16x32_bf16 v[216:219], a[28:31], v[16:19], v[216:219]
	ds_read_b128 v[36:39], v8 offset:15360
	v_mul_f32 v95, v95, v183
	v_cvt_pk_bf16_f32 v88, v88, v89
	v_mfma_f32_16x16x32_bf16 v[188:191], a[24:27], v[16:19], v[188:191]
	ds_read_b128 v[40:43], v8 offset:16384
	v_cvt_pk_bf16_f32 v89, v90, v91
	v_cvt_pk_bf16_f32 v90, v92, v93
	ds_read_b64_tr_b16 a[48:49], v195 offset:0
	ds_read_b64_tr_b16 a[50:51], v195 offset:512
	v_mfma_f32_16x16x32_bf16 v[236:239], v[16:19], a[32:35], v[236:239]
	v_cvt_pk_bf16_f32 v91, v94, v95
	ds_read_b64_tr_b16 a[52:53], v195 offset:1024
	buffer_load_dwordx4 v192, s[8:11], s1 offen offset:2048 lds
	v_mfma_f32_16x16x32_bf16 v[220:223], a[28:31], v[20:23], v[220:223]
	ds_read_b128 v[44:47], v8 offset:17408
	ds_write_b128 v6, v[88:91] offset:24576
	v_mul_f32 v56, v56, v176
	ds_read_b64_tr_b16 a[54:55], v195 offset:1536
	v_mfma_f32_16x16x32_bf16 v[200:203], a[24:27], v[20:23], v[200:203]
	v_mul_f32 v57, v57, v177
	ds_read_b64_tr_b16 a[56:57], v195 offset:2048
	v_mfma_f32_16x16x32_bf16 v[240:243], v[20:23], a[32:35], v[240:243]
	ds_read_b128 v[48:51], v8 offset:18432
	v_mul_f32 v58, v58, v178
	v_mul_f32 v59, v59, v179
	ds_read_b64_tr_b16 a[58:59], v195 offset:2560
	s_add_u32 m0, s68, 9312
	s_sub_u32 s1, 860160, s64
	buffer_load_dwordx4 v192, s[8:11], s1 offen offset:0 lds
	v_mfma_f32_16x16x32_bf16 v[224:227], a[28:31], v[24:27], v[224:227]
	v_mul_f32 v60, v60, v180
	ds_read_b64_tr_b16 a[60:61], v195 offset:12416
	v_mfma_f32_16x16x32_bf16 v[204:207], a[24:27], v[24:27], v[204:207]
	ds_read_b128 v[52:55], v8 offset:19456
	v_mul_f32 v61, v61, v181
	v_mul_f32 v62, v62, v182
	ds_read_b64_tr_b16 a[62:63], v195 offset:12928
	v_mfma_f32_16x16x32_bf16 v[244:247], v[24:27], a[32:35], v[244:247]
	v_mul_f32 v63, v63, v183
	ds_read_b64_tr_b16 a[64:65], v195 offset:13440
	buffer_load_dwordx4 v192, s[8:11], s1 offen offset:1024 lds
	v_mfma_f32_16x16x32_bf16 v[228:231], a[28:31], v[28:31], v[228:231]
	v_cvt_pk_bf16_f32 v56, v56, v57
	v_cvt_pk_bf16_f32 v57, v58, v59
	ds_read_b64_tr_b16 a[66:67], v195 offset:13952
	v_mfma_f32_16x16x32_bf16 v[208:211], a[24:27], v[28:31], v[208:211]
	v_cvt_pk_bf16_f32 v58, v60, v61
	ds_read_b64_tr_b16 a[68:69], v195 offset:14464
	v_mfma_f32_16x16x32_bf16 v[248:251], v[28:31], a[32:35], v[248:251]
	v_cvt_pk_bf16_f32 v59, v62, v63
	v_cndmask_b32 v56, v56, v184, vcc
	ds_read_b64_tr_b16 a[70:71], v195 offset:14976
	buffer_load_dwordx4 v192, s[8:11], s1 offen offset:2048 lds
	v_mfma_f32_16x16x32_bf16 v[232:235], a[28:31], v[32:35], v[232:235]
	v_cndmask_b32 v57, v57, v185, vcc
	ds_read_b64_tr_b16 a[72:73], v195 offset:24832
	v_mfma_f32_16x16x32_bf16 v[212:215], a[24:27], v[32:35], v[212:215]
	v_cndmask_b32 v58, v58, v186, vcc
	v_cndmask_b32 v59, v59, v187, vcc
	ds_read_b64_tr_b16 a[74:75], v195 offset:25344
	v_mfma_f32_16x16x32_bf16 v[252:255], v[32:35], a[32:35], v[252:255]
	ds_write_b128 v6, v[56:59] offset:20480
	ds_read_b64_tr_b16 a[76:77], v195 offset:25856
	s_waitcnt lgkmcnt(9)
	v_mfma_f32_16x16x32_bf16 v[216:219], a[40:43], v[36:39], v[216:219]
	ds_read_b64_tr_b16 a[78:79], v195 offset:26368
	ds_read_b64_tr_b16 a[80:81], v195 offset:26880
	v_mfma_f32_16x16x32_bf16 v[188:191], a[36:39], v[36:39], v[188:191]
	ds_read_b64_tr_b16 a[82:83], v195 offset:27392
	v_mfma_f32_16x16x32_bf16 v[236:239], v[36:39], a[44:47], v[236:239]
	ds_read_b64_tr_b16 a[84:85], v195 offset:37248
	v_mfma_f32_16x16x32_bf16 v[220:223], a[40:43], v[40:43], v[220:223]
	ds_read_b64_tr_b16 a[86:87], v195 offset:37760
	ds_read_b64_tr_b16 a[88:89], v195 offset:38272
	v_mfma_f32_16x16x32_bf16 v[200:203], a[36:39], v[40:43], v[200:203]
	ds_read_b64_tr_b16 a[90:91], v195 offset:38784
	v_mfma_f32_16x16x32_bf16 v[240:243], v[40:43], a[44:47], v[240:243]
	ds_read_b64_tr_b16 a[92:93], v195 offset:39296
	v_mfma_f32_16x16x32_bf16 v[224:227], a[40:43], v[44:47], v[224:227]
	ds_read_b64_tr_b16 a[94:95], v195 offset:39808
	v_mfma_f32_16x16x32_bf16 v[204:207], a[36:39], v[44:47], v[204:207]
	s_waitcnt lgkmcnt(0)
	s_barrier
	v_mfma_f32_16x16x32_bf16 v[244:247], v[44:47], a[44:47], v[244:247]
	ds_read_b128 v[16:19], v7 offset:20480
	ds_read_b128 v[20:23], v7 offset:21504
	s_add_u32 m0, s68, 50688
	v_mfma_f32_16x16x32_bf16 v[228:231], a[40:43], v[48:51], v[228:231]
	ds_read_b128 v[24:27], v7 offset:22528
	ds_read_b128 v[28:31], v7 offset:23552
	v_mfma_f32_16x16x32_bf16 v[208:211], a[36:39], v[48:51], v[208:211]
	ds_read_b128 v[32:35], v7 offset:24576
	s_sub_u32 s1, 1179648, s64
	v_mfma_f32_16x16x32_bf16 v[248:251], v[48:51], a[44:47], v[248:251]
	v_xor_b32 v9, 1024, v9
	v_xor_b32 v14, 512, v14
	v_mfma_f32_16x16x32_bf16 v[232:235], a[40:43], v[52:55], v[232:235]
	ds_read_b128 v[176:179], v9 offset:2048
	ds_read_b128 v[180:183], v9 offset:2064
	buffer_load_dwordx4 v192, s[8:11], s1 offen offset:0 lds
	v_mfma_f32_16x16x32_bf16 v[212:215], a[36:39], v[52:55], v[212:215]
	ds_read_b128 v[184:187], v14 offset:0
	v_mfma_f32_16x16x32_bf16 v[252:255], v[52:55], a[44:47], v[252:255]
	s_waitcnt lgkmcnt(7)
	v_mfma_f32_16x16x32_bf16 v[216:219], a[52:55], v[16:19], v[216:219]
	ds_read_b128 v[36:39], v8 offset:25600
	s_waitcnt lgkmcnt(3)
	v_mul_f32 v104, v104, v176
	v_mul_f32 v105, v105, v177
	v_mfma_f32_16x16x32_bf16 v[188:191], a[48:51], v[16:19], v[188:191]
	ds_read_b128 v[40:43], v8 offset:26624
	v_mul_f32 v106, v106, v178
	v_mul_f32 v107, v107, v179
	ds_read_b128 v[56:59], v9 offset:2560
	v_mfma_f32_16x16x32_bf16 v[236:239], v[16:19], a[56:59], v[236:239]
	s_waitcnt lgkmcnt(4)
	v_mul_f32 v108, v108, v180
	buffer_load_dwordx4 v192, s[8:11], s1 offen offset:1024 lds
	v_mfma_f32_16x16x32_bf16 v[220:223], a[52:55], v[20:23], v[220:223]
	ds_read_b128 v[44:47], v8 offset:27648
	v_mul_f32 v109, v109, v181
	v_mul_f32 v110, v110, v182
	v_mfma_f32_16x16x32_bf16 v[200:203], a[48:51], v[20:23], v[200:203]
	v_mul_f32 v111, v111, v183
	buffer_load_dwordx4 v192, s[8:11], s1 offen offset:2048 lds
	v_mfma_f32_16x16x32_bf16 v[240:243], v[20:23], a[56:59], v[240:243]
	ds_read_b128 v[48:51], v8 offset:28672
	v_cvt_pk_bf16_f32 v104, v104, v105
	v_cvt_pk_bf16_f32 v105, v106, v107
	ds_read_b128 v[60:63], v9 offset:2576
	v_mfma_f32_16x16x32_bf16 v[224:227], a[52:55], v[24:27], v[224:227]
	v_cvt_pk_bf16_f32 v106, v108, v109
	v_mfma_f32_16x16x32_bf16 v[204:207], a[48:51], v[24:27], v[204:207]
	ds_read_b128 v[52:55], v8 offset:29696
	v_cvt_pk_bf16_f32 v107, v110, v111
	ds_write_b128 v6, v[104:107] offset:1024
	s_add_u32 m0, s68, 53792
	s_sub_u32 s1, 1204224, s64
	buffer_load_dwordx4 v192, s[8:11], s1 offen offset:0 lds
	v_mfma_f32_16x16x32_bf16 v[244:247], v[24:27], a[56:59], v[244:247]
	v_mul_f32 v112, v112, v176
	v_mfma_f32_16x16x32_bf16 v[228:231], a[52:55], v[28:31], v[228:231]
	v_mul_f32 v113, v113, v177
	v_mul_f32 v114, v114, v178
	buffer_load_dwordx4 v192, s[8:11], s1 offen offset:1024 lds
	v_mfma_f32_16x16x32_bf16 v[208:211], a[48:51], v[28:31], v[208:211]
	v_mul_f32 v115, v115, v179
	ds_read_b128 v[64:67], v14 offset:256
	v_mfma_f32_16x16x32_bf16 v[248:251], v[28:31], a[56:59], v[248:251]
	v_mul_f32 v116, v116, v180
	v_mul_f32 v117, v117, v181
	v_mfma_f32_16x16x32_bf16 v[232:235], a[52:55], v[32:35], v[232:235]
	v_mul_f32 v118, v118, v182
	buffer_load_dwordx4 v192, s[8:11], s1 offen offset:2048 lds
	v_mfma_f32_16x16x32_bf16 v[212:215], a[48:51], v[32:35], v[212:215]
	v_mul_f32 v119, v119, v183
	v_cvt_pk_bf16_f32 v112, v112, v113
	v_mfma_f32_16x16x32_bf16 v[252:255], v[32:35], a[56:59], v[252:255]
	v_cvt_pk_bf16_f32 v113, v114, v115
	s_waitcnt lgkmcnt(2)
	v_mfma_f32_16x16x32_bf16 v[216:219], a[64:67], v[36:39], v[216:219]
	ds_read_b128 v[16:19], v7 offset:30720
	v_cvt_pk_bf16_f32 v114, v116, v117
	v_cvt_pk_bf16_f32 v115, v118, v119
	v_mfma_f32_16x16x32_bf16 v[188:191], a[60:63], v[36:39], v[188:191]
	ds_read_b128 v[20:23], v7 offset:31744
	ds_write_b128 v6, v[112:115] offset:2048
	v_mul_f32 v120, v120, v176
	v_mfma_f32_16x16x32_bf16 v[236:239], v[36:39], a[68:71], v[236:239]
	v_mul_f32 v121, v121, v177
	s_add_u32 m0, s68, 56896
	s_sub_u32 s1, 1228800, s64
	buffer_load_dwordx4 v192, s[8:11], s1 offen offset:0 lds
	v_mfma_f32_16x16x32_bf16 v[220:223], a[64:67], v[40:43], v[220:223]
	ds_read_b128 v[24:27], v7 offset:32768
	v_mul_f32 v122, v122, v178
	v_mul_f32 v123, v123, v179
	v_mfma_f32_16x16x32_bf16 v[200:203], a[60:63], v[40:43], v[200:203]
	v_mul_f32 v124, v124, v180
	buffer_load_dwordx4 v192, s[8:11], s1 offen offset:1024 lds
	v_mfma_f32_16x16x32_bf16 v[240:243], v[40:43], a[68:71], v[240:243]
	ds_read_b128 v[28:31], v7 offset:33792
	v_mul_f32 v125, v125, v181
	v_mul_f32 v126, v126, v182
	v_mfma_f32_16x16x32_bf16 v[224:227], a[64:67], v[44:47], v[224:227]
	v_mul_f32 v127, v127, v183
	buffer_load_dwordx4 v192, s[8:11], s1 offen offset:2048 lds
	v_mfma_f32_16x16x32_bf16 v[204:207], a[60:63], v[44:47], v[204:207]
	ds_read_b128 v[32:35], v7 offset:34816
	v_cvt_pk_bf16_f32 v120, v120, v121
	v_cvt_pk_bf16_f32 v121, v122, v123
	v_mfma_f32_16x16x32_bf16 v[244:247], v[44:47], a[68:71], v[244:247]
	v_cvt_pk_bf16_f32 v122, v124, v125
	s_add_u32 m0, s68, 60000
	s_sub_u32 s1, 1253376, s64
	buffer_load_dwordx4 v192, s[8:11], s1 offen offset:0 lds
	v_mfma_f32_16x16x32_bf16 v[228:231], a[64:67], v[48:51], v[228:231]
	v_cvt_pk_bf16_f32 v123, v126, v127
	ds_write_b128 v6, v[120:123] offset:3072
	v_mfma_f32_16x16x32_bf16 v[208:211], a[60:63], v[48:51], v[208:211]
	v_mul_f32 v128, v128, v176
	buffer_load_dwordx4 v192, s[8:11], s1 offen offset:1024 lds
	v_mfma_f32_16x16x32_bf16 v[248:251], v[48:51], a[68:71], v[248:251]
	v_mul_f32 v129, v129, v177
	v_mul_f32 v130, v130, v178
	v_mfma_f32_16x16x32_bf16 v[232:235], a[64:67], v[52:55], v[232:235]
	v_mul_f32 v131, v131, v179
	buffer_load_dwordx4 v192, s[8:11], s1 offen offset:2048 lds
	v_mfma_f32_16x16x32_bf16 v[212:215], a[60:63], v[52:55], v[212:215]
	v_mul_f32 v132, v132, v180
	v_mul_f32 v133, v133, v181
	v_mfma_f32_16x16x32_bf16 v[252:255], v[52:55], a[68:71], v[252:255]
	v_mul_f32 v134, v134, v182
	s_waitcnt lgkmcnt(1)
	s_waitcnt vmcnt(12)
	s_barrier
	v_mfma_f32_16x16x32_bf16 v[216:219], a[76:79], v[16:19], v[216:219]
	ds_read_b128 v[36:39], v8 offset:35840
	v_mul_f32 v135, v135, v183
	v_cvt_pk_bf16_f32 v128, v128, v129
	v_mfma_f32_16x16x32_bf16 v[188:191], a[72:75], v[16:19], v[188:191]
	ds_read_b128 v[40:43], v8 offset:36864
	v_cvt_pk_bf16_f32 v129, v130, v131
	v_cvt_pk_bf16_f32 v130, v132, v133
	ds_read_b64_tr_b16 a[96:97], v193 offset:0
	ds_read_b64_tr_b16 a[98:99], v193 offset:512
	v_mfma_f32_16x16x32_bf16 v[236:239], v[16:19], a[80:83], v[236:239]
	v_cvt_pk_bf16_f32 v131, v134, v135
	ds_read_b64_tr_b16 a[100:101], v193 offset:1024
	buffer_load_dwordx2 a[216:217], v4, s[4:7], s66 offen offset:0
	v_mfma_f32_16x16x32_bf16 v[220:223], a[76:79], v[20:23], v[220:223]
	ds_read_b128 v[44:47], v8 offset:37888
	ds_write_b128 v6, v[128:131] offset:4096
	v_mul_f32 v96, v96, v176
	ds_read_b64_tr_b16 a[102:103], v193 offset:1536
	v_mfma_f32_16x16x32_bf16 v[200:203], a[72:75], v[20:23], v[200:203]
	v_mul_f32 v97, v97, v177
	ds_read_b64_tr_b16 a[104:105], v193 offset:2048
	v_mfma_f32_16x16x32_bf16 v[240:243], v[20:23], a[80:83], v[240:243]
	ds_read_b128 v[48:51], v8 offset:38912
	v_mul_f32 v98, v98, v178
	v_mul_f32 v99, v99, v179
	ds_read_b64_tr_b16 a[106:107], v193 offset:2560
	buffer_load_dwordx2 a[218:219], v4, s[4:7], s66 offen offset:32
	v_mfma_f32_16x16x32_bf16 v[224:227], a[76:79], v[24:27], v[224:227]
	v_mul_f32 v100, v100, v180
	ds_read_b64_tr_b16 a[108:109], v193 offset:12416
	v_mfma_f32_16x16x32_bf16 v[204:207], a[72:75], v[24:27], v[204:207]
	ds_read_b128 v[52:55], v8 offset:39936
	v_mul_f32 v101, v101, v181
	v_mul_f32 v102, v102, v182
	ds_read_b64_tr_b16 a[110:111], v193 offset:12928
	v_mfma_f32_16x16x32_bf16 v[244:247], v[24:27], a[80:83], v[244:247]
	v_mul_f32 v103, v103, v183
	ds_read_b64_tr_b16 a[112:113], v193 offset:13440
	buffer_load_dwordx2 a[220:221], v4, s[4:7], s66 offen offset:64
	v_mfma_f32_16x16x32_bf16 v[228:231], a[76:79], v[28:31], v[228:231]
	v_cvt_pk_bf16_f32 v96, v96, v97
	v_cvt_pk_bf16_f32 v97, v98, v99
	ds_read_b64_tr_b16 a[114:115], v193 offset:13952
	v_mfma_f32_16x16x32_bf16 v[208:211], a[72:75], v[28:31], v[208:211]
	v_cvt_pk_bf16_f32 v98, v100, v101
	ds_read_b64_tr_b16 a[116:117], v193 offset:14464
	v_mfma_f32_16x16x32_bf16 v[248:251], v[28:31], a[80:83], v[248:251]
	v_cvt_pk_bf16_f32 v99, v102, v103
	v_cndmask_b32 v96, v96, v184, vcc
	ds_read_b64_tr_b16 a[118:119], v193 offset:14976
	buffer_load_dwordx2 a[222:223], v4, s[4:7], s66 offen offset:96
	v_mfma_f32_16x16x32_bf16 v[232:235], a[76:79], v[32:35], v[232:235]
	v_cndmask_b32 v97, v97, v185, vcc
	ds_read_b64_tr_b16 a[120:121], v193 offset:24832
	v_mfma_f32_16x16x32_bf16 v[212:215], a[72:75], v[32:35], v[212:215]
	v_cndmask_b32 v98, v98, v186, vcc
	v_cndmask_b32 v99, v99, v187, vcc
	ds_read_b64_tr_b16 a[122:123], v193 offset:25344
	v_mfma_f32_16x16x32_bf16 v[252:255], v[32:35], a[80:83], v[252:255]
	ds_write_b128 v6, v[96:99] offset:0
	ds_read_b64_tr_b16 a[124:125], v193 offset:25856
	s_waitcnt lgkmcnt(9)
	v_mfma_f32_16x16x32_bf16 v[216:219], a[88:91], v[36:39], v[216:219]
	ds_read_b64_tr_b16 a[126:127], v193 offset:26368
	ds_read_b64_tr_b16 a[128:129], v193 offset:26880
	v_accvgpr_read_b32 v11, a231
	buffer_load_dword v15, v11, s[44:47], 0 offen sc1
	v_mfma_f32_16x16x32_bf16 v[188:191], a[84:87], v[36:39], v[188:191]
	ds_read_b64_tr_b16 a[130:131], v193 offset:27392
	v_accvgpr_read_b32 v10, a232
	v_accvgpr_read_b32 v11, a233
	buffer_load_dword v15, v11, s[12:15], 0 offen
	v_mfma_f32_16x16x32_bf16 v[236:239], v[36:39], a[92:95], v[236:239]
	ds_read_b64_tr_b16 a[132:133], v193 offset:37248
	buffer_load_dword v15, v10, s[16:19], 0 offen
	v_mfma_f32_16x16x32_bf16 v[220:223], a[88:91], v[40:43], v[220:223]
	ds_read_b64_tr_b16 a[134:135], v193 offset:37760
	ds_read_b64_tr_b16 a[136:137], v193 offset:38272
	buffer_load_dword v15, v10, s[24:27], 0 offen
	v_mfma_f32_16x16x32_bf16 v[200:203], a[84:87], v[40:43], v[200:203]
	ds_read_b64_tr_b16 a[138:139], v193 offset:38784
	buffer_load_dwordx2 a[224:225], v13, s[28:31], s66 offen
	v_mfma_f32_16x16x32_bf16 v[240:243], v[40:43], a[92:95], v[240:243]
	ds_read_b64_tr_b16 a[140:141], v193 offset:39296
	buffer_load_dwordx2 a[226:227], v13, s[28:31], s66 offen offset:16
	v_mfma_f32_16x16x32_bf16 v[224:227], a[88:91], v[44:47], v[224:227]
	ds_read_b64_tr_b16 a[142:143], v193 offset:39808
	buffer_load_ushort a228, v199, s[20:23], 0 offen
	v_mfma_f32_16x16x32_bf16 v[204:207], a[84:87], v[44:47], v[204:207]
	s_waitcnt lgkmcnt(0)
	s_barrier
	v_mfma_f32_16x16x32_bf16 v[244:247], v[44:47], a[92:95], v[244:247]
	ds_read_b128 v[16:19], v7 offset:0
	v_mfma_f32_16x16x32_bf16 v[228:231], a[88:91], v[48:51], v[228:231]
	ds_read_b128 v[20:23], v7 offset:1024
	v_mfma_f32_16x16x32_bf16 v[208:211], a[84:87], v[48:51], v[208:211]
	ds_read_b128 v[24:27], v7 offset:2048
	v_mfma_f32_16x16x32_bf16 v[248:251], v[48:51], a[92:95], v[248:251]
	ds_read_b128 v[28:31], v7 offset:3072
	v_mfma_f32_16x16x32_bf16 v[232:235], a[88:91], v[52:55], v[232:235]
	ds_read_b128 v[32:35], v7 offset:4096
	v_mfma_f32_16x16x32_bf16 v[212:215], a[84:87], v[52:55], v[212:215]
	v_mfma_f32_16x16x32_bf16 v[252:255], v[52:55], a[92:95], v[252:255]
	s_waitcnt lgkmcnt(4)
	v_mfma_f32_16x16x32_bf16 v[216:219], a[100:103], v[16:19], v[216:219]
	ds_read_b128 v[36:39], v8 offset:5120
	v_mul_f32 v144, v144, v56
	v_mul_f32 v145, v145, v57
	v_mfma_f32_16x16x32_bf16 v[188:191], a[96:99], v[16:19], v[188:191]
	ds_read_b128 v[40:43], v8 offset:6144
	v_mul_f32 v146, v146, v58
	v_mul_f32 v147, v147, v59
	s_cmp_ge_u32 s49, 28
	s_cselect_b32 s18, 0, s18
	s_mov_b32 s65, 12288
	v_mfma_f32_16x16x32_bf16 v[236:239], v[16:19], a[104:107], v[236:239]
	v_mul_f32 v148, v148, v60
	s_add_u32 m0, s63, 0
	s_mov_b32 s1, 0
	buffer_load_dwordx4 v196, s[12:15], s1 offen lds
	s_waitcnt lgkmcnt(5)
	v_mfma_f32_16x16x32_bf16 v[220:223], a[100:103], v[20:23], v[220:223]
	ds_read_b128 v[44:47], v8 offset:7168
	v_mul_f32 v149, v149, v61
	v_mul_f32 v150, v150, v62
	v_mfma_f32_16x16x32_bf16 v[200:203], a[96:99], v[20:23], v[200:203]
	v_mul_f32 v151, v151, v63
	v_mfma_f32_16x16x32_bf16 v[240:243], v[20:23], a[104:107], v[240:243]
	ds_read_b128 v[48:51], v8 offset:8192
	v_cvt_pk_bf16_f32 v144, v144, v145
	v_cvt_pk_bf16_f32 v145, v146, v147
	s_waitcnt lgkmcnt(6)
	v_mfma_f32_16x16x32_bf16 v[224:227], a[100:103], v[24:27], v[224:227]
	v_cvt_pk_bf16_f32 v146, v148, v149
	buffer_load_dwordx4 v194, s[12:15], s1 offen offset:1056 lds
	v_mfma_f32_16x16x32_bf16 v[204:207], a[96:99], v[24:27], v[204:207]
	ds_read_b128 v[52:55], v8 offset:9216
	v_cvt_pk_bf16_f32 v147, v150, v151
	ds_write_b128 v6, v[144:147] offset:21504
	v_mfma_f32_16x16x32_bf16 v[244:247], v[24:27], a[104:107], v[244:247]
	v_mul_f32 v152, v152, v56
	s_waitcnt lgkmcnt(7)
	v_mfma_f32_16x16x32_bf16 v[228:231], a[100:103], v[28:31], v[228:231]
	v_mul_f32 v153, v153, v57
	v_mul_f32 v154, v154, v58
	v_mfma_f32_16x16x32_bf16 v[208:211], a[96:99], v[28:31], v[208:211]
	v_mul_f32 v155, v155, v59
	s_add_u32 m0, s63, 8448
	s_mov_b32 s1, 65536
	buffer_load_dwordx4 v196, s[12:15], s1 offen lds
	v_mfma_f32_16x16x32_bf16 v[248:251], v[28:31], a[104:107], v[248:251]
	v_mul_f32 v156, v156, v60
	v_mul_f32 v157, v157, v61
	s_waitcnt lgkmcnt(6)
	v_mfma_f32_16x16x32_bf16 v[232:235], a[100:103], v[32:35], v[232:235]
	v_mul_f32 v158, v158, v62
	v_mfma_f32_16x16x32_bf16 v[212:215], a[96:99], v[32:35], v[212:215]
	v_mul_f32 v159, v159, v63
	v_cvt_pk_bf16_f32 v152, v152, v153
	v_mfma_f32_16x16x32_bf16 v[252:255], v[32:35], a[104:107], v[252:255]
	v_cvt_pk_bf16_f32 v153, v154, v155
	s_waitcnt lgkmcnt(1)
	v_mfma_f32_16x16x32_bf16 v[216:219], a[112:115], v[36:39], v[216:219]
	ds_read_b128 v[16:19], v7 offset:10240
	v_cvt_pk_bf16_f32 v154, v156, v157
	v_cvt_pk_bf16_f32 v155, v158, v159
	v_mfma_f32_16x16x32_bf16 v[188:191], a[108:111], v[36:39], v[188:191]
	ds_read_b128 v[20:23], v7 offset:11264
	ds_write_b128 v6, v[152:155] offset:22528
	v_mul_f32 v160, v160, v56
	v_mfma_f32_16x16x32_bf16 v[236:239], v[36:39], a[116:119], v[236:239]
	v_mul_f32 v161, v161, v57
	buffer_load_dwordx4 v194, s[12:15], s1 offen offset:1056 lds
	v_mfma_f32_16x16x32_bf16 v[220:223], a[112:115], v[40:43], v[220:223]
	ds_read_b128 v[24:27], v7 offset:12288
	v_mul_f32 v162, v162, v58
	v_mul_f32 v163, v163, v59
	v_mfma_f32_16x16x32_bf16 v[200:203], a[108:111], v[40:43], v[200:203]
	v_mul_f32 v164, v164, v60
	v_mfma_f32_16x16x32_bf16 v[240:243], v[40:43], a[116:119], v[240:243]
	ds_read_b128 v[28:31], v7 offset:13312
	v_mul_f32 v165, v165, v61
	v_mul_f32 v166, v166, v62
	v_mfma_f32_16x16x32_bf16 v[224:227], a[112:115], v[44:47], v[224:227]
	v_mul_f32 v167, v167, v63
	s_add_u32 m0, s63, 16896
	s_mov_b32 s1, 131072
	buffer_load_dwordx4 v196, s[12:15], s1 offen lds
	v_mfma_f32_16x16x32_bf16 v[204:207], a[108:111], v[44:47], v[204:207]
	ds_read_b128 v[32:35], v7 offset:14336
	v_cvt_pk_bf16_f32 v160, v160, v161
	v_cvt_pk_bf16_f32 v161, v162, v163
	v_mfma_f32_16x16x32_bf16 v[244:247], v[44:47], a[116:119], v[244:247]
	v_cvt_pk_bf16_f32 v162, v164, v165
	v_mfma_f32_16x16x32_bf16 v[228:231], a[112:115], v[48:51], v[228:231]
	v_cvt_pk_bf16_f32 v163, v166, v167
	ds_write_b128 v6, v[160:163] offset:23552
	v_mfma_f32_16x16x32_bf16 v[208:211], a[108:111], v[48:51], v[208:211]
	v_mul_f32 v168, v168, v56
	buffer_load_dwordx4 v194, s[12:15], s1 offen offset:1056 lds
	v_mfma_f32_16x16x32_bf16 v[248:251], v[48:51], a[116:119], v[248:251]
	v_mul_f32 v169, v169, v57
	v_mul_f32 v170, v170, v58
	v_mfma_f32_16x16x32_bf16 v[232:235], a[112:115], v[52:55], v[232:235]
	v_mul_f32 v171, v171, v59
	v_mfma_f32_16x16x32_bf16 v[212:215], a[108:111], v[52:55], v[212:215]
	v_mul_f32 v172, v172, v60
	v_mul_f32 v173, v173, v61
	v_mfma_f32_16x16x32_bf16 v[252:255], v[52:55], a[116:119], v[252:255]
	v_mul_f32 v174, v174, v62
	s_waitcnt lgkmcnt(1)
	s_waitcnt vmcnt(17)
	s_barrier
	v_mfma_f32_16x16x32_bf16 v[216:219], a[124:127], v[16:19], v[216:219]
	ds_read_b128 v[36:39], v8 offset:15360
	v_mul_f32 v175, v175, v63
	v_cvt_pk_bf16_f32 v168, v168, v169
	v_mfma_f32_16x16x32_bf16 v[188:191], a[120:123], v[16:19], v[188:191]
	ds_read_b128 v[40:43], v8 offset:16384
	v_cvt_pk_bf16_f32 v169, v170, v171
	v_cvt_pk_bf16_f32 v170, v172, v173
	ds_read_b64_tr_b16 a[144:145], v195 offset:0
	ds_read_b64_tr_b16 a[146:147], v195 offset:512
	v_mfma_f32_16x16x32_bf16 v[236:239], v[16:19], a[128:131], v[236:239]
	v_cvt_pk_bf16_f32 v171, v174, v175
	ds_read_b64_tr_b16 a[148:149], v195 offset:1024
	s_add_u32 m0, s63, 25344
	s_mov_b32 s1, 196608
	buffer_load_dwordx4 v196, s[12:15], s1 offen lds
	v_mfma_f32_16x16x32_bf16 v[220:223], a[124:127], v[20:23], v[220:223]
	ds_read_b128 v[44:47], v8 offset:17408
	ds_write_b128 v6, v[168:171] offset:24576
	v_mul_f32 v136, v136, v56
	ds_read_b64_tr_b16 a[150:151], v195 offset:1536
	v_mfma_f32_16x16x32_bf16 v[200:203], a[120:123], v[20:23], v[200:203]
	v_mul_f32 v137, v137, v57
	ds_read_b64_tr_b16 a[152:153], v195 offset:2048
	buffer_load_dwordx4 v194, s[12:15], s1 offen offset:1056 lds
	v_mfma_f32_16x16x32_bf16 v[240:243], v[20:23], a[128:131], v[240:243]
	ds_read_b128 v[48:51], v8 offset:18432
	v_mul_f32 v138, v138, v58
	v_mul_f32 v139, v139, v59
	ds_read_b64_tr_b16 a[154:155], v195 offset:2560
	v_mfma_f32_16x16x32_bf16 v[224:227], a[124:127], v[24:27], v[224:227]
	v_mul_f32 v140, v140, v60
	ds_read_b64_tr_b16 a[156:157], v195 offset:12416
	v_mfma_f32_16x16x32_bf16 v[204:207], a[120:123], v[24:27], v[204:207]
	ds_read_b128 v[52:55], v8 offset:19456
	v_mul_f32 v141, v141, v61
	v_mul_f32 v142, v142, v62
	ds_read_b64_tr_b16 a[158:159], v195 offset:12928
	s_add_u32 m0, s63, 33792
	s_mov_b32 s1, 262144
	buffer_load_dwordx4 v196, s[12:15], s1 offen lds
	v_mfma_f32_16x16x32_bf16 v[244:247], v[24:27], a[128:131], v[244:247]
	v_mul_f32 v143, v143, v63
	ds_read_b64_tr_b16 a[160:161], v195 offset:13440
	v_mfma_f32_16x16x32_bf16 v[228:231], a[124:127], v[28:31], v[228:231]
	v_cvt_pk_bf16_f32 v136, v136, v137
	v_cvt_pk_bf16_f32 v137, v138, v139
	ds_read_b64_tr_b16 a[162:163], v195 offset:13952
	buffer_load_dwordx4 v194, s[12:15], s1 offen offset:1056 lds
	v_mfma_f32_16x16x32_bf16 v[208:211], a[120:123], v[28:31], v[208:211]
	v_cvt_pk_bf16_f32 v138, v140, v141
	ds_read_b64_tr_b16 a[164:165], v195 offset:14464
	v_mfma_f32_16x16x32_bf16 v[248:251], v[28:31], a[128:131], v[248:251]
	v_cvt_pk_bf16_f32 v139, v142, v143
	v_cndmask_b32 v136, v136, v64, vcc
	ds_read_b64_tr_b16 a[166:167], v195 offset:14976
	v_mfma_f32_16x16x32_bf16 v[232:235], a[124:127], v[32:35], v[232:235]
	v_cndmask_b32 v137, v137, v65, vcc
	ds_read_b64_tr_b16 a[168:169], v195 offset:24832
	buffer_load_dwordx2 v[12:13], v197, s[44:47], 0 offen sc1
	v_mfma_f32_16x16x32_bf16 v[212:215], a[120:123], v[32:35], v[212:215]
	v_cndmask_b32 v138, v138, v66, vcc
	v_cndmask_b32 v139, v139, v67, vcc
	ds_read_b64_tr_b16 a[170:171], v195 offset:25344
	v_mfma_f32_16x16x32_bf16 v[252:255], v[32:35], a[128:131], v[252:255]
	ds_write_b128 v6, v[136:139] offset:20480
	ds_read_b64_tr_b16 a[172:173], v195 offset:25856
	s_waitcnt lgkmcnt(9)
	v_mfma_f32_16x16x32_bf16 v[216:219], a[136:139], v[36:39], v[216:219]
	ds_read_b64_tr_b16 a[174:175], v195 offset:26368
	ds_read_b64_tr_b16 a[176:177], v195 offset:26880
	s_add_u32 m0, s63, 42240
	s_mov_b32 s1, 327680
	buffer_load_dwordx4 v196, s[12:15], s1 offen lds
	v_mfma_f32_16x16x32_bf16 v[188:191], a[132:135], v[36:39], v[188:191]
	ds_read_b64_tr_b16 a[178:179], v195 offset:27392
	v_mfma_f32_16x16x32_bf16 v[236:239], v[36:39], a[140:143], v[236:239]
	ds_read_b64_tr_b16 a[180:181], v195 offset:37248
	v_mfma_f32_16x16x32_bf16 v[220:223], a[136:139], v[40:43], v[220:223]
	ds_read_b64_tr_b16 a[182:183], v195 offset:37760
	ds_read_b64_tr_b16 a[184:185], v195 offset:38272
	v_mfma_f32_16x16x32_bf16 v[200:203], a[132:135], v[40:43], v[200:203]
	ds_read_b64_tr_b16 a[186:187], v195 offset:38784
	buffer_load_dwordx4 v194, s[12:15], s1 offen offset:1056 lds
	v_mfma_f32_16x16x32_bf16 v[240:243], v[40:43], a[140:143], v[240:243]
	ds_read_b64_tr_b16 a[188:189], v195 offset:39296
	v_mfma_f32_16x16x32_bf16 v[224:227], a[136:139], v[44:47], v[224:227]
	ds_read_b64_tr_b16 a[190:191], v195 offset:39808
	v_mfma_f32_16x16x32_bf16 v[204:207], a[132:135], v[44:47], v[204:207]
	s_waitcnt lgkmcnt(0)
	s_barrier
	v_mfma_f32_16x16x32_bf16 v[244:247], v[44:47], a[140:143], v[244:247]
	ds_read_b128 v[16:19], v7 offset:20480
	v_mfma_f32_16x16x32_bf16 v[228:231], a[136:139], v[48:51], v[228:231]
	ds_read_b128 v[20:23], v7 offset:21504
	v_mfma_f32_16x16x32_bf16 v[208:211], a[132:135], v[48:51], v[208:211]
	ds_read_b128 v[24:27], v7 offset:22528
	v_mfma_f32_16x16x32_bf16 v[248:251], v[48:51], a[140:143], v[248:251]
	ds_read_b128 v[28:31], v7 offset:23552
	v_mfma_f32_16x16x32_bf16 v[232:235], a[136:139], v[52:55], v[232:235]
	ds_read_b128 v[32:35], v7 offset:24576
	v_mfma_f32_16x16x32_bf16 v[212:215], a[132:135], v[52:55], v[212:215]
	v_mfma_f32_16x16x32_bf16 v[252:255], v[52:55], a[140:143], v[252:255]
	s_waitcnt lgkmcnt(4)
	v_mfma_f32_16x16x32_bf16 v[216:219], a[148:151], v[16:19], v[216:219]
	ds_read_b128 v[36:39], v8 offset:25600
	v_accvgpr_read_b32 v96, a192
	v_mfma_f32_16x16x32_bf16 v[188:191], a[144:147], v[16:19], v[188:191]
	ds_read_b128 v[40:43], v8 offset:26624
	v_accvgpr_read_b32 v97, a193
	v_and_b32 v70, 15, v0
	v_mfma_f32_16x16x32_bf16 v[236:239], v[16:19], a[152:155], v[236:239]
	s_add_u32 m0, s63, 50688
	s_mov_b32 s1, 393216
	buffer_load_dwordx4 v196, s[12:15], s1 offen lds
	s_waitcnt lgkmcnt(5)
	v_mfma_f32_16x16x32_bf16 v[220:223], a[148:151], v[20:23], v[220:223]
	ds_read_b128 v[44:47], v8 offset:27648
	v_accvgpr_read_b32 v98, a194
	v_lshlrev_b32 v70, 2, v70
	v_mfma_f32_16x16x32_bf16 v[200:203], a[144:147], v[20:23], v[200:203]
	v_mfma_f32_16x16x32_bf16 v[240:243], v[20:23], a[152:155], v[240:243]
	ds_read_b128 v[48:51], v8 offset:28672
	v_accvgpr_read_b32 v99, a195
	v_add_u32 v70, 162304, v70
	buffer_load_dwordx4 v194, s[12:15], s1 offen offset:1056 lds
	s_waitcnt lgkmcnt(6)
	v_mfma_f32_16x16x32_bf16 v[224:227], a[148:151], v[24:27], v[224:227]
	v_accvgpr_read_b32 v100, a196
	v_mfma_f32_16x16x32_bf16 v[204:207], a[144:147], v[24:27], v[204:207]
	ds_read_b128 v[52:55], v8 offset:29696
	v_mfma_f32_16x16x32_bf16 v[244:247], v[24:27], a[152:155], v[244:247]
	v_accvgpr_read_b32 v101, a197
	v_and_b32 v71, 48, v0
	s_add_u32 m0, s63, 59136
	s_mov_b32 s1, 458752
	buffer_load_dwordx4 v196, s[12:15], s1 offen lds
	s_waitcnt lgkmcnt(6)
	v_mfma_f32_16x16x32_bf16 v[228:231], a[148:151], v[28:31], v[228:231]
	v_mfma_f32_16x16x32_bf16 v[208:211], a[144:147], v[28:31], v[208:211]
	v_accvgpr_read_b32 v102, a198
	v_add_u32 v71, 162304, v71
	v_mfma_f32_16x16x32_bf16 v[248:251], v[28:31], a[152:155], v[248:251]
	v_accvgpr_read_b32 v103, a199
	buffer_load_dwordx4 v194, s[12:15], s1 offen offset:1056 lds
	s_waitcnt lgkmcnt(5)
	v_mfma_f32_16x16x32_bf16 v[232:235], a[148:151], v[32:35], v[232:235]
	ds_read2_b32 v[56:57], v70 offset0:0 offset1:80
	v_mfma_f32_16x16x32_bf16 v[212:215], a[144:147], v[32:35], v[212:215]
	v_accvgpr_read_b32 v104, a200
	v_mfma_f32_16x16x32_bf16 v[252:255], v[32:35], a[152:155], v[252:255]
	s_waitcnt lgkmcnt(1)
	v_mfma_f32_16x16x32_bf16 v[216:219], a[160:163], v[36:39], v[216:219]
	ds_read_b128 v[16:19], v7 offset:30720
	v_accvgpr_read_b32 v105, a201
	v_mfma_f32_16x16x32_bf16 v[188:191], a[156:159], v[36:39], v[188:191]
	ds_read_b128 v[20:23], v7 offset:31744
	v_accvgpr_read_b32 v106, a202
	ds_read2_b32 v[58:59], v70 offset0:16 offset1:96
	v_mfma_f32_16x16x32_bf16 v[236:239], v[36:39], a[164:167], v[236:239]
	s_add_u32 m0, s0, 0
	s_mov_b32 s1, 0
	buffer_load_dwordx4 v1, s[16:19], s1 offen lds
	v_mfma_f32_16x16x32_bf16 v[220:223], a[160:163], v[40:43], v[220:223]
	ds_read_b128 v[24:27], v7 offset:32768
	v_accvgpr_read_b32 v107, a203
	ds_read2_b32 v[60:61], v70 offset0:32 offset1:112
	v_mfma_f32_16x16x32_bf16 v[200:203], a[156:159], v[40:43], v[200:203]
	buffer_load_dwordx4 v2, s[16:19], s1 offen offset:1024 lds
	v_mfma_f32_16x16x32_bf16 v[240:243], v[40:43], a[164:167], v[240:243]
	ds_read_b128 v[28:31], v7 offset:33792
	v_accvgpr_read_b32 v108, a204
	ds_read2_b32 v[62:63], v70 offset0:48 offset1:128
	v_mfma_f32_16x16x32_bf16 v[224:227], a[160:163], v[44:47], v[224:227]
	v_accvgpr_read_b32 v109, a205
	v_mfma_f32_16x16x32_bf16 v[204:207], a[156:159], v[44:47], v[204:207]
	ds_read_b128 v[32:35], v7 offset:34816
	ds_read2_b32 v[64:65], v70 offset0:64 offset1:144
	s_add_u32 m0, s0, 2112
	s_mov_b32 s1, 114688
	buffer_load_dwordx4 v1, s[16:19], s1 offen lds
	v_mfma_f32_16x16x32_bf16 v[244:247], v[44:47], a[164:167], v[244:247]
	v_accvgpr_read_b32 v110, a206
	v_mfma_f32_16x16x32_bf16 v[228:231], a[160:163], v[48:51], v[228:231]
	ds_read_b128 v[160:163], v71 offset:0
	buffer_load_dwordx4 v[72:75], v198, s[44:47], 0 offen sc1
	v_mfma_f32_16x16x32_bf16 v[208:211], a[156:159], v[48:51], v[208:211]
	v_accvgpr_read_b32 v111, a207
	v_mfma_f32_16x16x32_bf16 v[248:251], v[48:51], a[164:167], v[248:251]
	v_accvgpr_read_b32 v112, a208
	ds_read_b128 v[180:183], v71 offset:320
	v_mfma_f32_16x16x32_bf16 v[232:235], a[160:163], v[52:55], v[232:235]
	buffer_load_dwordx4 v[76:79], v198, s[44:47], 0 offen offset:1024 sc1
	v_mfma_f32_16x16x32_bf16 v[212:215], a[156:159], v[52:55], v[212:215]
	v_accvgpr_read_b32 v113, a209
	ds_read_b128 v[164:167], v71 offset:64
	v_mfma_f32_16x16x32_bf16 v[252:255], v[52:55], a[164:167], v[252:255]
	s_waitcnt lgkmcnt(4)
	v_mfma_f32_16x16x32_bf16 v[216:219], a[172:175], v[16:19], v[216:219]
	ds_read_b128 v[36:39], v8 offset:35840
	v_accvgpr_read_b32 v114, a210
	v_mfma_f32_16x16x32_bf16 v[188:191], a[168:171], v[16:19], v[188:191]
	ds_read_b128 v[40:43], v8 offset:36864
	v_accvgpr_read_b32 v115, a211
	ds_read_b128 v[184:187], v71 offset:384
	v_mfma_f32_16x16x32_bf16 v[236:239], v[16:19], a[176:179], v[236:239]
	buffer_load_dwordx4 v2, s[16:19], s1 offen offset:1024 lds
	v_mfma_f32_16x16x32_bf16 v[220:223], a[172:175], v[20:23], v[220:223]
	ds_read_b128 v[44:47], v8 offset:37888
	v_accvgpr_read_b32 v116, a212
	ds_read_b128 v[168:171], v71 offset:128
	v_mfma_f32_16x16x32_bf16 v[200:203], a[168:171], v[20:23], v[200:203]
	v_accvgpr_read_b32 v117, a213
	s_add_u32 m0, s0, 4224
	s_mov_b32 s1, 229376
	buffer_load_dwordx4 v1, s[16:19], s1 offen lds
	v_mfma_f32_16x16x32_bf16 v[240:243], v[20:23], a[176:179], v[240:243]
	ds_read_b128 v[48:51], v8 offset:38912
	ds_read_b128 v[88:91], v71 offset:448
	v_mfma_f32_16x16x32_bf16 v[224:227], a[172:175], v[24:27], v[224:227]
	v_accvgpr_read_b32 v118, a214
	buffer_load_dwordx4 v2, s[16:19], s1 offen offset:1024 lds
	v_mfma_f32_16x16x32_bf16 v[204:207], a[168:171], v[24:27], v[204:207]
	ds_read_b128 v[52:55], v8 offset:39936
	v_accvgpr_read_b32 v119, a215
	ds_read_b128 v[172:175], v71 offset:192
	v_mfma_f32_16x16x32_bf16 v[244:247], v[24:27], a[176:179], v[244:247]
	s_add_u32 m0, s0, 6336
	s_mov_b32 s1, 344064
	buffer_load_dwordx4 v1, s[16:19], s1 offen lds
	v_mfma_f32_16x16x32_bf16 v[228:231], a[172:175], v[28:31], v[228:231]
	v_mov_b32 v120, 0x3f803f80
	ds_read_b128 v[92:95], v71 offset:512
	v_mfma_f32_16x16x32_bf16 v[208:211], a[168:171], v[28:31], v[208:211]
	v_mov_b32 v121, 0x3f803f80
	buffer_load_dwordx4 v[80:83], v198, s[44:47], s65 offen sc1
	v_mfma_f32_16x16x32_bf16 v[248:251], v[28:31], a[176:179], v[248:251]
	ds_read_b128 v[176:179], v71 offset:256
	v_mfma_f32_16x16x32_bf16 v[232:235], a[172:175], v[32:35], v[232:235]
	v_mov_b32 v122, 0x3f803f80
	buffer_load_dwordx4 v[84:87], v198, s[44:47], s65 offen offset:1024 sc1
	v_mfma_f32_16x16x32_bf16 v[212:215], a[168:171], v[32:35], v[212:215]
	v_mov_b32 v123, 0x3f803f80
	ds_read_b128 v[124:127], v71 offset:576
	v_mfma_f32_16x16x32_bf16 v[252:255], v[32:35], a[176:179], v[252:255]
	s_waitcnt lgkmcnt(4)
	v_mfma_f32_16x16x32_bf16 v[216:219], a[184:187], v[36:39], v[216:219]
	buffer_load_dwordx4 v2, s[16:19], s1 offen offset:1024 lds
	v_mfma_f32_16x16x32_bf16 v[188:191], a[180:183], v[36:39], v[188:191]
	v_mfma_f32_16x16x32_bf16 v[236:239], v[36:39], a[188:191], v[236:239]
	s_add_u32 m0, s0, 8448
	s_mov_b32 s1, 458752
	buffer_load_dwordx4 v1, s[16:19], s1 offen lds
	v_mfma_f32_16x16x32_bf16 v[220:223], a[184:187], v[40:43], v[220:223]
	v_mfma_f32_16x16x32_bf16 v[200:203], a[180:183], v[40:43], v[200:203]
	v_mfma_f32_16x16x32_bf16 v[224:227], a[184:187], v[44:47], v[224:227]
	buffer_load_dwordx4 v2, s[16:19], s1 offen offset:1024 lds
	v_mfma_f32_16x16x32_bf16 v[204:207], a[180:183], v[44:47], v[204:207]
	v_mfma_f32_16x16x32_bf16 v[228:231], a[184:187], v[48:51], v[228:231]
	s_waitcnt lgkmcnt(0)
	s_barrier
	v_mfma_f32_16x16x32_bf16 v[208:211], a[180:183], v[48:51], v[208:211]
	v_mov_b32_dpp v128, v216 row_newbcast:0 row_mask:0xf bank_mask:0xf
	s_add_u32 m0, s0, 42240
	s_mov_b32 s1, 573440
	buffer_load_dwordx4 v1, s[16:19], s1 offen lds
	v_mov_b32_dpp v129, v217 row_newbcast:0 row_mask:0xf bank_mask:0xf
	v_mov_b32_dpp v130, v218 row_newbcast:0 row_mask:0xf bank_mask:0xf
	v_mfma_f32_16x16x32_bf16 v[232:235], a[184:187], v[52:55], v[232:235]
	v_mov_b32_dpp v131, v219 row_newbcast:0 row_mask:0xf bank_mask:0xf
	v_mov_b32_dpp v132, v216 row_newbcast:8 row_mask:0xf bank_mask:0xf
	v_mov_b32_dpp v133, v217 row_newbcast:8 row_mask:0xf bank_mask:0xf
	buffer_load_dwordx4 v2, s[16:19], s1 offen offset:1024 lds
	v_mfma_f32_16x16x32_bf16 v[212:215], a[180:183], v[52:55], v[212:215]
	v_mov_b32_dpp v134, v218 row_newbcast:8 row_mask:0xf bank_mask:0xf
	v_mov_b32_dpp v135, v219 row_newbcast:8 row_mask:0xf bank_mask:0xf
	v_mov_b32_dpp v136, v188 row_newbcast:0 row_mask:0xf bank_mask:0xf
	v_mov_b32_dpp v137, v189 row_newbcast:0 row_mask:0xf bank_mask:0xf
	v_mfma_f32_16x16x32_bf16 v[240:243], v[40:43], a[188:191], v[240:243]
	v_mov_b32_dpp v138, v190 row_newbcast:0 row_mask:0xf bank_mask:0xf
	v_mov_b32_dpp v139, v191 row_newbcast:0 row_mask:0xf bank_mask:0xf
	s_add_u32 m0, s0, 44352
	s_mov_b32 s1, 688128
	buffer_load_dwordx4 v1, s[16:19], s1 offen lds
	v_mov_b32_dpp v140, v188 row_newbcast:8 row_mask:0xf bank_mask:0xf
	v_mfma_f32_16x16x32_bf16 v[244:247], v[44:47], a[188:191], v[244:247]
	v_mov_b32_dpp v141, v189 row_newbcast:8 row_mask:0xf bank_mask:0xf
	v_mov_b32_dpp v142, v190 row_newbcast:8 row_mask:0xf bank_mask:0xf
	v_mov_b32_dpp v143, v191 row_newbcast:8 row_mask:0xf bank_mask:0xf
	v_mov_b32 v66, v236
	v_mfma_f32_16x16x32_bf16 v[248:251], v[48:51], a[188:191], v[248:251]
	v_mov_b32 v67, v236
	buffer_load_dwordx4 v2, s[16:19], s1 offen offset:1024 lds
	s_nop 0
	v_permlane32_swap_b32 v66, v67
	v_mov_b32 v68, v66
	v_mfma_f32_16x16x32_bf16 v[252:255], v[52:55], a[188:191], v[252:255]
	v_mov_b32 v69, v67
	v_permlane16_swap_b32 v66, v68
	s_nop 0
	v_permlane16_swap_b32 v67, v69
	v_pk_fma_f32 v[216:217], v[128:129], v[56:57], v[216:217] op_sel_hi:[1,0,1]
	s_add_u32 m0, s0, 46464
	s_mov_b32 s1, 802816
	buffer_load_dwordx4 v1, s[16:19], s1 offen lds
	v_pk_fma_f32 v[218:219], v[130:131], v[56:57], v[218:219] op_sel_hi:[1,0,1]
	v_pk_fma_f32 v[216:217], v[216:217], v[56:57], v[132:133] op_sel:[0,1,0]
	v_pk_fma_f32 v[218:219], v[218:219], v[56:57], v[134:135] op_sel:[0,1,0]
	v_cvt_pk_bf16_f32 v24, v216, v217
	v_cvt_pk_bf16_f32 v25, v218, v219
	v_pk_fma_f32 v[220:221], v[128:129], v[58:59], v[220:221] op_sel_hi:[1,0,1]
	buffer_load_dwordx4 v2, s[16:19], s1 offen offset:1024 lds
	v_pk_fma_f32 v[222:223], v[130:131], v[58:59], v[222:223] op_sel_hi:[1,0,1]
	v_pk_fma_f32 v[200:201], v[136:137], v[58:59], v[200:201] op_sel_hi:[1,0,1]
	v_pk_fma_f32 v[202:203], v[138:139], v[58:59], v[202:203] op_sel_hi:[1,0,1]
	v_pk_fma_f32 v[220:221], v[220:221], v[58:59], v[132:133] op_sel:[0,1,0]
	v_pk_fma_f32 v[222:223], v[222:223], v[58:59], v[134:135] op_sel:[0,1,0]
	v_pk_fma_f32 v[200:201], v[200:201], v[58:59], v[140:141] op_sel:[0,1,0]
	v_pk_fma_f32 v[202:203], v[202:203], v[58:59], v[142:143] op_sel:[0,1,0]
	s_add_u32 m0, s0, 48576
	s_mov_b32 s1, 917504
	buffer_load_dwordx4 v1, s[16:19], s1 offen lds
	v_cvt_pk_bf16_f32 v26, v220, v221
	v_cvt_pk_bf16_f32 v27, v222, v223
	v_cvt_pk_bf16_f32 v16, v200, v201
	v_cvt_pk_bf16_f32 v17, v202, v203
	v_pk_fma_f32 v[224:225], v[128:129], v[60:61], v[224:225] op_sel_hi:[1,0,1]
	v_pk_fma_f32 v[226:227], v[130:131], v[60:61], v[226:227] op_sel_hi:[1,0,1]
	v_pk_fma_f32 v[204:205], v[136:137], v[60:61], v[204:205] op_sel_hi:[1,0,1]
	buffer_load_dwordx4 v2, s[16:19], s1 offen offset:1024 lds
	v_pk_fma_f32 v[206:207], v[138:139], v[60:61], v[206:207] op_sel_hi:[1,0,1]
	v_pk_fma_f32 v[224:225], v[224:225], v[60:61], v[132:133] op_sel:[0,1,0]
	v_pk_fma_f32 v[226:227], v[226:227], v[60:61], v[134:135] op_sel:[0,1,0]
	v_pk_fma_f32 v[204:205], v[204:205], v[60:61], v[140:141] op_sel:[0,1,0]
	v_pk_fma_f32 v[206:207], v[206:207], v[60:61], v[142:143] op_sel:[0,1,0]
	v_cvt_pk_bf16_f32 v28, v224, v225
	s_add_u32 m0, s0, 50688
	s_mov_b32 s1, 1032192
	buffer_load_dwordx4 v1, s[16:19], s1 offen lds
	v_cvt_pk_bf16_f32 v29, v226, v227
	v_cvt_pk_bf16_f32 v18, v204, v205
	v_cvt_pk_bf16_f32 v19, v206, v207
	v_pk_fma_f32 v[228:229], v[128:129], v[62:63], v[228:229] op_sel_hi:[1,0,1]
	v_pk_fma_f32 v[230:231], v[130:131], v[62:63], v[230:231] op_sel_hi:[1,0,1]
	v_pk_fma_f32 v[208:209], v[136:137], v[62:63], v[208:209] op_sel_hi:[1,0,1]
	v_pk_fma_f32 v[210:211], v[138:139], v[62:63], v[210:211] op_sel_hi:[1,0,1]
	buffer_load_dwordx4 v2, s[16:19], s1 offen offset:1024 lds
	v_pk_fma_f32 v[228:229], v[228:229], v[62:63], v[132:133] op_sel:[0,1,0]
	v_pk_fma_f32 v[230:231], v[230:231], v[62:63], v[134:135] op_sel:[0,1,0]
	v_pk_fma_f32 v[208:209], v[208:209], v[62:63], v[140:141] op_sel:[0,1,0]
	v_pk_fma_f32 v[210:211], v[210:211], v[62:63], v[142:143] op_sel:[0,1,0]
	v_cvt_pk_bf16_f32 v30, v228, v229
	v_cvt_pk_bf16_f32 v31, v230, v231
	v_cvt_pk_bf16_f32 v20, v208, v209
	v_cvt_pk_bf16_f32 v21, v210, v211
	v_pk_fma_f32 v[232:233], v[128:129], v[64:65], v[232:233] op_sel_hi:[1,0,1]
	v_pk_fma_f32 v[234:235], v[130:131], v[64:65], v[234:235] op_sel_hi:[1,0,1]
	v_pk_fma_f32 v[212:213], v[136:137], v[64:65], v[212:213] op_sel_hi:[1,0,1]
	v_pk_fma_f32 v[214:215], v[138:139], v[64:65], v[214:215] op_sel_hi:[1,0,1]
	v_pk_fma_f32 v[232:233], v[232:233], v[64:65], v[132:133] op_sel:[0,1,0]
	v_pk_fma_f32 v[234:235], v[234:235], v[64:65], v[134:135] op_sel:[0,1,0]
	v_pk_fma_f32 v[212:213], v[212:213], v[64:65], v[140:141] op_sel:[0,1,0]
	v_pk_fma_f32 v[214:215], v[214:215], v[64:65], v[142:143] op_sel:[0,1,0]
	v_cvt_pk_bf16_f32 v32, v232, v233
	v_cvt_pk_bf16_f32 v33, v234, v235
	v_cvt_pk_bf16_f32 v22, v212, v213
	v_cvt_pk_bf16_f32 v23, v214, v215
	v_mfma_f32_16x16x16_bf16 v[128:131], v[26:27], v[16:17], v[96:99]
	v_mfma_f32_16x16x16_bf16 v[144:147], v[24:25], v[16:17], v[104:107]
	v_mfma_f32_16x16x16_bf16 v[132:135], v[28:29], v[18:19], v[96:99]
	v_mfma_f32_16x16x16_bf16 v[148:151], v[26:27], v[18:19], v[100:103]
	v_mfma_f32_16x16x16_bf16 v[136:139], v[30:31], v[20:21], v[96:99]
	v_mfma_f32_16x16x16_bf16 v[152:155], v[24:25], v[20:21], v[108:111]
	v_mfma_f32_16x16x16_bf16 v[140:143], v[32:33], v[22:23], v[96:99]
	v_mfma_f32_16x16x16_bf16 v[156:159], v[30:31], v[22:23], v[100:103]
	v_pk_fma_f32 v[236:237], v[160:161], v[66:67], v[236:237] op_sel_hi:[1,0,1]
	v_pk_fma_f32 v[238:239], v[162:163], v[66:67], v[238:239] op_sel_hi:[1,0,1]
	v_pk_fma_f32 v[240:241], v[164:165], v[66:67], v[240:241] op_sel_hi:[1,0,1]
	v_pk_fma_f32 v[242:243], v[166:167], v[66:67], v[242:243] op_sel_hi:[1,0,1]
	v_pk_fma_f32 v[244:245], v[168:169], v[66:67], v[244:245] op_sel_hi:[1,0,1]
	v_pk_fma_f32 v[246:247], v[170:171], v[66:67], v[246:247] op_sel_hi:[1,0,1]
	v_pk_fma_f32 v[248:249], v[172:173], v[66:67], v[248:249] op_sel_hi:[1,0,1]
	v_pk_fma_f32 v[250:251], v[174:175], v[66:67], v[250:251] op_sel_hi:[1,0,1]
	v_pk_fma_f32 v[252:253], v[176:177], v[66:67], v[252:253] op_sel_hi:[1,0,1]
	v_pk_fma_f32 v[254:255], v[178:179], v[66:67], v[254:255] op_sel_hi:[1,0,1]
	v_pk_fma_f32 v[236:237], v[236:237], v[180:181], v[66:67] op_sel:[0,0,1]
	v_pk_fma_f32 v[238:239], v[238:239], v[182:183], v[66:67] op_sel:[0,0,1]
	v_pk_fma_f32 v[240:241], v[240:241], v[184:185], v[66:67] op_sel:[0,0,1]
	v_pk_fma_f32 v[242:243], v[242:243], v[186:187], v[66:67] op_sel:[0,0,1]
	v_pk_fma_f32 v[244:245], v[244:245], v[88:89], v[66:67] op_sel:[0,0,1]
	v_pk_fma_f32 v[246:247], v[246:247], v[90:91], v[66:67] op_sel:[0,0,1]
	v_pk_fma_f32 v[248:249], v[248:249], v[92:93], v[66:67] op_sel:[0,0,1]
	v_pk_fma_f32 v[250:251], v[250:251], v[94:95], v[66:67] op_sel:[0,0,1]
	v_pk_fma_f32 v[252:253], v[252:253], v[124:125], v[66:67] op_sel:[0,0,1]
	v_pk_fma_f32 v[254:255], v[254:255], v[126:127], v[66:67] op_sel:[0,0,1]
	v_cvt_pk_bf16_f32 v34, v236, v237
	v_cvt_pk_bf16_f32 v35, v238, v239
	v_cvt_pk_bf16_f32 v36, v240, v241
	v_cvt_pk_bf16_f32 v37, v242, v243
	v_cvt_pk_bf16_f32 v38, v244, v245
	v_cvt_pk_bf16_f32 v39, v246, v247
	v_cvt_pk_bf16_f32 v40, v236, v237
	v_cvt_pk_bf16_f32 v41, v238, v239
	v_cvt_pk_bf16_f32 v42, v248, v249
	v_cvt_pk_bf16_f32 v43, v250, v251
	v_cvt_pk_bf16_f32 v44, v252, v253
	v_cvt_pk_bf16_f32 v45, v254, v255
	s_mov_b32 s56, 0x3eb8aa3b
	v_max_f32 v128, v128, v144
	v_max_f32 v129, v129, v145
	v_max_f32 v130, v130, v146
	v_max_f32 v131, v131, v147
	v_max_f32 v132, v132, v148
	v_max_f32 v133, v133, v149
	v_max_f32 v134, v134, v150
	v_max_f32 v135, v135, v151
	v_max_f32 v136, v136, v152
	v_max_f32 v137, v137, v153
	v_max_f32 v138, v138, v154
	v_max_f32 v139, v139, v155
	v_max_f32 v140, v140, v156
	v_max_f32 v141, v141, v157
	v_max_f32 v142, v142, v158
	v_max_f32 v143, v143, v159
	v_max3_f32 v160, v128, v129, v130
	v_max3_f32 v161, v132, v133, v134
	v_max3_f32 v162, v136, v137, v138
	v_max3_f32 v163, v140, v141, v142
	v_max_f32 v160, v160, v131
	v_max_f32 v161, v161, v135
	v_max_f32 v162, v162, v139
	v_max_f32 v163, v163, v143
	v_permlane32_swap_b32 v160, v161
	s_nop 0
	v_permlane32_swap_b32 v162, v163
	v_max_f32 v160, v160, v161
	v_max_f32 v162, v162, v163
	s_nop 1
	v_permlane16_swap_b32 v160, v162
	v_max_f32 v160, v160, v162
	v_mul_f32 v160, s56, v160
	v_mov_b32 v162, v160
	s_nop 1
	v_permlane16_swap_b32 v160, v162
	v_mov_b32 v161, v160
	v_mov_b32 v163, v162
	s_nop 0
	v_permlane32_swap_b32 v160, v161
	v_permlane32_swap_b32 v162, v163
	v_fma_f32 v128, v128, s56, -v160
	v_fma_f32 v129, v129, s56, -v160
	v_fma_f32 v130, v130, s56, -v160
	v_fma_f32 v131, v131, s56, -v160
	v_exp_f32 v128, v128
	v_exp_f32 v129, v129
	v_exp_f32 v130, v130
	v_exp_f32 v131, v131
	v_fma_f32 v132, v132, s56, -v161
	v_fma_f32 v133, v133, s56, -v161
	v_fma_f32 v134, v134, s56, -v161
	v_fma_f32 v135, v135, s56, -v161
	v_exp_f32 v132, v132
	v_exp_f32 v133, v133
	v_exp_f32 v134, v134
	v_exp_f32 v135, v135
	v_fma_f32 v136, v136, s56, -v162
	v_fma_f32 v137, v137, s56, -v162
	v_fma_f32 v138, v138, s56, -v162
	v_fma_f32 v139, v139, s56, -v162
	v_exp_f32 v136, v136
	v_exp_f32 v137, v137
	v_exp_f32 v138, v138
	v_exp_f32 v139, v139
	v_fma_f32 v140, v140, s56, -v163
	v_fma_f32 v141, v141, s56, -v163
	v_fma_f32 v142, v142, s56, -v163
	v_fma_f32 v143, v143, s56, -v163
	v_exp_f32 v140, v140
	v_exp_f32 v141, v141
	v_exp_f32 v142, v142
	v_exp_f32 v143, v143
	v_cvt_pk_bf16_f32 v164, v128, v129
	v_cvt_pk_bf16_f32 v165, v130, v131
	v_cvt_pk_bf16_f32 v166, v132, v133
	v_cvt_pk_bf16_f32 v167, v134, v135
	v_cvt_pk_bf16_f32 v168, v136, v137
	v_cvt_pk_bf16_f32 v169, v138, v139
	v_cvt_pk_bf16_f32 v170, v140, v141
	v_cvt_pk_bf16_f32 v171, v142, v143
	v_and_b32 v176, v164, v116
	v_and_b32 v178, v164, v112
	v_and_b32 v177, v165, v117
	v_and_b32 v179, v165, v113
	v_and_b32 v180, v166, v114
	v_and_b32 v182, v166, v112
	v_and_b32 v181, v167, v115
	v_and_b32 v183, v167, v113
	v_and_b32 v184, v168, v118
	v_and_b32 v186, v168, v112
	v_and_b32 v185, v169, v119
	v_and_b32 v187, v169, v113
	v_and_b32 v188, v170, v114
	v_and_b32 v190, v170, v112
	v_and_b32 v189, v171, v115
	v_and_b32 v191, v171, v113
	v_mfma_f32_16x16x32_bf16 v[144:147], v[120:123], v[176:179], 0
	v_mfma_f32_16x16x32_bf16 v[128:131], v[34:37], v[176:179], 0
	v_mfma_f32_16x16x32_bf16 v[148:151], v[120:123], v[180:183], 0
	v_mfma_f32_16x16x32_bf16 v[132:135], v[36:39], v[180:183], 0
	v_mfma_f32_16x16x32_bf16 v[152:155], v[120:123], v[184:187], 0
	v_mfma_f32_16x16x32_bf16 v[136:139], v[40:43], v[184:187], 0
	v_mfma_f32_16x16x32_bf16 v[156:159], v[120:123], v[188:191], 0
	v_mfma_f32_16x16x32_bf16 v[140:143], v[42:45], v[188:191], 0
	v_lshrrev_b32 v46, 4, v0
	v_and_b32 v47, 1, v46
	v_lshlrev_b32 v47, 14, v47
	v_lshrrev_b32 v46, 1, v46
	v_lshl_add_u32 v47, v46, 8, v47
	v_and_b32 v46, 15, v0
	v_lshl_add_u32 v47, v46, 4, v47
	s_lshl_b32 s56, s52, 9
	s_lshl_b32 s57, s51, 11
	s_add_u32 s56, s56, s57
	s_lshl_b32 s57, s50, 16
	s_add_u32 s56, s56, s57
	s_add_u32 s56, s56, 1048576
	v_add_u32 v47, s56, v47
	v_rcp_f32 v144, v144
	v_rcp_f32 v148, v148
	v_rcp_f32 v152, v152
	v_rcp_f32 v156, v156
	v_mul_f32 v128, v128, v144
	v_mul_f32 v129, v129, v144
	v_mul_f32 v130, v130, v144
	v_mul_f32 v131, v131, v144
	v_cvt_pk_bf16_f32 v160, v128, v129
	v_cvt_pk_bf16_f32 v161, v130, v131
	v_mul_f32 v132, v132, v148
	v_mul_f32 v133, v133, v148
	v_mul_f32 v134, v134, v148
	v_mul_f32 v135, v135, v148
	v_cvt_pk_bf16_f32 v162, v132, v133
	v_cvt_pk_bf16_f32 v163, v134, v135
	v_mul_f32 v136, v136, v152
	v_mul_f32 v137, v137, v152
	v_mul_f32 v138, v138, v152
	v_mul_f32 v139, v139, v152
	v_cvt_pk_bf16_f32 v164, v136, v137
	v_cvt_pk_bf16_f32 v165, v138, v139
	v_mul_f32 v140, v140, v156
	v_mul_f32 v141, v141, v156
	v_mul_f32 v142, v142, v156
	v_mul_f32 v143, v143, v156
	v_cvt_pk_bf16_f32 v166, v140, v141
	v_cvt_pk_bf16_f32 v167, v142, v143
	s_waitcnt vmcnt(30)
	v_cmp_ne_u32 vcc, s53, v13
	s_cbranch_vccz ok_4
	s_mov_b32 s58, 200000
poll_5:
	buffer_load_dwordx2 v[12:13], v197, s[44:47], 0 offen sc1
	s_waitcnt vmcnt(0)
	v_cmp_ne_u32 vcc, s53, v13
	s_cbranch_vccz pdone_6
	s_sub_u32 s58, s58, 1
	s_cbranch_scc0 poll_5
pdone_6:
ok_4:
	v_cmp_ne_u32 vcc, s69, v12
	v_permlane16_swap_b32 v160, v162
	v_permlane16_swap_b32 v161, v163
	v_permlane16_swap_b32 v164, v166
	v_permlane16_swap_b32 v165, v167
	s_mov_b32 s57, 32768
	s_cbranch_vccnz SLOW
	buffer_store_dwordx4 v[160:163], v47, s[44:47], 0 offen sc1
	buffer_store_dwordx4 v[164:167], v47, s[44:47], s57 offen sc1
	v_mov_b32 v8, s53
	s_lshl_b32 s54, s50, 7
	s_lshl_b32 s55, s51, 4
	s_add_u32 s54, s54, s55
	s_lshl_b32 s55, s52, 2
	s_add_u32 s54, s54, s55
	s_add_u32 s54, s54, 24576
	v_mov_b32 v4, s54
	v_accvgpr_read_b32 v32, a216
	v_accvgpr_read_b32 v33, a217
	v_accvgpr_read_b32 v34, a218
	v_accvgpr_read_b32 v35, a219
	v_accvgpr_read_b32 v36, a220
	v_accvgpr_read_b32 v37, a221
	v_accvgpr_read_b32 v38, a222
	v_accvgpr_read_b32 v39, a223
	v_accvgpr_read_b32 v108, a224
	v_accvgpr_read_b32 v109, a225
	v_accvgpr_read_b32 v110, a226
	v_accvgpr_read_b32 v111, a227
	v_accvgpr_read_b32 v22, a228
	v_lshrrev_b32 v21, 4, v0
	v_mul_u32_u24 v48, 1056, v21
	v_mov_b32 v49, 0
	v_bfe_u32 v52, v0, 1, 1
	v_lshl_add_u32 v52, v49, 1, v52
	v_lshrrev_b32 v51, 1, v0
	v_and_b32 v51, 4, v51
	v_xor_b32 v52, v52, v51
	v_lshlrev_b32 v52, 4, v52
	v_and_b32 v51, 1, v0
	v_lshl_add_u32 v52, v51, 3, v52
	v_bfe_u32 v51, v0, 2, 2
	v_lshl_add_u32 v52, v51, 7, v52
	v_add_u32 v6, v52, v48
	v_sub_u32 v7, v6, v48
	v_xor_b32 v7, 64, v7
	v_add_u32 v7, v7, v48
	s_waitcnt vmcnt(22)
	v_cmp_ne_u32 vcc, s53, v75
	s_waitcnt vmcnt(21)
	v_cmp_ne_u32 s[54:55], s53, v79
	s_or_b64 vcc, vcc, s[54:55]
	s_waitcnt vmcnt(16)
	v_cmp_ne_u32 s[54:55], s53, v83
	s_or_b64 vcc, vcc, s[54:55]
	s_waitcnt vmcnt(15)
	v_cmp_ne_u32 s[54:55], s53, v87
	s_or_b64 vcc, vcc, s[54:55]
	s_cbranch_vccz ok_7
	s_mov_b32 s58, 200000
poll_8:
	buffer_load_dwordx4 v[72:75], v198, s[44:47], 0 offen sc1
	buffer_load_dwordx4 v[76:79], v198, s[44:47], 0 offen offset:1024 sc1
	buffer_load_dwordx4 v[80:83], v198, s[44:47], s65 offen sc1
	buffer_load_dwordx4 v[84:87], v198, s[44:47], s65 offen offset:1024 sc1
	s_waitcnt vmcnt(0)
	v_cmp_ne_u32 vcc, s53, v75
	v_cmp_ne_u32 s[54:55], s53, v79
	s_or_b64 vcc, vcc, s[54:55]
	v_cmp_ne_u32 s[54:55], s53, v83
	s_or_b64 vcc, vcc, s[54:55]
	v_cmp_ne_u32 s[54:55], s53, v87
	s_or_b64 vcc, vcc, s[54:55]
	s_cbranch_vccz pdone_9
	s_sub_u32 s58, s58, 1
	s_cbranch_scc0 poll_8
pdone_9:
ok_7:
	s_cmp_eq_u32 s52, 2
	s_cselect_b32 s57, 1.0, 0
	s_mov_b32 s54, 0x04000c0c
	s_mov_b32 s55, 0x0302040c
	v_perm_b32 v75, v74, v73, s54
	v_perm_b32 v83, v82, v81, s54
	v_perm_b32 v75, v72, v75, s55
	v_perm_b32 v83, v80, v83, s55
	v_add_f32 v52, v72, v80
	v_add_f32 v53, v73, v81
	v_add_f32 v54, v74, v82
	v_add_f32 v55, v75, v83
	v_perm_b32 v79, v78, v77, s54
	v_perm_b32 v87, v86, v85, s54
	v_perm_b32 v79, v76, v79, s55
	v_perm_b32 v87, v84, v87, s55
	v_add_f32 v56, v76, v84
	v_add_f32 v57, v77, v85
	v_add_f32 v58, v78, v86
	v_add_f32 v59, v79, v87
	v_add_f32 v52, s57, v52
	v_add_f32 v53, s57, v53
	v_add_f32 v54, s57, v54
	v_add_f32 v55, s57, v55
	v_add_f32 v56, s57, v56
	v_add_f32 v57, s57, v57
	v_add_f32 v58, s57, v58
	v_add_f32 v59, s57, v59
	v_cvt_pk_bf16_f32 v52, v52, v53
	v_cvt_pk_bf16_f32 v53, v54, v55
	v_cvt_pk_bf16_f32 v54, v56, v57
	v_cvt_pk_bf16_f32 v55, v58, v59
	v_lshrrev_b32 v48, 3, v0
	v_lshlrev_b32 v48, 6, v48
	v_and_b32 v49, 3, v0
	v_lshl_add_u32 v48, v49, 4, v48
	v_bfe_u32 v49, v0, 2, 1
	v_lshl_add_u32 v48, v49, 3, v48
	s_lshl_b32 s54, s52, 10
	s_add_u32 s54, s54, 157440
	v_add_u32 v48, s54, v48
	ds_write_b64 v48, v[52:53]
	ds_write_b64 v48, v[54:55] offset:512
	s_cmp_lt_u32 s52, 2
	s_cselect_b32 s55, 0x3f803f80, 0
	s_lshl_b32 s54, s52, 9
	s_add_u32 s54, s54, 161536
	v_lshl_add_u32 v49, v0, 3, s54
	v_mov_b32 v56, s55
	v_mov_b32 v57, s55
	ds_write_b64 v49, v[56:57]
	v_lshrrev_b32 v40, 2, v0
	v_and_b32 v40, 4, v40
	v_and_b32 v10, 7, v0
	v_xor_b32 v10, v10, v40
	v_lshlrev_b32 v10, 4, v10
	v_lshrrev_b32 v40, 3, v0
	v_mul_u32_u24 v40, 1024, v40
	v_add_u32 v10, v10, v40
	s_lshl_b32 s54, s51, 7
	s_mul_i32 s55, s52, 458752
	s_add_u32 s54, s54, s55
	v_add_u32 v10, s54, v10
	v_add_u32 v23, 7136, v10
	v_and_b32 v40, 1, v21
	v_xor_b32 v40, s52, v40
	v_lshrrev_b32 v41, 5, v0
	v_lshlrev_b32 v41, 9, v41
	v_bfe_u32 v42, v0, 1, 1
	v_lshl_add_u32 v42, v40, 1, v42
	v_lshrrev_b32 v43, 1, v0
	v_and_b32 v43, 4, v43
	v_xor_b32 v42, v42, v43
	v_lshlrev_b32 v42, 4, v42
	v_and_b32 v43, 1, v0
	v_lshl_add_u32 v42, v43, 3, v42
	v_bfe_u32 v43, v0, 2, 2
	v_lshl_add_u32 v42, v43, 7, v42
	v_add_u32 v11, v42, v41
	v_xor_b32 v12, 64, v11
	v_add_u32 v11, s0, v11
	v_add_u32 v12, s0, v12
	s_waitcnt vmcnt(0)
	buffer_store_dword v8, v4, s[44:47], 0 offen
	s_waitcnt lgkmcnt(0)
	s_barrier
	s_lshl_b32 s54, s51, 7
	ds_read_b64_tr_b16 a[128:129], v6 offset:0
	s_add_u32 s54, s54, 157440
	ds_read_b64_tr_b16 a[0:1], v3 offset:0
	v_lshl_add_u32 v49, v21, 4, s54
	ds_read_b64_tr_b16 a[130:131], v6 offset:512
	ds_read_b64_tr_b16 a[2:3], v3 offset:1024
	ds_read_b128 v[44:47], v49 offset:0
	ds_read_b64_tr_b16 a[4:5], v3 offset:512
	ds_read_b128 v[52:55], v49 offset:64
	ds_read_b64_tr_b16 a[132:133], v6 offset:32
	ds_read_b128 v[60:63], v49 offset:2048
	ds_read_b64_tr_b16 a[6:7], v3 offset:1536
	ds_read_b128 v[68:71], v49 offset:2112
	ds_read_b64_tr_b16 a[134:135], v6 offset:544
	ds_read_b128 v[76:79], v49 offset:1024
	ds_read_b64_tr_b16 a[8:9], v3 offset:2112
	ds_read_b128 v[84:87], v49 offset:1088
	s_lshr_b32 s55, s52, 1
	ds_read_b64_tr_b16 a[136:137], v6 offset:4224
	ds_read_b64_tr_b16 a[10:11], v3 offset:3136
	s_lshl_b32 s55, s55, 6
	ds_read_b64_tr_b16 a[12:13], v3 offset:2624
	s_add_u32 s54, s54, s55
	ds_read_b64_tr_b16 a[138:139], v6 offset:4736
	ds_read_b64_tr_b16 a[14:15], v3 offset:3648
	s_and_b32 s55, s52, 1
	s_lshl_b32 s55, s55, 3
	s_waitcnt lgkmcnt(10)
	ds_read_b64_tr_b16 a[140:141], v6 offset:4256
	s_add_u32 s54, s54, s55
	s_add_u32 m0, s0, 0
	v_lshrrev_b32 v17, 5, v0
	s_mov_b32 s1, 1146880
	ds_read_b64_tr_b16 a[142:143], v6 offset:4768
	v_lshl_add_u32 v16, v17, 4, s54
	ds_read_b64 v[104:105], v16 offset:3072
	buffer_load_dwordx4 v1, s[16:19], s1 offen lds
	ds_read_b64 v[106:107], v16 offset:3104
	ds_read_b64_tr_b16 a[144:145], v6 offset:8448
	buffer_load_dwordx4 v2, s[16:19], s1 offen offset:1024 lds
	v_and_b32 v18, 15, v0
	v_lshrrev_b32 v16, 1, v21
	ds_read_b64_tr_b16 a[146:147], v6 offset:8960
	v_lshlrev_b32 v240, 10, v16
	ds_read_b64_tr_b16 a[16:17], v3 offset:4224
	v_and_b32 v16, 1, v21
	ds_read_b64_tr_b16 a[18:19], v3 offset:5248
	ds_read_b64_tr_b16 a[148:149], v6 offset:8480
	v_lshl_add_u32 v240, v16, 9, v240
	ds_read_b64_tr_b16 a[20:21], v3 offset:4736
	v_lshl_add_u32 v240, v18, 4, v240
	s_lshl_b32 s54, s50, 1
	ds_read_b64_tr_b16 a[150:151], v6 offset:8992
	ds_read_b64_tr_b16 a[22:23], v3 offset:5760
	s_lshr_b32 s55, s52, 1
	s_waitcnt lgkmcnt(12)
	s_add_u32 s54, s54, s55
	ds_read_b64_tr_b16 a[152:153], v6 offset:12672
	s_add_u32 m0, s0, 2112
	s_lshl_b32 s54, s54, 15
	s_lshl_b32 s55, s51, 12
	s_mov_b32 s1, 1261568
	ds_read_b64_tr_b16 a[154:155], v6 offset:13184
	s_add_u32 s54, s54, s55
	buffer_load_dwordx4 v1, s[16:19], s1 offen lds
	s_and_b32 s55, s52, 1
	buffer_load_dwordx4 v2, s[16:19], s1 offen offset:1024 lds
	ds_read_b64_tr_b16 a[156:157], v6 offset:12704
	s_lshl_b32 s55, s55, 8
	s_add_u32 s54, s54, s55
	s_add_u32 s54, s54, 3145728
	ds_read_b64_tr_b16 a[158:159], v6 offset:13216
	ds_read_b64_tr_b16 a[24:25], v3 offset:6336
	v_add_u32 v240, s54, v240
	ds_read_b64_tr_b16 a[26:27], v3 offset:7360
	s_lshl_b32 s54, s50, 3
	ds_read_b64_tr_b16 a[160:161], v6 offset:16896
	s_add_u32 s54, s54, s51
	ds_read_b64_tr_b16 a[28:29], v3 offset:6848
	s_lshl_b32 s54, s54, 11
	ds_read_b64_tr_b16 a[30:31], v3 offset:7872
	ds_read_b64_tr_b16 a[162:163], v6 offset:17408
	s_lshl_b32 s55, s52, 8
	s_waitcnt lgkmcnt(10)
	s_add_u32 s54, s54, s55
	s_add_u32 s54, s54, 524288
	ds_read_b64_tr_b16 a[164:165], v6 offset:16928
	s_add_u32 m0, s0, 4224
	v_lshl_add_u32 v241, v18, 4, s54
	s_mov_b32 s1, 1376256
	v_lshl_add_u32 v241, v17, 10, v241
	ds_read_b64_tr_b16 a[166:167], v6 offset:17440
	buffer_load_dwordx4 v1, s[16:19], s1 offen lds
	v_and_b32 v16, 31, v0
	s_lshl_b32 s54, s50, 7
	buffer_load_dwordx4 v2, s[16:19], s1 offen offset:1024 lds
	ds_read_b64_tr_b16 a[168:169], v6 offset:21120
	s_add_u32 s54, s54, 24576
	v_lshl_add_u32 v13, v16, 2, s54
	ds_read_b64_tr_b16 a[32:33], v3 offset:8448
	ds_read_b64_tr_b16 a[170:171], v6 offset:21632
	v_lshlrev_b32 v24, 16, v32
	v_and_b32 v25, s67, v32
	ds_read_b64_tr_b16 a[34:35], v3 offset:9472
	v_lshlrev_b32 v26, 16, v33
	ds_read_b64_tr_b16 a[172:173], v6 offset:21152
	ds_read_b64_tr_b16 a[36:37], v3 offset:8960
	v_and_b32 v27, s67, v33
	ds_read_b64_tr_b16 a[38:39], v3 offset:9984
	v_lshlrev_b32 v28, 16, v34
	ds_read_b64_tr_b16 a[174:175], v6 offset:21664
	v_and_b32 v29, s67, v34
	v_lshlrev_b32 v30, 16, v35
	ds_read_b64_tr_b16 a[40:41], v3 offset:42240
	ds_read_b64_tr_b16 a[176:177], v6 offset:25344
	v_and_b32 v31, s67, v35
	ds_read_b64_tr_b16 a[42:43], v3 offset:43264
	v_lshlrev_b32 v32, 16, v36
	v_and_b32 v33, s67, v36
	ds_read_b64_tr_b16 a[178:179], v6 offset:25856
	ds_read_b64_tr_b16 a[44:45], v3 offset:42752
	v_lshlrev_b32 v34, 16, v37
	ds_read_b64_tr_b16 a[46:47], v3 offset:43776
	v_and_b32 v35, s67, v37
	ds_read_b64_tr_b16 a[180:181], v6 offset:25376
	v_lshlrev_b32 v36, 16, v38
	v_and_b32 v37, s67, v38
	ds_read_b64_tr_b16 a[48:49], v3 offset:44352
	ds_read_b64_tr_b16 a[182:183], v6 offset:25888
	v_lshlrev_b32 v38, 16, v39
	ds_read_b64_tr_b16 a[50:51], v3 offset:45376
	v_and_b32 v39, s67, v39
	ds_read_b64_tr_b16 a[52:53], v3 offset:44864
	ds_read_b64_tr_b16 a[184:185], v6 offset:29568
	v_lshlrev_b32 v40, 16, v44
	v_and_b32 v41, s67, v44
	ds_read_b64_tr_b16 a[54:55], v3 offset:45888
	v_lshlrev_b32 v42, 16, v45
	ds_read_b64_tr_b16 a[186:187], v6 offset:30080
	v_and_b32 v43, s67, v45
	ds_read_b64_tr_b16 a[56:57], v3 offset:46464
	v_lshlrev_b32 v44, 16, v46
	ds_read_b64_tr_b16 a[188:189], v6 offset:29600
	v_and_b32 v45, s67, v46
	ds_read_b64_tr_b16 a[58:59], v3 offset:47488
	v_lshlrev_b32 v46, 16, v47
	ds_read_b64_tr_b16 a[60:61], v3 offset:46976
	ds_read_b64_tr_b16 a[190:191], v6 offset:30112
	v_and_b32 v47, s67, v47
	ds_read_b64_tr_b16 a[62:63], v3 offset:48000
	v_lshlrev_b32 v48, 16, v52
	buffer_load_dword v4, v13, s[44:47], 0 offen sc1
	v_and_b32 v49, s67, v52
	ds_read_b64_tr_b16 a[192:193], v6 offset:33792
	v_lshlrev_b32 v50, 16, v53
	ds_read_b64_tr_b16 a[194:195], v6 offset:34304
	v_and_b32 v51, s67, v53
	v_lshlrev_b32 v52, 16, v54
	ds_read_b64_tr_b16 a[196:197], v6 offset:33824
	v_and_b32 v53, s67, v54
	ds_read_b64_tr_b16 a[198:199], v6 offset:34336
	v_lshlrev_b32 v54, 16, v55
	v_and_b32 v55, s67, v55
	ds_read_b64_tr_b16 a[200:201], v6 offset:38016
	v_lshlrev_b32 v56, 16, v60
	ds_read_b64_tr_b16 a[202:203], v6 offset:38528
	v_and_b32 v57, s67, v60
	v_lshlrev_b32 v58, 16, v61
	ds_read_b64_tr_b16 a[204:205], v6 offset:38048
	v_and_b32 v59, s67, v61
	ds_read_b64_tr_b16 a[206:207], v6 offset:38560
	v_lshlrev_b32 v60, 16, v62
	v_and_b32 v61, s67, v62
	ds_read_b64_tr_b16 a[208:209], v6 offset:42240
	v_lshlrev_b32 v62, 16, v63
	v_and_b32 v63, s67, v63
	ds_read_b64_tr_b16 a[210:211], v6 offset:42752
	v_lshlrev_b32 v64, 16, v68
	ds_read_b64_tr_b16 a[212:213], v6 offset:42272
	v_and_b32 v65, s67, v68
	v_lshlrev_b32 v66, 16, v69
	ds_read_b64_tr_b16 a[214:215], v6 offset:42784
	v_and_b32 v67, s67, v69
	ds_read_b64_tr_b16 a[216:217], v6 offset:46464
	v_lshlrev_b32 v68, 16, v70
	v_and_b32 v69, s67, v70
	ds_read_b64_tr_b16 a[218:219], v6 offset:46976
	v_lshlrev_b32 v70, 16, v71
	ds_read_b64_tr_b16 a[220:221], v6 offset:46496
	v_and_b32 v71, s67, v71
	v_lshlrev_b32 v72, 16, v76
	ds_read_b64_tr_b16 a[222:223], v6 offset:47008
	v_and_b32 v73, s67, v76
	v_lshlrev_b32 v74, 16, v77
	ds_read_b64_tr_b16 a[224:225], v6 offset:50688
	v_and_b32 v75, s67, v77
	ds_read_b64_tr_b16 a[226:227], v6 offset:51200
	v_lshlrev_b32 v76, 16, v78
	v_and_b32 v77, s67, v78
	ds_read_b64_tr_b16 a[228:229], v6 offset:50720
	v_lshlrev_b32 v78, 16, v79
	ds_read_b64_tr_b16 a[230:231], v6 offset:51232
	v_and_b32 v79, s67, v79
	v_lshlrev_b32 v80, 16, v84
	ds_read_b64_tr_b16 a[232:233], v6 offset:54912
	v_and_b32 v81, s67, v84
	ds_read_b64_tr_b16 a[234:235], v6 offset:55424
	v_lshlrev_b32 v82, 16, v85
	v_and_b32 v83, s67, v85
	ds_read_b64_tr_b16 a[236:237], v6 offset:54944
	v_lshlrev_b32 v84, 16, v86
	ds_read_b64_tr_b16 a[238:239], v6 offset:55456
	v_and_b32 v85, s67, v86
	v_lshlrev_b32 v86, 16, v87
	ds_read_b64_tr_b16 a[240:241], v6 offset:59136
	v_and_b32 v87, s67, v87
	s_lshl_b32 s54, s50, 7
	ds_read_b64_tr_b16 a[242:243], v6 offset:59648
	s_lshl_b32 s55, s51, 3
	ds_read_b64_tr_b16 a[244:245], v6 offset:59168
	s_add_u32 s54, s54, s55
	s_add_u32 s54, s54, 28672
	ds_read_b64_tr_b16 a[246:247], v6 offset:59680
	v_mov_b32 v242, s54
	ds_read_b64_tr_b16 a[248:249], v6 offset:63360
	s_lshr_b32 s54, s52, 1
	s_lshl_b32 s54, s54, 6
	ds_read_b64_tr_b16 a[250:251], v6 offset:63872
	s_and_b32 s55, s52, 1
	ds_read_b64_tr_b16 a[252:253], v6 offset:63392
	s_lshl_b32 s55, s55, 2
	s_add_u32 s54, s54, s55
	ds_read_b64_tr_b16 a[254:255], v6 offset:63904
	v_add_u32 v242, s54, v242
	ds_read_b64_tr_b16 v[128:129], v7 offset:0
	ds_read_b64_tr_b16 v[130:131], v7 offset:512
	ds_read_b64_tr_b16 v[132:133], v7 offset:32
	ds_read_b64_tr_b16 v[134:135], v7 offset:544
	ds_read_b64_tr_b16 v[136:137], v7 offset:4224
	ds_read_b64_tr_b16 v[138:139], v7 offset:4736
	ds_read_b64_tr_b16 v[140:141], v7 offset:4256
	ds_read_b64_tr_b16 v[142:143], v7 offset:4768
	ds_read_b64_tr_b16 v[144:145], v7 offset:8448
	ds_read_b64_tr_b16 v[146:147], v7 offset:8960
	ds_read_b64_tr_b16 v[148:149], v7 offset:8480
	ds_read_b64_tr_b16 v[150:151], v7 offset:8992
	ds_read_b64_tr_b16 v[152:153], v7 offset:12672
	ds_read_b64_tr_b16 v[154:155], v7 offset:13184
	s_lshl_b32 s56, s50, 2
	s_add_u32 s56, s56, s52
	s_lshl_b32 s56, s56, 14
	s_add_u32 s56, s56, 1048576
	s_waitcnt vmcnt(0)
	v_cmp_ne_u32 vcc, s53, v4
	s_cbranch_vccz ok_10
	s_mov_b32 s58, 200000
poll_11:
	buffer_load_dword v4, v13, s[44:47], 0 offen sc1
	s_waitcnt vmcnt(0)
	v_cmp_ne_u32 vcc, s53, v4
	s_cbranch_vccz pdone_12
	s_sub_u32 s58, s58, 1
	s_cbranch_scc0 poll_11
pdone_12:
ok_10:
	buffer_load_dwordx4 v[160:163], v5, s[44:47], s56 offen offset:0 sc1
	ds_read_b64_tr_b16 a[64:65], v3 offset:48576
	buffer_load_dwordx4 v[164:167], v5, s[44:47], s56 offen offset:1024 sc1
	ds_read_b64_tr_b16 a[66:67], v3 offset:49600
	buffer_load_dwordx4 v[168:171], v5, s[44:47], s56 offen offset:2048 sc1
	ds_read_b64_tr_b16 a[68:69], v3 offset:49088
	buffer_load_dwordx4 v[172:175], v5, s[44:47], s56 offen offset:3072 sc1
	ds_read_b64_tr_b16 a[70:71], v3 offset:50112
	s_add_u32 s56, s56, 4096
	buffer_load_dwordx4 v[176:179], v5, s[44:47], s56 offen offset:0 sc1
	buffer_load_dwordx4 v[180:183], v5, s[44:47], s56 offen offset:1024 sc1
	ds_read_b64_tr_b16 a[72:73], v3 offset:50688
	buffer_load_dwordx4 v[184:187], v5, s[44:47], s56 offen offset:2048 sc1
	ds_read_b64_tr_b16 a[74:75], v3 offset:51712
	buffer_load_dwordx4 v[188:191], v5, s[44:47], s56 offen offset:3072 sc1
	ds_read_b64_tr_b16 a[76:77], v3 offset:51200
	s_add_u32 s56, s56, 4096
	buffer_load_dwordx4 v[192:195], v5, s[44:47], s56 offen offset:0 sc1
	ds_read_b64_tr_b16 a[78:79], v3 offset:52224
	s_waitcnt vmcnt(8)
	v_mfma_f32_16x16x32_bf16 v[88:91], a[128:131], v[160:163], 0
	buffer_load_dwordx4 v[196:199], v5, s[44:47], s56 offen offset:1024 sc1
	v_mfma_f32_16x16x32_bf16 v[92:95], a[132:135], v[160:163], 0
	s_waitcnt lgkmcnt(15)
	v_mfma_f32_16x16x32_bf16 v[96:99], v[128:131], v[160:163], 0
	ds_read_b64_tr_b16 v[156:157], v7 offset:12704
	ds_read_b64_tr_b16 v[158:159], v7 offset:13216
	v_mfma_f32_16x16x32_bf16 v[100:103], v[132:135], v[160:163], 0
	ds_read_b64_tr_b16 v[128:129], v7 offset:16896
	ds_read_b64_tr_b16 v[130:131], v7 offset:17408
	s_waitcnt vmcnt(8)
	v_mfma_f32_16x16x32_bf16 v[88:91], a[136:139], v[164:167], v[88:91]
	buffer_load_dwordx4 v[200:203], v5, s[44:47], s56 offen offset:2048 sc1
	v_mfma_f32_16x16x32_bf16 v[92:95], a[140:143], v[164:167], v[92:95]
	s_waitcnt lgkmcnt(15)
	v_mfma_f32_16x16x32_bf16 v[96:99], v[136:139], v[164:167], v[96:99]
	ds_read_b64_tr_b16 v[132:133], v7 offset:16928
	ds_read_b64_tr_b16 v[134:135], v7 offset:17440
	v_mfma_f32_16x16x32_bf16 v[100:103], v[140:143], v[164:167], v[100:103]
	ds_read_b64_tr_b16 v[136:137], v7 offset:21120
	ds_read_b64_tr_b16 v[138:139], v7 offset:21632
	s_waitcnt vmcnt(8)
	v_mfma_f32_16x16x32_bf16 v[88:91], a[144:147], v[168:171], v[88:91]
	buffer_load_dwordx4 v[204:207], v5, s[44:47], s56 offen offset:3072 sc1
	v_mfma_f32_16x16x32_bf16 v[92:95], a[148:151], v[168:171], v[92:95]
	s_waitcnt lgkmcnt(15)
	v_mfma_f32_16x16x32_bf16 v[96:99], v[144:147], v[168:171], v[96:99]
	ds_read_b64_tr_b16 v[140:141], v7 offset:21152
	ds_read_b64_tr_b16 v[142:143], v7 offset:21664
	v_mfma_f32_16x16x32_bf16 v[100:103], v[148:151], v[168:171], v[100:103]
	ds_read_b64_tr_b16 v[144:145], v7 offset:25344
	ds_read_b64_tr_b16 v[146:147], v7 offset:25856
	s_waitcnt vmcnt(8)
	v_mfma_f32_16x16x32_bf16 v[88:91], a[152:155], v[172:175], v[88:91]
	s_add_u32 s56, s56, 4096
	buffer_load_dwordx4 v[208:211], v5, s[44:47], s56 offen offset:0 sc1
	v_mfma_f32_16x16x32_bf16 v[92:95], a[156:159], v[172:175], v[92:95]
	s_waitcnt lgkmcnt(10)
	v_mfma_f32_16x16x32_bf16 v[96:99], v[152:155], v[172:175], v[96:99]
	ds_read_b64_tr_b16 v[148:149], v7 offset:25376
	ds_read_b64_tr_b16 v[150:151], v7 offset:25888
	v_mfma_f32_16x16x32_bf16 v[100:103], v[156:159], v[172:175], v[100:103]
	ds_read_b64_tr_b16 v[152:153], v7 offset:29568
	ds_read_b64_tr_b16 v[154:155], v7 offset:30080
	s_waitcnt vmcnt(8)
	v_mfma_f32_16x16x32_bf16 v[88:91], a[160:163], v[176:179], v[88:91]
	buffer_load_dwordx4 v[212:215], v5, s[44:47], s56 offen offset:1024 sc1
	v_mfma_f32_16x16x32_bf16 v[92:95], a[164:167], v[176:179], v[92:95]
	s_waitcnt lgkmcnt(10)
	v_mfma_f32_16x16x32_bf16 v[96:99], v[128:131], v[176:179], v[96:99]
	ds_read_b64_tr_b16 v[156:157], v7 offset:29600
	ds_read_b64_tr_b16 v[158:159], v7 offset:30112
	v_mfma_f32_16x16x32_bf16 v[100:103], v[132:135], v[176:179], v[100:103]
	ds_read_b64_tr_b16 v[128:129], v7 offset:33792
	ds_read_b64_tr_b16 v[130:131], v7 offset:34304
	s_waitcnt vmcnt(8)
	v_mfma_f32_16x16x32_bf16 v[88:91], a[168:171], v[180:183], v[88:91]
	buffer_load_dwordx4 v[216:219], v5, s[44:47], s56 offen offset:2048 sc1
	v_mfma_f32_16x16x32_bf16 v[92:95], a[172:175], v[180:183], v[92:95]
	s_waitcnt lgkmcnt(10)
	v_mfma_f32_16x16x32_bf16 v[96:99], v[136:139], v[180:183], v[96:99]
	ds_read_b64_tr_b16 v[132:133], v7 offset:33824
	ds_read_b64_tr_b16 v[134:135], v7 offset:34336
	v_mfma_f32_16x16x32_bf16 v[100:103], v[140:143], v[180:183], v[100:103]
	ds_read_b64_tr_b16 v[136:137], v7 offset:38016
	ds_read_b64_tr_b16 v[138:139], v7 offset:38528
	s_waitcnt vmcnt(8)
	v_mfma_f32_16x16x32_bf16 v[88:91], a[176:179], v[184:187], v[88:91]
	buffer_load_dwordx4 v[220:223], v5, s[44:47], s56 offen offset:3072 sc1
	v_mfma_f32_16x16x32_bf16 v[92:95], a[180:183], v[184:187], v[92:95]
	s_waitcnt lgkmcnt(10)
	v_mfma_f32_16x16x32_bf16 v[96:99], v[144:147], v[184:187], v[96:99]
	ds_read_b64_tr_b16 v[140:141], v7 offset:38048
	ds_read_b64_tr_b16 v[142:143], v7 offset:38560
	v_mfma_f32_16x16x32_bf16 v[100:103], v[148:151], v[184:187], v[100:103]
	ds_read_b64_tr_b16 v[144:145], v7 offset:42240
	ds_read_b64_tr_b16 v[146:147], v7 offset:42752
	s_waitcnt vmcnt(8)
	v_mfma_f32_16x16x32_bf16 v[88:91], a[184:187], v[188:191], v[88:91]
	v_mfma_f32_16x16x32_bf16 v[92:95], a[188:191], v[188:191], v[92:95]
	s_waitcnt lgkmcnt(10)
	v_mfma_f32_16x16x32_bf16 v[96:99], v[152:155], v[188:191], v[96:99]
	ds_read_b64_tr_b16 v[148:149], v7 offset:42272
	ds_read_b64_tr_b16 v[150:151], v7 offset:42784
	v_mfma_f32_16x16x32_bf16 v[100:103], v[156:159], v[188:191], v[100:103]
	ds_read_b64_tr_b16 v[152:153], v7 offset:46464
	ds_read_b64_tr_b16 v[154:155], v7 offset:46976
	s_waitcnt vmcnt(7)
	v_mfma_f32_16x16x32_bf16 v[88:91], a[192:195], v[192:195], v[88:91]
	v_mfma_f32_16x16x32_bf16 v[92:95], a[196:199], v[192:195], v[92:95]
	s_add_u32 m0, s0, 6336
	s_waitcnt lgkmcnt(10)
	v_mfma_f32_16x16x32_bf16 v[96:99], v[128:131], v[192:195], v[96:99]
	ds_read_b64_tr_b16 v[156:157], v7 offset:46496
	ds_read_b64_tr_b16 v[158:159], v7 offset:47008
	s_mov_b32 s1, 1490944
	v_mfma_f32_16x16x32_bf16 v[100:103], v[132:135], v[192:195], v[100:103]
	ds_read_b64_tr_b16 v[128:129], v7 offset:50688
	ds_read_b64_tr_b16 v[130:131], v7 offset:51200
	buffer_load_dwordx4 v1, s[16:19], s1 offen lds
	s_waitcnt vmcnt(7)
	v_mfma_f32_16x16x32_bf16 v[88:91], a[200:203], v[196:199], v[88:91]
	buffer_load_dwordx4 v2, s[16:19], s1 offen offset:1024 lds
	v_mfma_f32_16x16x32_bf16 v[92:95], a[204:207], v[196:199], v[92:95]
	s_waitcnt lgkmcnt(10)
	v_mfma_f32_16x16x32_bf16 v[96:99], v[136:139], v[196:199], v[96:99]
	ds_read_b64_tr_b16 v[132:133], v7 offset:50720
	ds_read_b64_tr_b16 v[134:135], v7 offset:51232
	s_add_u32 m0, s0, 8448
	v_mfma_f32_16x16x32_bf16 v[100:103], v[140:143], v[196:199], v[100:103]
	ds_read_b64_tr_b16 v[136:137], v7 offset:54912
	ds_read_b64_tr_b16 v[138:139], v7 offset:55424
	s_mov_b32 s1, 1605632
	s_waitcnt vmcnt(7)
	v_mfma_f32_16x16x32_bf16 v[88:91], a[208:211], v[200:203], v[88:91]
	buffer_load_dwordx4 v1, s[16:19], s1 offen lds
	v_mfma_f32_16x16x32_bf16 v[92:95], a[212:215], v[200:203], v[92:95]
	buffer_load_dwordx4 v2, s[16:19], s1 offen offset:1024 lds
	s_waitcnt lgkmcnt(10)
	v_mfma_f32_16x16x32_bf16 v[96:99], v[144:147], v[200:203], v[96:99]
	ds_read_b64_tr_b16 v[140:141], v7 offset:54944
	ds_read_b64_tr_b16 v[142:143], v7 offset:55456
	v_mfma_f32_16x16x32_bf16 v[100:103], v[148:151], v[200:203], v[100:103]
	ds_read_b64_tr_b16 v[144:145], v7 offset:59136
	ds_read_b64_tr_b16 v[146:147], v7 offset:59648
	s_add_u32 m0, s0, 42240
	s_waitcnt vmcnt(8)
	v_mfma_f32_16x16x32_bf16 v[88:91], a[216:219], v[204:207], v[88:91]
	s_mov_b32 s1, 1720320
	v_mfma_f32_16x16x32_bf16 v[92:95], a[220:223], v[204:207], v[92:95]
	buffer_load_dwordx4 v1, s[16:19], s1 offen lds
	s_waitcnt lgkmcnt(10)
	v_mfma_f32_16x16x32_bf16 v[96:99], v[152:155], v[204:207], v[96:99]
	ds_read_b64_tr_b16 v[148:149], v7 offset:59168
	ds_read_b64_tr_b16 v[150:151], v7 offset:59680
	buffer_load_dwordx4 v2, s[16:19], s1 offen offset:1024 lds
	v_mfma_f32_16x16x32_bf16 v[100:103], v[156:159], v[204:207], v[100:103]
	ds_read_b64_tr_b16 v[152:153], v7 offset:63360
	ds_read_b64_tr_b16 v[154:155], v7 offset:63872
	s_waitcnt vmcnt(9)
	v_mfma_f32_16x16x32_bf16 v[88:91], a[224:227], v[208:211], v[88:91]
	v_mfma_f32_16x16x32_bf16 v[92:95], a[228:231], v[208:211], v[92:95]
	s_add_u32 m0, s0, 44352
	s_waitcnt lgkmcnt(10)
	v_mfma_f32_16x16x32_bf16 v[96:99], v[128:131], v[208:211], v[96:99]
	ds_read_b64_tr_b16 v[156:157], v7 offset:63392
	ds_read_b64_tr_b16 v[158:159], v7 offset:63904
	s_mov_b32 s1, 0
	v_mfma_f32_16x16x32_bf16 v[100:103], v[132:135], v[208:211], v[100:103]
	buffer_load_dwordx4 v10, s[24:27], s1 offen lds
	s_waitcnt vmcnt(9)
	v_mfma_f32_16x16x32_bf16 v[88:91], a[232:235], v[212:215], v[88:91]
	buffer_load_dwordx4 v23, s[24:27], s1 offen offset:1056 lds
	v_mfma_f32_16x16x32_bf16 v[92:95], a[236:239], v[212:215], v[92:95]
	s_waitcnt lgkmcnt(8)
	v_mfma_f32_16x16x32_bf16 v[96:99], v[136:139], v[212:215], v[96:99]
	ds_read_b64_tr_b16 a[80:81], v3 offset:0
	v_mfma_f32_16x16x32_bf16 v[100:103], v[140:143], v[212:215], v[100:103]
	ds_read_b64_tr_b16 a[82:83], v3 offset:1024
	s_waitcnt vmcnt(9)
	v_mfma_f32_16x16x32_bf16 v[88:91], a[240:243], v[216:219], v[88:91]
	ds_read_b64_tr_b16 a[84:85], v3 offset:512
	v_mfma_f32_16x16x32_bf16 v[92:95], a[244:247], v[216:219], v[92:95]
	ds_read_b64_tr_b16 a[86:87], v3 offset:1536
	s_waitcnt lgkmcnt(8)
	v_mfma_f32_16x16x32_bf16 v[96:99], v[144:147], v[216:219], v[96:99]
	v_mfma_f32_16x16x32_bf16 v[100:103], v[148:151], v[216:219], v[100:103]
	ds_read_b64_tr_b16 a[88:89], v3 offset:2112
	s_waitcnt vmcnt(8)
	v_mfma_f32_16x16x32_bf16 v[88:91], a[248:251], v[220:223], v[88:91]
	ds_read_b64_tr_b16 a[90:91], v3 offset:3136
	v_mfma_f32_16x16x32_bf16 v[92:95], a[252:255], v[220:223], v[92:95]
	ds_read_b64_tr_b16 a[92:93], v3 offset:2624
	s_waitcnt lgkmcnt(7)
	v_mfma_f32_16x16x32_bf16 v[96:99], v[152:155], v[220:223], v[96:99]
	ds_read_b64_tr_b16 a[94:95], v3 offset:3648
	v_mfma_f32_16x16x32_bf16 v[100:103], v[156:159], v[220:223], v[100:103]
	v_pk_fma_f32 v[24:25], v[88:89], v[40:41], v[24:25]
	v_pk_fma_f32 v[26:27], v[90:91], v[42:43], v[26:27]
	v_pk_fma_f32 v[28:29], v[92:93], v[44:45], v[28:29]
	v_pk_fma_f32 v[30:31], v[94:95], v[46:47], v[30:31]
	s_nop 0
	v_pk_fma_f32 v[32:33], v[96:97], v[48:49], v[32:33]
	v_pk_fma_f32 v[34:35], v[98:99], v[50:51], v[34:35]
	s_nop 0
	v_pk_fma_f32 v[36:37], v[100:101], v[52:53], v[36:37]
	v_pk_fma_f32 v[38:39], v[102:103], v[54:55], v[38:39]
	v_pk_mul_f32 v[224:225], v[24:25], v[56:57]
	v_pk_mul_f32 v[226:227], v[26:27], v[58:59]
	v_pk_mul_f32 v[228:229], v[28:29], v[60:61]
	v_pk_mul_f32 v[230:231], v[30:31], v[62:63]
	v_pk_mul_f32 v[232:233], v[32:33], v[64:65]
	v_pk_mul_f32 v[234:235], v[34:35], v[66:67]
	v_pk_mul_f32 v[236:237], v[36:37], v[68:69]
	v_pk_mul_f32 v[238:239], v[38:39], v[70:71]
	v_cvt_pk_bf16_f32 v88, v224, v225
	v_cvt_pk_bf16_f32 v89, v226, v227
	v_cvt_pk_bf16_f32 v90, v228, v229
	v_cvt_pk_bf16_f32 v91, v230, v231
	v_cvt_pk_bf16_f32 v92, v232, v233
	v_cvt_pk_bf16_f32 v93, v234, v235
	v_cvt_pk_bf16_f32 v94, v236, v237
	v_cvt_pk_bf16_f32 v95, v238, v239
	buffer_store_dwordx4 v[88:91], v240, s[44:47], 0 offen sc1
	buffer_store_dwordx4 v[92:95], v240, s[44:47], 0 offen offset:2048 sc1
	v_pk_mul_f32 v[130:131], v[24:25], v[24:25]
	v_pk_mul_f32 v[134:135], v[224:225], v[224:225]
	v_pk_mul_f32 v[136:137], v[224:225], v[56:57]
	v_pk_mul_f32 v[138:139], v[224:225], v[72:73]
	v_pk_add_f32 v[128:129], v[26:27], v[24:25]
	v_pk_fma_f32 v[130:131], v[26:27], v[26:27], v[130:131]
	v_pk_add_f32 v[132:133], v[226:227], v[224:225]
	v_pk_fma_f32 v[134:135], v[226:227], v[226:227], v[134:135]
	v_pk_fma_f32 v[136:137], v[226:227], v[58:59], v[136:137]
	v_pk_fma_f32 v[138:139], v[226:227], v[74:75], v[138:139]
	v_pk_add_f32 v[128:129], v[28:29], v[128:129]
	v_pk_fma_f32 v[130:131], v[28:29], v[28:29], v[130:131]
	v_pk_add_f32 v[132:133], v[228:229], v[132:133]
	v_pk_fma_f32 v[134:135], v[228:229], v[228:229], v[134:135]
	v_pk_fma_f32 v[136:137], v[228:229], v[60:61], v[136:137]
	v_pk_fma_f32 v[138:139], v[228:229], v[76:77], v[138:139]
	v_pk_add_f32 v[128:129], v[30:31], v[128:129]
	v_pk_fma_f32 v[130:131], v[30:31], v[30:31], v[130:131]
	v_pk_add_f32 v[132:133], v[230:231], v[132:133]
	v_pk_fma_f32 v[134:135], v[230:231], v[230:231], v[134:135]
	v_pk_fma_f32 v[136:137], v[230:231], v[62:63], v[136:137]
	v_pk_fma_f32 v[138:139], v[230:231], v[78:79], v[138:139]
	v_pk_add_f32 v[128:129], v[32:33], v[128:129]
	v_pk_fma_f32 v[130:131], v[32:33], v[32:33], v[130:131]
	v_pk_add_f32 v[132:133], v[232:233], v[132:133]
	v_pk_fma_f32 v[134:135], v[232:233], v[232:233], v[134:135]
	v_pk_fma_f32 v[136:137], v[232:233], v[64:65], v[136:137]
	v_pk_fma_f32 v[138:139], v[232:233], v[80:81], v[138:139]
	v_pk_add_f32 v[128:129], v[34:35], v[128:129]
	v_pk_fma_f32 v[130:131], v[34:35], v[34:35], v[130:131]
	v_pk_add_f32 v[132:133], v[234:235], v[132:133]
	v_pk_fma_f32 v[134:135], v[234:235], v[234:235], v[134:135]
	v_pk_fma_f32 v[136:137], v[234:235], v[66:67], v[136:137]
	v_pk_fma_f32 v[138:139], v[234:235], v[82:83], v[138:139]
	v_pk_add_f32 v[128:129], v[36:37], v[128:129]
	v_pk_fma_f32 v[130:131], v[36:37], v[36:37], v[130:131]
	v_pk_add_f32 v[132:133], v[236:237], v[132:133]
	v_pk_fma_f32 v[134:135], v[236:237], v[236:237], v[134:135]
	v_pk_fma_f32 v[136:137], v[236:237], v[68:69], v[136:137]
	v_pk_fma_f32 v[138:139], v[236:237], v[84:85], v[138:139]
	v_pk_add_f32 v[128:129], v[38:39], v[128:129]
	v_pk_fma_f32 v[130:131], v[38:39], v[38:39], v[130:131]
	v_pk_add_f32 v[132:133], v[238:239], v[132:133]
	v_pk_fma_f32 v[134:135], v[238:239], v[238:239], v[134:135]
	v_pk_fma_f32 v[136:137], v[238:239], v[70:71], v[136:137]
	v_pk_fma_f32 v[138:139], v[238:239], v[86:87], v[138:139]
	v_add_f32 v96, v128, v129
	v_add_f32 v97, v130, v131
	v_add_f32 v98, v132, v133
	v_add_f32 v99, v134, v135
	v_add_f32 v100, v136, v137
	v_add_f32 v101, v138, v139
	v_permlane32_swap_b32 v96, v97
	v_permlane32_swap_b32 v98, v99
	v_permlane32_swap_b32 v100, v101
	v_add_f32 v16, v96, v97
	v_add_f32 v17, v98, v99
	v_add_f32 v18, v100, v101
	v_mov_b32 v100, v16
	v_mov_b32 v101, v17
	v_mov_b32 v102, v18
	v_permlane16_swap_b32 v16, v100
	v_permlane16_swap_b32 v17, v101
	v_permlane16_swap_b32 v18, v102
	v_add_f32 v16, v16, v100
	v_add_f32 v17, v17, v101
	v_add_f32 v18, v18, v102
	buffer_store_dwordx4 v[16:19], v241, s[44:47], 0 offen sc1
	s_add_u32 m0, s0, 46464
	s_mov_b32 s1, 16384
	buffer_load_dwordx4 v10, s[24:27], s1 offen lds
	buffer_load_dwordx4 v23, s[24:27], s1 offen offset:1056 lds
	s_add_u32 m0, s0, 48576
	s_mov_b32 s1, 32768
	buffer_load_dwordx4 v10, s[24:27], s1 offen lds
	buffer_load_dwordx4 v23, s[24:27], s1 offen offset:1056 lds
	s_add_u32 m0, s0, 50688
	s_mov_b32 s1, 49152
	buffer_load_dwordx4 v10, s[24:27], s1 offen lds
	buffer_load_dwordx4 v23, s[24:27], s1 offen offset:1056 lds
	ds_read_b64_tr_b16 a[96:97], v3 offset:4224
	ds_read_b64_tr_b16 a[98:99], v3 offset:5248
	ds_read_b64_tr_b16 a[100:101], v3 offset:4736
	ds_read_b64_tr_b16 a[102:103], v3 offset:5760
	s_waitcnt vmcnt(15)
	ds_read_b64_tr_b16 a[104:105], v3 offset:6336
	ds_read_b64_tr_b16 a[106:107], v3 offset:7360
	ds_read_b64_tr_b16 a[108:109], v3 offset:6848
	ds_read_b64_tr_b16 a[110:111], v3 offset:7872
	s_waitcnt vmcnt(13)
	ds_read_b64_tr_b16 a[112:113], v3 offset:8448
	ds_read_b64_tr_b16 a[114:115], v3 offset:9472
	ds_read_b64_tr_b16 a[116:117], v3 offset:8960
	ds_read_b64_tr_b16 a[118:119], v3 offset:9984
	s_waitcnt vmcnt(11)
	ds_read_b64_tr_b16 a[120:121], v3 offset:42240
	ds_read_b64_tr_b16 a[122:123], v3 offset:43264
	ds_read_b64_tr_b16 a[124:125], v3 offset:42752
	ds_read_b64_tr_b16 a[126:127], v3 offset:43776
	s_lshl_b32 s54, s52, 10
	s_add_u32 s54, s54, 32768
	v_add_u32 v40, s54, v5
	v_bfe_u32 v41, v0, 4, 1
	v_lshlrev_b32 v41, 10, v41
	v_lshrrev_b32 v42, 5, v0
	v_lshl_add_u32 v41, v42, 8, v41
	v_and_b32 v43, 15, v0
	v_lshl_add_u32 v41, v43, 4, v41
	s_lshl_b32 s54, s52, 12
	s_add_u32 s54, s54, 32768
	v_add_u32 v41, s54, v41
	v_and_b32 v49, 3, v0
	v_lshlrev_b32 v51, 2, v49
	s_mov_b32 s54, 0x5412
	v_lshrrev_b32 v51, v51, s54
	v_and_b32 v51, 7, v51
	v_lshrrev_b32 v52, 2, v0
	v_xor_b32 v52, v52, v21
	v_and_b32 v52, 1, v52
	v_cmp_eq_u32 vcc, 0, v52
	s_nop 1
	v_cndmask_b32 v51, 5, v51, vcc
	v_lshlrev_b32 v51, 10, v51
	v_lshl_add_u32 v51, v42, 4, v51
	v_add_u32 v9, 157440, v51
	v_add_u32 v43, 157440, v5
	s_barrier
	ds_write_b128 v40, v[24:27] offset:0
	ds_write_b128 v40, v[28:31] offset:4096
	ds_write_b128 v40, v[32:35] offset:8192
	ds_write_b128 v40, v[36:39] offset:12288
	ds_read_b128 v[44:47], v43 offset:2048
	ds_read_b128 v[48:51], v43 offset:1024
	ds_read_b128 v[224:227], v9 offset:0
	ds_read_b128 v[228:231], v9 offset:32
	ds_read_b128 v[232:235], v9 offset:64
	ds_read_b128 v[236:239], v9 offset:96
	s_waitcnt lgkmcnt(3)
	v_mfma_f32_16x16x32_bf16 v[120:123], v[224:227], a[0:3], 0
	ds_read_b128 v[224:227], v9 offset:128
	s_waitcnt lgkmcnt(3)
	v_mfma_f32_16x16x32_bf16 v[124:127], v[228:231], a[4:7], 0
	ds_read_b128 v[228:231], v9 offset:160
	s_waitcnt lgkmcnt(3)
	v_mfma_f32_16x16x32_bf16 v[120:123], v[232:235], a[8:11], v[120:123]
	ds_read_b128 v[232:235], v9 offset:192
	s_waitcnt lgkmcnt(3)
	v_mfma_f32_16x16x32_bf16 v[124:127], v[236:239], a[12:15], v[124:127]
	ds_read_b128 v[236:239], v9 offset:224
	s_waitcnt lgkmcnt(3)
	v_mfma_f32_16x16x32_bf16 v[120:123], v[224:227], a[16:19], v[120:123]
	ds_read_b128 v[224:227], v9 offset:256
	s_waitcnt lgkmcnt(3)
	v_mfma_f32_16x16x32_bf16 v[124:127], v[228:231], a[20:23], v[124:127]
	ds_read_b128 v[228:231], v9 offset:288
	s_waitcnt lgkmcnt(3)
	v_mfma_f32_16x16x32_bf16 v[120:123], v[232:235], a[24:27], v[120:123]
	ds_read_b128 v[232:235], v9 offset:320
	s_waitcnt lgkmcnt(3)
	v_mfma_f32_16x16x32_bf16 v[124:127], v[236:239], a[28:31], v[124:127]
	ds_read_b128 v[236:239], v9 offset:352
	s_waitcnt lgkmcnt(3)
	v_mfma_f32_16x16x32_bf16 v[120:123], v[224:227], a[32:35], v[120:123]
	ds_read_b128 v[224:227], v9 offset:384
	s_waitcnt lgkmcnt(3)
	v_mfma_f32_16x16x32_bf16 v[124:127], v[228:231], a[36:39], v[124:127]
	ds_read_b128 v[228:231], v9 offset:416
	s_waitcnt lgkmcnt(3)
	v_mfma_f32_16x16x32_bf16 v[120:123], v[232:235], a[40:43], v[120:123]
	ds_read_b128 v[232:235], v9 offset:448
	s_waitcnt lgkmcnt(3)
	v_mfma_f32_16x16x32_bf16 v[124:127], v[236:239], a[44:47], v[124:127]
	ds_read_b128 v[236:239], v9 offset:480
	s_waitcnt lgkmcnt(3)
	v_mfma_f32_16x16x32_bf16 v[120:123], v[224:227], a[48:51], v[120:123]
	ds_read_b128 v[224:227], v9 offset:512
	s_waitcnt lgkmcnt(3)
	v_mfma_f32_16x16x32_bf16 v[124:127], v[228:231], a[52:55], v[124:127]
	s_waitcnt vmcnt(6)
	buffer_store_dword v8, v242, s[44:47], 0 offen
	ds_read_b128 v[228:231], v9 offset:544
	s_waitcnt lgkmcnt(3)
	v_mfma_f32_16x16x32_bf16 v[120:123], v[232:235], a[56:59], v[120:123]
	ds_read_b128 v[232:235], v9 offset:576
	s_waitcnt lgkmcnt(3)
	v_mfma_f32_16x16x32_bf16 v[124:127], v[236:239], a[60:63], v[124:127]
	s_add_u32 m0, s0, 42240
	ds_read_b128 v[236:239], v9 offset:608
	s_waitcnt lgkmcnt(3)
	v_mfma_f32_16x16x32_bf16 v[120:123], v[224:227], a[64:67], v[120:123]
	s_mov_b32 s1, 65536
	ds_read_b128 v[224:227], v9 offset:640
	s_waitcnt lgkmcnt(3)
	v_mfma_f32_16x16x32_bf16 v[124:127], v[228:231], a[68:71], v[124:127]
	buffer_load_dwordx4 v10, s[24:27], s1 offen lds
	ds_read_b128 v[228:231], v9 offset:672
	s_waitcnt lgkmcnt(3)
	v_mfma_f32_16x16x32_bf16 v[120:123], v[232:235], a[72:75], v[120:123]
	buffer_load_dwordx4 v23, s[24:27], s1 offen offset:1056 lds
	ds_read_b128 v[232:235], v9 offset:704
	s_waitcnt lgkmcnt(3)
	v_mfma_f32_16x16x32_bf16 v[124:127], v[236:239], a[76:79], v[124:127]
	ds_read_b128 v[236:239], v9 offset:736
	s_waitcnt lgkmcnt(3)
	v_mfma_f32_16x16x32_bf16 v[120:123], v[224:227], a[80:83], v[120:123]
	ds_read_b128 v[224:227], v9 offset:768
	s_waitcnt lgkmcnt(3)
	v_mfma_f32_16x16x32_bf16 v[124:127], v[228:231], a[84:87], v[124:127]
	ds_read_b64_tr_b16 a[128:129], v11 offset:44352
	ds_read_b128 v[228:231], v9 offset:800
	s_waitcnt lgkmcnt(4)
	v_mfma_f32_16x16x32_bf16 v[120:123], v[232:235], a[88:91], v[120:123]
	ds_read_b64_tr_b16 a[130:131], v11 offset:45408
	ds_read_b128 v[232:235], v9 offset:832
	s_waitcnt lgkmcnt(5)
	v_mfma_f32_16x16x32_bf16 v[124:127], v[236:239], a[92:95], v[124:127]
	ds_read_b64_tr_b16 a[132:133], v12 offset:44352
	ds_read_b128 v[236:239], v9 offset:864
	s_waitcnt lgkmcnt(6)
	v_mfma_f32_16x16x32_bf16 v[120:123], v[224:227], a[96:99], v[120:123]
	ds_read_b64_tr_b16 a[134:135], v12 offset:45408
	ds_read_b128 v[224:227], v9 offset:896
	s_waitcnt lgkmcnt(6)
	v_mfma_f32_16x16x32_bf16 v[124:127], v[228:231], a[100:103], v[124:127]
	ds_read_b128 v[228:231], v9 offset:928
	s_waitcnt lgkmcnt(5)
	v_mfma_f32_16x16x32_bf16 v[120:123], v[232:235], a[104:107], v[120:123]
	s_waitcnt vmcnt(7)
	ds_read_b128 v[232:235], v9 offset:960
	s_waitcnt lgkmcnt(4)
	v_mfma_f32_16x16x32_bf16 v[124:127], v[236:239], a[108:111], v[124:127]
	ds_read_b64_tr_b16 a[136:137], v11 offset:46464
	ds_read_b128 v[236:239], v9 offset:992
	s_waitcnt lgkmcnt(4)
	v_mfma_f32_16x16x32_bf16 v[120:123], v[224:227], a[112:115], v[120:123]
	ds_read_b64_tr_b16 a[138:139], v11 offset:47520
	s_waitcnt lgkmcnt(4)
	v_mfma_f32_16x16x32_bf16 v[124:127], v[228:231], a[116:119], v[124:127]
	ds_read_b64_tr_b16 a[140:141], v12 offset:46464
	s_waitcnt lgkmcnt(4)
	v_mfma_f32_16x16x32_bf16 v[120:123], v[232:235], a[120:123], v[120:123]
	ds_read_b64_tr_b16 a[142:143], v12 offset:47520
	s_waitcnt lgkmcnt(3)
	v_mfma_f32_16x16x32_bf16 v[124:127], v[236:239], a[124:127], v[124:127]
	s_mov_b32 s54, 0x3f803f80
	v_dot2_f32_bf16 v72, v44, s54, 0
	s_add_u32 m0, s0, 44352
	v_dot2_f32_bf16 v73, v44, v44, 0
	s_mov_b32 s1, 81920
	v_dot2_f32_bf16 v74, v48, s54, 0
	buffer_load_dwordx4 v10, s[24:27], s1 offen lds
	v_dot2_f32_bf16 v75, v48, v48, 0
	v_dot2_f32_bf16 v76, v44, v48, 0
	buffer_load_dwordx4 v23, s[24:27], s1 offen offset:1056 lds
	v_dot2_f32_bf16 v72, v45, s54, v72
	s_waitcnt vmcnt(7)
	v_dot2_f32_bf16 v73, v45, v45, v73
	ds_read_b64_tr_b16 a[144:145], v11 offset:48576
	v_dot2_f32_bf16 v74, v49, s54, v74
	ds_read_b64_tr_b16 a[146:147], v11 offset:49632
	v_dot2_f32_bf16 v75, v49, v49, v75
	ds_read_b64_tr_b16 a[148:149], v12 offset:48576
	v_dot2_f32_bf16 v76, v45, v49, v76
	v_dot2_f32_bf16 v72, v46, s54, v72
	ds_read_b64_tr_b16 a[150:151], v12 offset:49632
	v_dot2_f32_bf16 v73, v46, v46, v73
	s_waitcnt lgkmcnt(4)
	v_dot2_f32_bf16 v74, v50, s54, v74
	s_add_u32 m0, s0, 46464
	v_dot2_f32_bf16 v75, v50, v50, v75
	s_mov_b32 s1, 98304
	v_dot2_f32_bf16 v76, v46, v50, v76
	buffer_load_dwordx4 v10, s[24:27], s1 offen lds
	v_dot2_f32_bf16 v72, v47, s54, v72
	v_dot2_f32_bf16 v73, v47, v47, v73
	buffer_load_dwordx4 v23, s[24:27], s1 offen offset:1056 lds
	v_dot2_f32_bf16 v74, v51, s54, v74
	s_waitcnt vmcnt(7)
	v_dot2_f32_bf16 v75, v51, v51, v75
	ds_read_b64_tr_b16 a[152:153], v11 offset:50688
	v_dot2_f32_bf16 v76, v47, v51, v76
	ds_read_b64_tr_b16 a[154:155], v11 offset:51744
	v_add_f32_dpp v72, v72, v72 row_ror:8 row_mask:0xf bank_mask:0xf
	v_add_f32_dpp v73, v73, v73 row_ror:8 row_mask:0xf bank_mask:0xf
	ds_read_b64_tr_b16 a[156:157], v12 offset:50688
	v_add_f32_dpp v74, v74, v74 row_ror:8 row_mask:0xf bank_mask:0xf
	ds_read_b64_tr_b16 a[158:159], v12 offset:51744
	v_add_f32_dpp v75, v75, v75 row_ror:8 row_mask:0xf bank_mask:0xf
	s_waitcnt lgkmcnt(4)
	v_add_f32_dpp v76, v76, v76 row_ror:8 row_mask:0xf bank_mask:0xf
	s_add_u32 m0, s0, 48576
	v_add_f32_dpp v72, v72, v72 row_ror:4 row_mask:0xf bank_mask:0xf
	s_mov_b32 s1, 114688
	v_add_f32_dpp v73, v73, v73 row_ror:4 row_mask:0xf bank_mask:0xf
	v_add_f32_dpp v74, v74, v74 row_ror:4 row_mask:0xf bank_mask:0xf
	buffer_load_dwordx4 v10, s[24:27], s1 offen lds
	v_add_f32_dpp v75, v75, v75 row_ror:4 row_mask:0xf bank_mask:0xf
	buffer_load_dwordx4 v23, s[24:27], s1 offen offset:1056 lds
	v_add_f32_dpp v76, v76, v76 row_ror:4 row_mask:0xf bank_mask:0xf
	s_waitcnt vmcnt(6)
	v_add_f32_dpp v72, v72, v72 row_ror:2 row_mask:0xf bank_mask:0xf
	ds_read_b64_tr_b16 a[160:161], v11 offset:42240
	v_add_f32_dpp v73, v73, v73 row_ror:2 row_mask:0xf bank_mask:0xf
	ds_read_b64_tr_b16 a[162:163], v11 offset:43296
	v_add_f32_dpp v74, v74, v74 row_ror:2 row_mask:0xf bank_mask:0xf
	v_add_f32_dpp v75, v75, v75 row_ror:2 row_mask:0xf bank_mask:0xf
	ds_read_b64_tr_b16 a[164:165], v12 offset:42240
	v_add_f32_dpp v76, v76, v76 row_ror:2 row_mask:0xf bank_mask:0xf
	ds_read_b64_tr_b16 a[166:167], v12 offset:43296
	v_add_f32_dpp v72, v72, v72 row_ror:1 row_mask:0xf bank_mask:0xf
	s_waitcnt lgkmcnt(4)
	v_add_f32_dpp v73, v73, v73 row_ror:1 row_mask:0xf bank_mask:0xf
	s_add_u32 m0, s0, 50688
	v_add_f32_dpp v74, v74, v74 row_ror:1 row_mask:0xf bank_mask:0xf
	s_mov_b32 s1, 131072
	v_add_f32_dpp v75, v75, v75 row_ror:1 row_mask:0xf bank_mask:0xf
	v_add_f32_dpp v76, v76, v76 row_ror:1 row_mask:0xf bank_mask:0xf
	buffer_load_dwordx4 v10, s[24:27], s1 offen lds
	v_mov_b32 v80, v72
	buffer_load_dwordx4 v23, s[24:27], s1 offen offset:1056 lds
	v_mov_b32 v81, v73
	s_waitcnt vmcnt(6)
	v_mov_b32 v82, v74
	ds_read_b64_tr_b16 a[168:169], v11 offset:44352
	v_mov_b32 v83, v75
	v_mov_b32 v84, v76
	ds_read_b64_tr_b16 a[170:171], v11 offset:45408
	v_permlane16_swap_b32 v72, v80
	ds_read_b64_tr_b16 a[172:173], v12 offset:44352
	v_permlane16_swap_b32 v73, v81
	ds_read_b64_tr_b16 a[174:175], v12 offset:45408
	v_permlane16_swap_b32 v74, v82
	s_waitcnt lgkmcnt(4)
	v_permlane16_swap_b32 v75, v83
	s_add_u32 m0, s0, 42240
	v_permlane16_swap_b32 v76, v84
	v_add_f32 v72, v72, v80
	s_mov_b32 s1, 147456
	v_add_f32 v73, v73, v81
	buffer_load_dwordx4 v10, s[24:27], s1 offen lds
	v_add_f32 v74, v74, v82
	buffer_load_dwordx4 v23, s[24:27], s1 offen offset:1056 lds
	v_add_f32 v75, v75, v83
	s_waitcnt vmcnt(6)
	v_add_f32 v76, v76, v84
	ds_read_b64_tr_b16 a[176:177], v11 offset:46464
	v_mov_b32 v80, v72
	v_mov_b32 v81, v73
	ds_read_b64_tr_b16 a[178:179], v11 offset:47520
	v_mov_b32 v82, v74
	ds_read_b64_tr_b16 a[180:181], v12 offset:46464
	v_mov_b32 v83, v75
	ds_read_b64_tr_b16 a[182:183], v12 offset:47520
	v_mov_b32 v84, v76
	s_waitcnt lgkmcnt(4)
	v_permlane32_swap_b32 v72, v80
	v_permlane32_swap_b32 v73, v81
	s_add_u32 m0, s0, 44352
	v_permlane32_swap_b32 v74, v82
	s_mov_b32 s1, 163840
	v_permlane32_swap_b32 v75, v83
	buffer_load_dwordx4 v10, s[24:27], s1 offen lds
	v_permlane32_swap_b32 v76, v84
	buffer_load_dwordx4 v23, s[24:27], s1 offen offset:1056 lds
	v_add_f32 v72, v72, v80
	s_waitcnt vmcnt(6)
	v_add_f32 v73, v73, v81
	v_add_f32 v74, v74, v82
	ds_read_b64_tr_b16 a[184:185], v11 offset:48576
	v_add_f32 v75, v75, v83
	ds_read_b64_tr_b16 a[186:187], v11 offset:49632
	v_add_f32 v76, v76, v84
	ds_read_b64_tr_b16 a[188:189], v12 offset:48576
	v_readfirstlane_b32 s62, v72
	ds_read_b64_tr_b16 a[190:191], v12 offset:49632
	v_readfirstlane_b32 s63, v73
	s_waitcnt lgkmcnt(4)
	v_readfirstlane_b32 s64, v74
	v_readfirstlane_b32 s65, v75
	s_add_u32 m0, s0, 46464
	v_readfirstlane_b32 s66, v76
	s_mov_b32 s1, 180224
	s_lshl_b32 s54, s61, 7
	buffer_load_dwordx4 v10, s[24:27], s1 offen lds
	s_add_u32 s54, s54, 28672
	buffer_load_dwordx4 v23, s[24:27], s1 offen offset:1056 lds
	v_lshl_add_u32 v13, v0, 2, s54
	buffer_load_dword v4, v13, s[44:47], 0 offen sc1
	s_barrier
	ds_read_b128 v[24:27], v41 offset:0
	ds_read_b128 v[28:31], v41 offset:512
	ds_read_b128 v[32:35], v41 offset:2048
	ds_read_b128 v[36:39], v41 offset:2560
	v_add_f32 v124, v124, v120
	v_add_f32 v125, v125, v121
	v_add_f32 v126, v126, v122
	v_lshlrev_b32 v127, 16, v22
	v_cvt_pk_bf16_f32 v72, v124, v125
	v_cvt_pk_bf16_f32 v73, v126, v127
	v_lshlrev_b32 v74, 16, v72
	v_and_b32 v75, s67, v72
	v_lshlrev_b32 v76, 16, v73
	v_sub_f32 v74, v124, v74
	v_sub_f32 v75, v125, v75
	v_sub_f32 v76, v126, v76
	v_cvt_pk_bf16_f32 v74, v74, v75
	v_cvt_pk_bf16_f32 v75, v76, 0
	v_cndmask_b32 v124, v72, v74, s[2:3]
	v_cndmask_b32 v125, v73, v75, s[2:3]
	v_cndmask_b32 v126, v72, 0, s[2:3]
	v_cndmask_b32 v127, v73, 0, s[2:3]
	s_lshl_b32 s68, s52, 12
	v_add_u32 v21, s68, v5
	v_add_u32 v16, 65536, v5
	v_add_u32 v17, 157440, v5
	v_and_b32 v18, 31, v0
	v_lshlrev_b32 v18, 4, v18
	v_lshl_add_u32 v6, v42, 10, v18
	v_add_u32 v18, 161536, v18
	s_mul_i32 s54, s61, 229376
	s_lshl_b32 s55, s60, 13
	s_add_u32 s54, s54, s55
	s_lshl_b32 s55, s52, 11
	s_add_u32 s54, s54, s55
	s_add_u32 s54, s54, 8388608
	v_add_u32 v19, s54, v5
	s_lshl_b32 s54, s52, 10
	v_add_u32 v1, s54, v17
	s_lshl_b32 s54, s52, 9
	v_add_u32 v3, s54, v18
	s_lshl_b32 s54, s61, 9
	s_lshl_b32 s55, s60, 4
	s_add_u32 s54, s54, s55
	s_lshl_b32 s55, s52, 2
	s_add_u32 s54, s54, s55
	s_add_u32 s54, s54, 32768
	v_mov_b32 v20, s54
	v_min_u32 v7, 13, v0
	s_mul_i32 s54, s52, 56
	s_lshl_b32 s55, s50, 9
	s_add_u32 s54, s54, s55
	s_add_u32 s54, s54, 32768
	v_lshl_add_u32 v7, v7, 2, s54
	s_lshl_b32 s57, s61, 16
	s_add_u32 s57, s57, 3145728
	s_and_b32 s56, s52, 1
	s_add_u32 s56, s56, s61
	s_lshl_b32 s56, s56, 14
	s_lshr_b32 s55, s52, 1
	s_lshl_b32 s55, s55, 9
	s_add_u32 s56, s56, s55
	s_add_u32 s56, s56, 524288
	s_cmp_ge_u32 s49, 28
	s_cbranch_scc1 IDLEF
	s_waitcnt vmcnt(0)
	v_cmp_ne_u32 vcc, s53, v4
	s_cbranch_vccz ok_13
	s_mov_b32 s58, 200000
poll_14:
	buffer_load_dword v4, v13, s[44:47], 0 offen sc1
	s_waitcnt vmcnt(0)
	v_cmp_ne_u32 vcc, s53, v4
	s_cbranch_vccz pdone_15
	s_sub_u32 s58, s58, 1
	s_cbranch_scc0 poll_14
pdone_15:
ok_13:
	s_add_u32 m0, s68, 0
	s_add_u32 s1, s57, 0
	ds_read_b64_tr_b16 a[192:193], v11 offset:50688
	buffer_load_dwordx4 v21, s[44:47], s1 offen offset:0 sc1 lds
	ds_read_b64_tr_b16 a[194:195], v11 offset:51744
	buffer_load_dwordx4 v21, s[44:47], s1 offen offset:1024 sc1 lds
	ds_read_b64_tr_b16 a[196:197], v12 offset:50688
	buffer_load_dwordx4 v21, s[44:47], s1 offen offset:2048 sc1 lds
	ds_read_b64_tr_b16 a[198:199], v12 offset:51744
	buffer_load_dwordx4 v21, s[44:47], s1 offen offset:3072 sc1 lds
	s_add_u32 m0, s68, 16384
	ds_read_b64_tr_b16 a[200:201], v11 offset:42240
	s_add_u32 s1, s57, 16384
	ds_read_b64_tr_b16 a[202:203], v11 offset:43296
	buffer_load_dwordx4 v21, s[44:47], s1 offen offset:0 sc1 lds
	buffer_load_dwordx4 v21, s[44:47], s1 offen offset:1024 sc1 lds
	ds_read_b64_tr_b16 a[204:205], v12 offset:42240
	buffer_load_dwordx4 v21, s[44:47], s1 offen offset:2048 sc1 lds
	ds_read_b64_tr_b16 a[206:207], v12 offset:43296
	buffer_load_dwordx4 v21, s[44:47], s1 offen offset:3072 sc1 lds
	buffer_load_dwordx4 v[128:131], v6, s[44:47], s56 offen offset:0 sc1
	ds_read_b64_tr_b16 a[208:209], v11 offset:44352
	buffer_load_dwordx4 v[132:135], v6, s[44:47], s56 offen offset:2048 sc1
	ds_read_b64_tr_b16 a[210:211], v11 offset:45408
	s_add_u32 s56, s56, 4096
	ds_read_b64_tr_b16 a[212:213], v12 offset:44352
	buffer_load_dwordx4 v[136:139], v6, s[44:47], s56 offen offset:0 sc1
	ds_read_b64_tr_b16 a[214:215], v12 offset:45408
	buffer_load_dwordx4 v[140:143], v6, s[44:47], s56 offen offset:2048 sc1
	s_waitcnt vmcnt(8)
	s_waitcnt lgkmcnt(0)
	s_barrier
	ds_read_b128 v[72:75], v5 offset:0
	ds_read_b128 v[76:79], v5 offset:1024
	ds_read_b128 v[80:83], v5 offset:2048
	ds_read_b128 v[84:87], v5 offset:3072
	ds_read_b128 v[88:91], v5 offset:4096
	ds_read_b128 v[92:95], v5 offset:5120
	ds_read_b128 v[96:99], v5 offset:6144
	s_waitcnt lgkmcnt(6)
	v_mfma_f32_32x32x16_bf16 v[40:55], a[0:3], v[72:75], 0
	ds_read_b128 v[100:103], v5 offset:7168
	s_add_u32 s56, s56, 4096
	buffer_load_dwordx4 v[144:147], v6, s[44:47], s56 offen offset:0 sc1
	s_waitcnt lgkmcnt(6)
	v_mfma_f32_32x32x16_bf16 v[40:55], a[4:7], v[76:79], v[40:55]
	ds_read_b128 v[72:75], v5 offset:8192
	buffer_load_dwordx4 v[148:151], v6, s[44:47], s56 offen offset:2048 sc1
	s_waitcnt lgkmcnt(6)
	v_mfma_f32_32x32x16_bf16 v[40:55], a[8:11], v[80:83], v[40:55]
	ds_read_b128 v[76:79], v5 offset:9216
	s_add_u32 s56, s56, 4096
	s_waitcnt lgkmcnt(4)
	v_mfma_f32_32x32x16_bf16 v[40:55], a[12:15], v[84:87], v[40:55]
	ds_read_b128 v[80:83], v5 offset:10240
	buffer_load_dwordx4 v[152:155], v6, s[44:47], s56 offen offset:0 sc1
	buffer_load_dwordx4 v[156:159], v6, s[44:47], s56 offen offset:2048 sc1
	v_mfma_f32_32x32x16_bf16 v[40:55], a[16:19], v[88:91], v[40:55]
	ds_read_b128 v[84:87], v5 offset:11264
	s_add_u32 m0, s68, 32768
	v_mfma_f32_32x32x16_bf16 v[40:55], a[20:23], v[92:95], v[40:55]
	ds_read_b128 v[88:91], v5 offset:12288
	s_add_u32 s1, s57, 65536
	s_waitcnt lgkmcnt(4)
	v_mfma_f32_32x32x16_bf16 v[40:55], a[24:27], v[96:99], v[40:55]
	ds_read_b128 v[92:95], v5 offset:13312
	buffer_load_dwordx4 v21, s[44:47], s1 offen offset:0 sc1 lds
	v_mfma_f32_32x32x16_bf16 v[40:55], a[28:31], v[100:103], v[40:55]
	ds_read_b128 v[96:99], v5 offset:14336
	buffer_load_dwordx4 v21, s[44:47], s1 offen offset:1024 sc1 lds
	buffer_load_dwordx4 v21, s[44:47], s1 offen offset:2048 sc1 lds
	v_mfma_f32_32x32x16_bf16 v[40:55], a[32:35], v[72:75], v[40:55]
	ds_read_b128 v[100:103], v5 offset:15360
	buffer_load_dwordx4 v21, s[44:47], s1 offen offset:3072 sc1 lds
	s_waitcnt lgkmcnt(4)
	v_mfma_f32_32x32x16_bf16 v[40:55], a[36:39], v[76:79], v[40:55]
	s_add_u32 m0, s68, 49152
	v_mfma_f32_32x32x16_bf16 v[40:55], a[40:43], v[80:83], v[40:55]
	s_add_u32 s1, s57, 81920
	buffer_load_dwordx4 v21, s[44:47], s1 offen offset:0 sc1 lds
	s_waitcnt vmcnt(11)
	v_add_f32 v128, v128, v132
	s_waitcnt vmcnt(9)
	v_add_f32 v136, v136, v140
	s_waitcnt vmcnt(7)
	v_add_f32 v144, v144, v148
	s_waitcnt vmcnt(5)
	v_add_f32 v152, v152, v156
	v_add_f32 v129, v129, v133
	v_mfma_f32_32x32x16_bf16 v[40:55], a[44:47], v[84:87], v[40:55]
	buffer_load_dwordx4 v21, s[44:47], s1 offen offset:1024 sc1 lds
	v_add_f32 v137, v137, v141
	v_add_f32 v145, v145, v149
	v_add_f32 v153, v153, v157
	v_add_f32 v130, v130, v134
	s_waitcnt lgkmcnt(1)
	v_mfma_f32_32x32x16_bf16 v[40:55], a[48:51], v[88:91], v[40:55]
	buffer_load_dwordx4 v21, s[44:47], s1 offen offset:2048 sc1 lds
	v_add_f32 v138, v138, v142
	v_add_f32 v146, v146, v150
	v_add_f32 v154, v154, v158
	v_add_f32 v128, v128, v136
	v_mfma_f32_32x32x16_bf16 v[40:55], a[52:55], v[92:95], v[40:55]
	s_barrier
	ds_read_b128 v[72:75], v5 offset:16384
	ds_read_b128 v[76:79], v5 offset:17408
	ds_read_b128 v[80:83], v5 offset:18432
	ds_read_b128 v[84:87], v5 offset:19456
	ds_read_b128 v[88:91], v5 offset:20480
	buffer_load_dwordx4 v21, s[44:47], s1 offen offset:3072 sc1 lds
	v_add_f32 v144, v144, v152
	v_add_f32 v129, v129, v137
	v_add_f32 v145, v145, v153
	v_add_f32 v130, v130, v138
	v_add_f32 v146, v146, v154
	v_mfma_f32_32x32x16_bf16 v[40:55], a[56:59], v[96:99], v[40:55]
	ds_read_b128 v[92:95], v5 offset:21504
	s_add_u32 m0, s0, 48576
	s_mov_b32 s1, 196608
	buffer_load_dwordx4 v10, s[24:27], s1 offen lds
	buffer_load_dwordx4 v23, s[24:27], s1 offen offset:1056 lds
	v_add_f32 v56, v128, v144
	v_add_f32 v57, v129, v145
	v_add_f32 v58, v130, v146
	v_mov_b32 v60, v56
	s_waitcnt lgkmcnt(4)
	v_mfma_f32_32x32x16_bf16 v[40:55], a[60:63], v[100:103], v[40:55]
	ds_read_b128 v[96:99], v5 offset:22528
	s_add_u32 m0, s0, 50688
	s_mov_b32 s1, 212992
	buffer_load_dwordx4 v10, s[24:27], s1 offen lds
	v_mov_b32 v61, v57
	v_mov_b32 v62, v58
	s_mov_b32 s54, 0x3b000000
	s_mov_b32 s55, 0x3727c5ac
	v_mfma_f32_32x32x16_bf16 v[40:55], a[64:67], v[72:75], v[40:55]
	ds_read_b128 v[100:103], v5 offset:23552
	buffer_load_dwordx4 v23, s[24:27], s1 offen offset:1056 lds
	s_add_u32 m0, s0, 42240
	s_mov_b32 s1, 229376
	buffer_load_dwordx4 v10, s[24:27], s1 offen lds
	v_permlane32_swap_b32 v56, v60
	v_permlane32_swap_b32 v57, v61
	v_permlane32_swap_b32 v58, v62
	v_mul_f32 v64, s54, v56
	v_mfma_f32_32x32x16_bf16 v[40:55], a[68:71], v[76:79], v[40:55]
	ds_read_b128 v[72:75], v5 offset:24576
	buffer_load_dwordx4 v23, s[24:27], s1 offen offset:1056 lds
	s_add_u32 m0, s0, 44352
	s_mov_b32 s1, 245760
	v_mul_f32 v65, v64, v64
	v_fma_f32 v65, v60, s54, -v65
	v_max_f32 v65, 0, v65
	v_add_f32 v65, s55, v65
	v_rsq_f32 v66, v65
	s_waitcnt lgkmcnt(4)
	v_mfma_f32_32x32x16_bf16 v[40:55], a[72:75], v[80:83], v[40:55]
	ds_read_b128 v[76:79], v5 offset:25600
	buffer_load_dwordx4 v10, s[24:27], s1 offen lds
	buffer_load_dwordx4 v23, s[24:27], s1 offen offset:1056 lds
	ds_read_b64_tr_b16 a[216:217], v11 offset:46464
	v_fma_f32 v57, -v64, s62, v57
	v_mul_f32 v67, v65, v66
	v_fma_f32 v57, v57, v66, s64
	v_mul_f32 v57, s54, v57
	v_mfma_f32_32x32x16_bf16 v[40:55], a[76:79], v[84:87], v[40:55]
	ds_read_b128 v[80:83], v5 offset:26624
	ds_read_b64_tr_b16 a[218:219], v11 offset:47520
	ds_read_b64_tr_b16 a[220:221], v12 offset:46464
	ds_read_b64_tr_b16 a[222:223], v12 offset:47520
	s_waitcnt vmcnt(6)
	ds_read_b64_tr_b16 a[224:225], v11 offset:48576
	v_mul_f32 v68, s63, v64
	v_fma_f32 v68, v58, -2.0, v68
	v_fma_f32 v68, v68, v64, v61
	v_fma_f32 v62, -v64, s66, v62
	v_mfma_f32_32x32x16_bf16 v[40:55], a[80:83], v[88:91], v[40:55]
	ds_read_b128 v[84:87], v5 offset:27648
	ds_read_b64_tr_b16 a[226:227], v11 offset:49632
	ds_read_b64_tr_b16 a[228:229], v12 offset:48576
	ds_read_b64_tr_b16 a[230:231], v12 offset:49632
	s_waitcnt lgkmcnt(5)
	v_add_f32 v62, v62, v62
	v_fma_f32 v68, v68, v66, v62
	v_fma_f32 v68, v68, v66, s65
	v_mul_f32 v69, v57, v57
	v_fma_f32 v68, v68, s54, -v69
	v_mfma_f32_32x32x16_bf16 v[40:55], a[84:87], v[92:95], v[40:55]
	ds_read_b128 v[88:91], v5 offset:28672
	s_add_u32 m0, s0, 46464
	s_mov_b32 s1, 262144
	buffer_load_dwordx4 v10, s[24:27], s1 offen lds
	buffer_load_dwordx4 v23, s[24:27], s1 offen offset:1056 lds
	v_max_f32 v68, 0, v68
	v_add_f32 v68, s55, v68
	v_rsq_f32 v69, v68
	v_sub_f32 v128, 0, v64
	v_mfma_f32_32x32x16_bf16 v[40:55], a[88:91], v[96:99], v[40:55]
	ds_read_b128 v[92:95], v5 offset:29696
	s_add_u32 m0, s68, 65536
	s_add_u32 s1, s57, 32768
	v_mul_f32 v130, -v57, v67
	v_mul_f32 v68, v68, v69
	v_mul_f32 v69, v69, v66
	v_mul_f32 v131, v68, v67
	v_mfma_f32_32x32x16_bf16 v[40:55], a[92:95], v[100:103], v[40:55]
	ds_read_b128 v[96:99], v5 offset:30720
	buffer_load_dwordx4 v21, s[44:47], s1 offen offset:0 sc1 lds
	v_mul_f32 v132, 0xc0135761, v69
	v_mul_f32 v133, v69, v69
	v_mul_f32 v133, v133, v69
	v_mul_f32 v133, 0xbdd2d3e8, v133
	v_mfma_f32_32x32x16_bf16 v[40:55], a[96:99], v[72:75], v[40:55]
	ds_read_b128 v[100:103], v5 offset:31744
	buffer_load_dwordx4 v21, s[44:47], s1 offen offset:1024 sc1 lds
	v_mov_b32 v134, v131
	ds_write_b128 v3, v[132:135]
	v_cvt_pk_bf16_f32 v56, v128, v67
	v_cvt_pk_bf16_f32 v57, v130, v131
	v_lshlrev_b32 v60, 16, v56
	v_mfma_f32_32x32x16_bf16 v[40:55], a[100:103], v[76:79], v[40:55]
	buffer_load_dwordx4 v21, s[44:47], s1 offen offset:2048 sc1 lds
	v_and_b32 v61, s67, v56
	v_lshlrev_b32 v62, 16, v57
	v_and_b32 v63, s67, v57
	v_sub_f32 v60, v128, v60
	v_mfma_f32_32x32x16_bf16 v[40:55], a[104:107], v[80:83], v[40:55]
	buffer_load_dwordx4 v21, s[44:47], s1 offen offset:3072 sc1 lds
	v_sub_f32 v61, v67, v61
	v_sub_f32 v62, v130, v62
	v_sub_f32 v63, v131, v63
	v_cvt_pk_bf16_f32 v58, v60, v61
	s_waitcnt lgkmcnt(3)
	v_mfma_f32_32x32x16_bf16 v[40:55], a[108:111], v[84:87], v[40:55]
	s_add_u32 m0, s68, 81920
	v_cvt_pk_bf16_f32 v59, v62, v63
	v_cndmask_b32 v58, v58, 0, s[2:3]
	v_cndmask_b32 v59, v59, 0, s[2:3]
	ds_write_b128 v1, v[56:59]
	v_mfma_f32_32x32x16_bf16 v[40:55], a[112:115], v[88:91], v[40:55]
	s_add_u32 s1, s57, 49152
	v_mfma_f32_32x32x16_bf16 v[40:55], a[116:119], v[92:95], v[40:55]
	s_waitcnt lgkmcnt(0)
	s_barrier
	ds_read_b128 v[72:75], v17 offset:0
	ds_read_b128 v[76:79], v5 offset:32768
	ds_read_b128 v[80:83], v5 offset:33792
	ds_read_b128 v[84:87], v5 offset:34816
	ds_read_b128 v[88:91], v5 offset:35840
	buffer_load_dwordx4 v21, s[44:47], s1 offen offset:0 sc1 lds
	v_mfma_f32_32x32x16_bf16 v[40:55], a[120:123], v[96:99], v[40:55]
	ds_read_b128 v[92:95], v5 offset:36864
	buffer_load_dwordx4 v21, s[44:47], s1 offen offset:1024 sc1 lds
	v_mfma_f32_32x32x16_bf16 v[40:55], a[124:127], v[100:103], v[40:55]
	ds_read_b128 v[96:99], v5 offset:37888
	buffer_load_dwordx4 v21, s[44:47], s1 offen offset:2048 sc1 lds
	s_waitcnt lgkmcnt(6)
	v_mfma_f32_32x32x16_bf16 v[40:55], v[124:127], v[72:75], v[40:55]
	ds_read_b128 v[100:103], v5 offset:38912
	buffer_load_dwordx4 v21, s[44:47], s1 offen offset:3072 sc1 lds
	s_waitcnt lgkmcnt(4)
	v_mfma_f32_32x32x16_bf16 v[56:71], a[0:3], v[76:79], 0
	ds_read_b128 v[72:75], v5 offset:39936
	s_add_u32 m0, s68, 0
	v_mfma_f32_32x32x16_bf16 v[56:71], a[4:7], v[80:83], v[56:71]
	ds_read_b128 v[76:79], v5 offset:40960
	ds_read_b128 v[112:115], v18 offset:0
	v_mul_f32 v128, v40, v40
	v_mul_f32 v129, v41, v41
	v_mul_f32 v130, v42, v42
	s_add_u32 s1, s57, 98304
	v_mfma_f32_32x32x16_bf16 v[56:71], a[8:11], v[84:87], v[56:71]
	ds_read_b128 v[80:83], v5 offset:41984
	v_mul_f32 v131, v43, v43
	s_waitcnt lgkmcnt(1)
	v_fma_f32 v128, v128, v113, v112
	v_fma_f32 v129, v129, v113, v112
	v_fma_f32 v130, v130, v113, v112
	buffer_load_dwordx4 v21, s[44:47], s1 offen offset:0 sc1 lds
	v_mfma_f32_32x32x16_bf16 v[56:71], a[12:15], v[88:91], v[56:71]
	ds_read_b128 v[84:87], v5 offset:43008
	v_fma_f32 v131, v131, v113, v112
	v_mul_f32 v128, v128, v40
	v_mul_f32 v129, v129, v41
	v_mul_f32 v130, v130, v42
	buffer_load_dwordx4 v21, s[44:47], s1 offen offset:1024 sc1 lds
	v_mfma_f32_32x32x16_bf16 v[56:71], a[16:19], v[92:95], v[56:71]
	ds_read_b128 v[88:91], v5 offset:44032
	v_mul_f32 v131, v131, v43
	v_exp_f32 v128, v128
	v_exp_f32 v129, v129
	v_exp_f32 v130, v130
	buffer_load_dwordx4 v21, s[44:47], s1 offen offset:2048 sc1 lds
	v_mfma_f32_32x32x16_bf16 v[56:71], a[20:23], v[96:99], v[56:71]
	ds_read_b128 v[92:95], v5 offset:45056
	v_exp_f32 v131, v131
	v_fma_f32 v128, v128, v114, v114
	v_fma_f32 v129, v129, v114, v114
	v_fma_f32 v130, v130, v114, v114
	buffer_load_dwordx4 v21, s[44:47], s1 offen offset:3072 sc1 lds
	v_mfma_f32_32x32x16_bf16 v[56:71], a[24:27], v[100:103], v[56:71]
	ds_read_b128 v[96:99], v5 offset:46080
	v_fma_f32 v131, v131, v114, v114
	v_rcp_f32 v128, v128
	v_rcp_f32 v129, v129
	v_rcp_f32 v130, v130
	v_mfma_f32_32x32x16_bf16 v[56:71], a[28:31], v[72:75], v[56:71]
	ds_read_b128 v[100:103], v5 offset:47104
	v_rcp_f32 v131, v131
	v_mul_f32 v128, v128, v40
	v_mul_f32 v129, v129, v41
	v_mul_f32 v130, v130, v42
	s_add_u32 m0, s68, 16384
	v_mfma_f32_32x32x16_bf16 v[56:71], a[32:35], v[76:79], v[56:71]
	ds_read_b128 v[72:75], v5 offset:48128
	v_mul_f32 v131, v131, v43
	v_cvt_pk_bf16_f32 v116, v128, v129
	v_cvt_pk_bf16_f32 v117, v130, v131
	s_add_u32 s1, s57, 114688
	s_waitcnt lgkmcnt(4)
	v_mfma_f32_32x32x16_bf16 v[56:71], a[36:39], v[80:83], v[56:71]
	ds_read_b128 v[76:79], v5 offset:49152
	v_mul_f32 v132, v44, v44
	v_mul_f32 v133, v45, v45
	v_mul_f32 v134, v46, v46
	v_mul_f32 v135, v47, v47
	buffer_load_dwordx4 v21, s[44:47], s1 offen offset:0 sc1 lds
	v_mfma_f32_32x32x16_bf16 v[56:71], a[40:43], v[84:87], v[56:71]
	ds_read_b128 v[80:83], v5 offset:50176
	v_fma_f32 v132, v132, v113, v112
	v_fma_f32 v133, v133, v113, v112
	v_fma_f32 v134, v134, v113, v112
	v_fma_f32 v135, v135, v113, v112
	buffer_load_dwordx4 v21, s[44:47], s1 offen offset:1024 sc1 lds
	v_mfma_f32_32x32x16_bf16 v[56:71], a[44:47], v[88:91], v[56:71]
	ds_read_b128 v[84:87], v5 offset:51200
	v_mul_f32 v132, v132, v44
	v_mul_f32 v133, v133, v45
	v_mul_f32 v134, v134, v46
	v_mul_f32 v135, v135, v47
	buffer_load_dwordx4 v21, s[44:47], s1 offen offset:2048 sc1 lds
	s_waitcnt lgkmcnt(4)
	v_mfma_f32_32x32x16_bf16 v[56:71], a[48:51], v[92:95], v[56:71]
	ds_read_b128 v[88:91], v5 offset:52224
	v_exp_f32 v132, v132
	v_exp_f32 v133, v133
	v_exp_f32 v134, v134
	v_exp_f32 v135, v135
	buffer_load_dwordx4 v21, s[44:47], s1 offen offset:3072 sc1 lds
	v_mfma_f32_32x32x16_bf16 v[56:71], a[52:55], v[96:99], v[56:71]
	ds_read_b128 v[92:95], v5 offset:53248
	v_fma_f32 v132, v132, v114, v114
	v_fma_f32 v133, v133, v114, v114
	v_fma_f32 v134, v134, v114, v114
	v_fma_f32 v135, v135, v114, v114
	v_mfma_f32_32x32x16_bf16 v[56:71], a[56:59], v[100:103], v[56:71]
	ds_read_b128 v[96:99], v5 offset:54272
	v_rcp_f32 v132, v132
	v_rcp_f32 v133, v133
	v_rcp_f32 v134, v134
	v_rcp_f32 v135, v135
	s_waitcnt vmcnt(22)
	ds_read_b64_tr_b16 a[232:233], v11 offset:50688
	ds_read_b64_tr_b16 a[234:235], v11 offset:51744
	s_waitcnt lgkmcnt(6)
	v_mfma_f32_32x32x16_bf16 v[56:71], a[60:63], v[72:75], v[56:71]
	ds_read_b128 v[100:103], v5 offset:55296
	v_mul_f32 v132, v132, v44
	v_mul_f32 v133, v133, v45
	v_mul_f32 v134, v134, v46
	v_mul_f32 v135, v135, v47
	ds_read_b64_tr_b16 a[236:237], v12 offset:50688
	ds_read_b64_tr_b16 a[238:239], v12 offset:51744
	v_mfma_f32_32x32x16_bf16 v[56:71], a[64:67], v[76:79], v[56:71]
	ds_read_b128 v[72:75], v5 offset:56320
	v_cvt_pk_bf16_f32 v118, v132, v133
	v_cvt_pk_bf16_f32 v119, v134, v135
	s_mov_b32 s54, 0
	buffer_store_dwordx4 v[116:119], v19, s[44:47], s54 offen offset:0 sc1
	s_add_u32 m0, s0, 48576
	s_mov_b32 s1, 278528
	v_mfma_f32_32x32x16_bf16 v[56:71], a[68:71], v[80:83], v[56:71]
	ds_read_b128 v[76:79], v5 offset:57344
	v_mul_f32 v128, v48, v48
	v_mul_f32 v129, v49, v49
	v_mul_f32 v130, v50, v50
	v_mul_f32 v131, v51, v51
	buffer_load_dwordx4 v10, s[24:27], s1 offen lds
	buffer_load_dwordx4 v23, s[24:27], s1 offen offset:1056 lds
	s_waitcnt vmcnt(23)
	s_waitcnt lgkmcnt(8)
	v_mfma_f32_32x32x16_bf16 v[56:71], a[72:75], v[84:87], v[56:71]
	ds_read_b128 v[80:83], v5 offset:58368
	v_fma_f32 v128, v128, v113, v112
	v_fma_f32 v129, v129, v113, v112
	v_fma_f32 v130, v130, v113, v112
	v_fma_f32 v131, v131, v113, v112
	ds_read_b64_tr_b16 a[240:241], v11 offset:42240
	ds_read_b64_tr_b16 a[242:243], v11 offset:43296
	ds_read_b64_tr_b16 a[244:245], v12 offset:42240
	v_mfma_f32_32x32x16_bf16 v[56:71], a[76:79], v[88:91], v[56:71]
	ds_read_b128 v[84:87], v5 offset:59392
	v_mul_f32 v128, v128, v48
	v_mul_f32 v129, v129, v49
	v_mul_f32 v130, v130, v50
	v_mul_f32 v131, v131, v51
	ds_read_b64_tr_b16 a[246:247], v12 offset:43296
	s_waitcnt lgkmcnt(8)
	v_mfma_f32_32x32x16_bf16 v[56:71], a[80:83], v[92:95], v[56:71]
	ds_read_b128 v[88:91], v5 offset:60416
	v_exp_f32 v128, v128
	v_exp_f32 v129, v129
	v_exp_f32 v130, v130
	v_exp_f32 v131, v131
	s_add_u32 m0, s0, 50688
	s_mov_b32 s1, 294912
	buffer_load_dwordx4 v10, s[24:27], s1 offen lds
	s_waitcnt lgkmcnt(8)
	v_mfma_f32_32x32x16_bf16 v[56:71], a[84:87], v[96:99], v[56:71]
	ds_read_b128 v[92:95], v5 offset:61440
	v_fma_f32 v128, v128, v114, v114
	v_fma_f32 v129, v129, v114, v114
	v_fma_f32 v130, v130, v114, v114
	v_fma_f32 v131, v131, v114, v114
	buffer_load_dwordx4 v23, s[24:27], s1 offen offset:1056 lds
	s_waitcnt vmcnt(23)
	ds_read_b64_tr_b16 a[248:249], v11 offset:44352
	v_mfma_f32_32x32x16_bf16 v[56:71], a[88:91], v[100:103], v[56:71]
	ds_read_b128 v[96:99], v5 offset:62464
	v_rcp_f32 v128, v128
	v_rcp_f32 v129, v129
	v_rcp_f32 v130, v130
	v_rcp_f32 v131, v131
	ds_read_b64_tr_b16 a[250:251], v11 offset:45408
	ds_read_b64_tr_b16 a[252:253], v12 offset:44352
	v_mfma_f32_32x32x16_bf16 v[56:71], a[92:95], v[72:75], v[56:71]
	ds_read_b128 v[100:103], v5 offset:63488
	v_mul_f32 v128, v128, v48
	v_mul_f32 v129, v129, v49
	v_mul_f32 v130, v130, v50
	v_mul_f32 v131, v131, v51
	ds_read_b64_tr_b16 a[254:255], v12 offset:45408
	s_waitcnt lgkmcnt(8)
	s_add_u32 m0, s0, 42240
	v_mfma_f32_32x32x16_bf16 v[56:71], a[96:99], v[76:79], v[56:71]
	ds_read_b128 v[72:75], v5 offset:64512
	v_cvt_pk_bf16_f32 v120, v128, v129
	v_cvt_pk_bf16_f32 v121, v130, v131
	v_mul_f32 v132, v52, v52
	s_mov_b32 s1, 311296
	buffer_load_dwordx4 v10, s[24:27], s1 offen lds
	v_mfma_f32_32x32x16_bf16 v[56:71], a[100:103], v[80:83], v[56:71]
	ds_read_b128 v[76:79], v17 offset:1024
	v_mul_f32 v133, v53, v53
	v_mul_f32 v134, v54, v54
	v_mul_f32 v135, v55, v55
	v_fma_f32 v132, v132, v113, v112
	buffer_load_dwordx4 v23, s[24:27], s1 offen offset:1056 lds
	s_waitcnt vmcnt(23)
	ds_read_b64_tr_b16 v[160:161], v11 offset:46464
	v_mfma_f32_32x32x16_bf16 v[56:71], a[104:107], v[84:87], v[56:71]
	v_fma_f32 v133, v133, v113, v112
	v_fma_f32 v134, v134, v113, v112
	v_fma_f32 v135, v135, v113, v112
	v_mul_f32 v132, v132, v52
	ds_read_b64_tr_b16 v[162:163], v11 offset:47520
	ds_read_b64_tr_b16 v[164:165], v12 offset:46464
	ds_read_b64_tr_b16 v[166:167], v12 offset:47520
	s_waitcnt lgkmcnt(10)
	v_mfma_f32_32x32x16_bf16 v[56:71], a[108:111], v[88:91], v[56:71]
	v_mul_f32 v133, v133, v53
	v_mul_f32 v134, v134, v54
	v_mul_f32 v135, v135, v55
	v_exp_f32 v132, v132
	s_waitcnt lgkmcnt(6)
	s_add_u32 m0, s0, 44352
	v_mfma_f32_32x32x16_bf16 v[56:71], a[112:115], v[92:95], v[56:71]
	v_exp_f32 v133, v133
	v_exp_f32 v134, v134
	v_exp_f32 v135, v135
	v_fma_f32 v132, v132, v114, v114
	s_mov_b32 s1, 327680
	buffer_load_dwordx4 v10, s[24:27], s1 offen lds
	buffer_load_dwordx4 v23, s[24:27], s1 offen offset:1056 lds
	v_mfma_f32_32x32x16_bf16 v[56:71], a[116:119], v[96:99], v[56:71]
	v_fma_f32 v133, v133, v114, v114
	v_fma_f32 v134, v134, v114, v114
	v_fma_f32 v135, v135, v114, v114
	v_rcp_f32 v132, v132
	s_waitcnt vmcnt(6)
	ds_read_b64_tr_b16 v[168:169], v11 offset:48576
	ds_read_b64_tr_b16 v[170:171], v11 offset:49632
	s_waitcnt lgkmcnt(6)
	v_mfma_f32_32x32x16_bf16 v[56:71], a[120:123], v[100:103], v[56:71]
	s_barrier
	ds_read_b128 v[80:83], v16 offset:0
	ds_read_b128 v[84:87], v16 offset:1024
	ds_read_b128 v[88:91], v16 offset:2048
	ds_read_b128 v[92:95], v16 offset:3072
	ds_read_b128 v[96:99], v16 offset:4096
	v_rcp_f32 v133, v133
	v_rcp_f32 v134, v134
	v_rcp_f32 v135, v135
	v_mul_f32 v132, v132, v52
	ds_read_b64_tr_b16 v[172:173], v12 offset:48576
	ds_read_b64_tr_b16 v[174:175], v12 offset:49632
	v_mfma_f32_32x32x16_bf16 v[56:71], a[124:127], v[72:75], v[56:71]
	ds_read_b128 v[100:103], v16 offset:5120
	v_mul_f32 v133, v133, v53
	v_mul_f32 v134, v134, v54
	v_mul_f32 v135, v135, v55
	v_cvt_pk_bf16_f32 v122, v132, v133
	s_waitcnt lgkmcnt(10)
	s_add_u32 m0, s0, 46464
	s_mov_b32 s1, 344064
	v_mfma_f32_32x32x16_bf16 v[56:71], v[124:127], v[76:79], v[56:71]
	ds_read_b128 v[72:75], v16 offset:6144
	v_cvt_pk_bf16_f32 v123, v134, v135
	s_mov_b32 s54, 0
	buffer_store_dwordx4 v[120:123], v19, s[44:47], s54 offen offset:1024 sc1
	ds_read_b128 v[112:115], v18 offset:512
	buffer_load_dwordx4 v10, s[24:27], s1 offen lds
	buffer_load_dwordx4 v23, s[24:27], s1 offen offset:1056 lds
	s_waitcnt lgkmcnt(7)
	v_mfma_f32_32x32x16_bf16 v[40:55], a[0:3], v[80:83], 0
	ds_read_b128 v[76:79], v16 offset:7168
	s_waitcnt vmcnt(7)
	ds_read_b64_tr_b16 v[176:177], v11 offset:50688
	v_mfma_f32_32x32x16_bf16 v[40:55], a[4:7], v[84:87], v[40:55]
	ds_read_b128 v[80:83], v16 offset:8192
	v_mul_f32 v128, v56, v56
	v_mul_f32 v129, v57, v57
	v_mul_f32 v130, v58, v58
	v_mul_f32 v131, v59, v59
	ds_read_b64_tr_b16 v[178:179], v11 offset:51744
	ds_read_b64_tr_b16 v[180:181], v12 offset:50688
	v_mfma_f32_32x32x16_bf16 v[40:55], a[8:11], v[88:91], v[40:55]
	ds_read_b128 v[84:87], v16 offset:9216
	s_waitcnt lgkmcnt(6)
	v_fma_f32 v128, v128, v113, v112
	v_fma_f32 v129, v129, v113, v112
	v_fma_f32 v130, v130, v113, v112
	v_fma_f32 v131, v131, v113, v112
	ds_read_b64_tr_b16 v[182:183], v12 offset:51744
	v_mfma_f32_32x32x16_bf16 v[40:55], a[12:15], v[92:95], v[40:55]
	ds_read_b128 v[88:91], v16 offset:10240
	v_mul_f32 v128, v128, v56
	v_mul_f32 v129, v129, v57
	v_mul_f32 v130, v130, v58
	v_mul_f32 v131, v131, v59
	s_add_u32 m0, s0, 48576
	v_mfma_f32_32x32x16_bf16 v[40:55], a[16:19], v[96:99], v[40:55]
	ds_read_b128 v[92:95], v16 offset:11264
	v_exp_f32 v128, v128
	v_exp_f32 v129, v129
	v_exp_f32 v130, v130
	v_exp_f32 v131, v131
	s_mov_b32 s1, 360448
	v_mfma_f32_32x32x16_bf16 v[40:55], a[20:23], v[100:103], v[40:55]
	ds_read_b128 v[96:99], v16 offset:12288
	v_fma_f32 v128, v128, v114, v114
	v_fma_f32 v129, v129, v114, v114
	v_fma_f32 v130, v130, v114, v114
	v_fma_f32 v131, v131, v114, v114
	buffer_load_dwordx4 v10, s[24:27], s1 offen lds
	buffer_load_dwordx4 v23, s[24:27], s1 offen offset:1056 lds
	s_waitcnt lgkmcnt(7)
	v_mfma_f32_32x32x16_bf16 v[40:55], a[24:27], v[72:75], v[40:55]
	ds_read_b128 v[100:103], v16 offset:13312
	v_rcp_f32 v128, v128
	v_rcp_f32 v129, v129
	v_rcp_f32 v130, v130
	v_rcp_f32 v131, v131
	s_waitcnt vmcnt(7)
	v_mfma_f32_32x32x16_bf16 v[40:55], a[28:31], v[76:79], v[40:55]
	ds_read_b128 v[72:75], v16 offset:14336
	v_mul_f32 v128, v128, v56
	v_mul_f32 v129, v129, v57
	v_mul_f32 v130, v130, v58
	ds_read_b64_tr_b16 v[184:185], v11 offset:42240
	ds_read_b64_tr_b16 v[186:187], v11 offset:43296
	v_mfma_f32_32x32x16_bf16 v[40:55], a[32:35], v[80:83], v[40:55]
	ds_read_b128 v[76:79], v16 offset:15360
	v_mul_f32 v131, v131, v59
	v_cvt_pk_bf16_f32 v116, v128, v129
	v_cvt_pk_bf16_f32 v117, v130, v131
	v_mul_f32 v132, v60, v60
	ds_read_b64_tr_b16 v[188:189], v12 offset:42240
	s_waitcnt lgkmcnt(7)
	v_mfma_f32_32x32x16_bf16 v[40:55], a[36:39], v[84:87], v[40:55]
	ds_read_b128 v[80:83], v16 offset:16384
	v_mul_f32 v133, v61, v61
	v_mul_f32 v134, v62, v62
	v_mul_f32 v135, v63, v63
	v_fma_f32 v132, v132, v113, v112
	ds_read_b64_tr_b16 v[190:191], v12 offset:43296
	v_mfma_f32_32x32x16_bf16 v[40:55], a[40:43], v[88:91], v[40:55]
	ds_read_b128 v[84:87], v16 offset:17408
	v_fma_f32 v133, v133, v113, v112
	v_fma_f32 v134, v134, v113, v112
	v_fma_f32 v135, v135, v113, v112
	v_mul_f32 v132, v132, v60
	s_add_u32 m0, s0, 50688
	v_mfma_f32_32x32x16_bf16 v[40:55], a[44:47], v[92:95], v[40:55]
	ds_read_b128 v[88:91], v16 offset:18432
	v_mul_f32 v133, v133, v61
	v_mul_f32 v134, v134, v62
	v_mul_f32 v135, v135, v63
	v_exp_f32 v132, v132
	s_mov_b32 s1, 376832
	buffer_load_dwordx4 v10, s[24:27], s1 offen lds
	s_waitcnt lgkmcnt(8)
	v_mfma_f32_32x32x16_bf16 v[40:55], a[48:51], v[96:99], v[40:55]
	ds_read_b128 v[92:95], v16 offset:19456
	v_exp_f32 v133, v133
	v_exp_f32 v134, v134
	v_exp_f32 v135, v135
	v_fma_f32 v132, v132, v114, v114
	s_waitcnt vmcnt(5)
	buffer_store_dword v8, v20, s[44:47], 0 offen offset:0
	buffer_load_dwordx4 v23, s[24:27], s1 offen offset:1056 lds
	v_mfma_f32_32x32x16_bf16 v[40:55], a[52:55], v[100:103], v[40:55]
	ds_read_b128 v[96:99], v16 offset:20480
	v_fma_f32 v133, v133, v114, v114
	v_fma_f32 v134, v134, v114, v114
	v_fma_f32 v135, v135, v114, v114
	ds_read_b64_tr_b16 v[192:193], v11 offset:44352
	v_mfma_f32_32x32x16_bf16 v[40:55], a[56:59], v[72:75], v[40:55]
	ds_read_b128 v[100:103], v16 offset:21504
	v_rcp_f32 v132, v132
	v_rcp_f32 v133, v133
	v_rcp_f32 v134, v134
	v_rcp_f32 v135, v135
	ds_read_b64_tr_b16 v[194:195], v11 offset:45408
	s_waitcnt lgkmcnt(6)
	v_mfma_f32_32x32x16_bf16 v[40:55], a[60:63], v[76:79], v[40:55]
	ds_read_b128 v[72:75], v16 offset:22528
	v_mul_f32 v132, v132, v60
	v_mul_f32 v133, v133, v61
	v_mul_f32 v134, v134, v62
	v_mul_f32 v135, v135, v63
	ds_read_b64_tr_b16 v[196:197], v12 offset:44352
	ds_read_b64_tr_b16 v[198:199], v12 offset:45408
	v_mfma_f32_32x32x16_bf16 v[40:55], a[64:67], v[80:83], v[40:55]
	ds_read_b128 v[76:79], v16 offset:23552
	v_cvt_pk_bf16_f32 v118, v132, v133
	v_cvt_pk_bf16_f32 v119, v134, v135
	s_mov_b32 s54, 229376
	buffer_store_dwordx4 v[116:119], v19, s[44:47], s54 offen offset:0 sc1
	v_mul_f32 v128, v64, v64
	v_mfma_f32_32x32x16_bf16 v[40:55], a[68:71], v[84:87], v[40:55]
	ds_read_b128 v[80:83], v16 offset:24576
	v_mul_f32 v129, v65, v65
	v_mul_f32 v130, v66, v66
	v_mul_f32 v131, v67, v67
	v_fma_f32 v128, v128, v113, v112
	s_add_u32 m0, s0, 42240
	s_mov_b32 s1, 393216
	s_waitcnt lgkmcnt(8)
	v_mfma_f32_32x32x16_bf16 v[40:55], a[72:75], v[88:91], v[40:55]
	ds_read_b128 v[84:87], v16 offset:25600
	v_fma_f32 v129, v129, v113, v112
	v_fma_f32 v130, v130, v113, v112
	v_fma_f32 v131, v131, v113, v112
	v_mul_f32 v128, v128, v64
	buffer_load_dwordx4 v10, s[24:27], s1 offen lds
	v_mfma_f32_32x32x16_bf16 v[40:55], a[76:79], v[92:95], v[40:55]
	ds_read_b128 v[88:91], v16 offset:26624
	v_mul_f32 v129, v129, v65
	v_mul_f32 v130, v130, v66
	v_mul_f32 v131, v131, v67
	v_exp_f32 v128, v128
	buffer_load_dwordx4 v23, s[24:27], s1 offen offset:1056 lds
	s_waitcnt vmcnt(8)
	v_mfma_f32_32x32x16_bf16 v[40:55], a[80:83], v[96:99], v[40:55]
	ds_read_b128 v[92:95], v16 offset:27648
	v_exp_f32 v129, v129
	v_exp_f32 v130, v130
	v_exp_f32 v131, v131
	ds_read_b64_tr_b16 v[200:201], v11 offset:46464
	s_waitcnt lgkmcnt(5)
	v_mfma_f32_32x32x16_bf16 v[40:55], a[84:87], v[100:103], v[40:55]
	ds_read_b128 v[96:99], v16 offset:28672
	v_fma_f32 v128, v128, v114, v114
	v_fma_f32 v129, v129, v114, v114
	v_fma_f32 v130, v130, v114, v114
	v_fma_f32 v131, v131, v114, v114
	ds_read_b64_tr_b16 v[202:203], v11 offset:47520
	ds_read_b64_tr_b16 v[204:205], v12 offset:46464
	v_mfma_f32_32x32x16_bf16 v[40:55], a[88:91], v[72:75], v[40:55]
	ds_read_b128 v[100:103], v16 offset:29696
	v_rcp_f32 v128, v128
	v_rcp_f32 v129, v129
	v_rcp_f32 v130, v130
	v_rcp_f32 v131, v131
	ds_read_b64_tr_b16 v[206:207], v12 offset:47520
	v_mfma_f32_32x32x16_bf16 v[40:55], a[92:95], v[76:79], v[40:55]
	ds_read_b128 v[72:75], v16 offset:30720
	v_mul_f32 v128, v128, v64
	v_mul_f32 v129, v129, v65
	v_mul_f32 v130, v130, v66
	v_mul_f32 v131, v131, v67
	s_add_u32 m0, s0, 44352
	s_waitcnt lgkmcnt(8)
	v_mfma_f32_32x32x16_bf16 v[40:55], a[96:99], v[80:83], v[40:55]
	ds_read_b128 v[76:79], v16 offset:31744
	v_cvt_pk_bf16_f32 v120, v128, v129
	v_cvt_pk_bf16_f32 v121, v130, v131
	v_mul_f32 v132, v68, v68
	v_mul_f32 v133, v69, v69
	s_mov_b32 s1, 409600
	v_mfma_f32_32x32x16_bf16 v[40:55], a[100:103], v[84:87], v[40:55]
	ds_read_b128 v[80:83], v17 offset:2048
	v_mul_f32 v134, v70, v70
	v_mul_f32 v135, v71, v71
	v_fma_f32 v132, v132, v113, v112
	v_fma_f32 v133, v133, v113, v112
	buffer_load_dwordx4 v10, s[24:27], s1 offen lds
	buffer_load_dwordx4 v23, s[24:27], s1 offen offset:1056 lds
	v_mfma_f32_32x32x16_bf16 v[40:55], a[104:107], v[88:91], v[40:55]
	v_fma_f32 v134, v134, v113, v112
	v_fma_f32 v135, v135, v113, v112
	v_mul_f32 v132, v132, v68
	s_waitcnt vmcnt(8)
	s_waitcnt lgkmcnt(4)
	v_mfma_f32_32x32x16_bf16 v[40:55], a[108:111], v[92:95], v[40:55]
	v_mul_f32 v133, v133, v69
	v_mul_f32 v134, v134, v70
	v_mul_f32 v135, v135, v71
	v_exp_f32 v132, v132
	ds_read_b64_tr_b16 v[208:209], v11 offset:48576
	ds_read_b64_tr_b16 v[210:211], v11 offset:49632
	v_mfma_f32_32x32x16_bf16 v[40:55], a[112:115], v[96:99], v[40:55]
	v_exp_f32 v133, v133
	v_exp_f32 v134, v134
	v_exp_f32 v135, v135
	v_fma_f32 v132, v132, v114, v114
	ds_read_b64_tr_b16 v[212:213], v12 offset:48576
	v_mfma_f32_32x32x16_bf16 v[40:55], a[116:119], v[100:103], v[40:55]
	v_fma_f32 v133, v133, v114, v114
	v_fma_f32 v134, v134, v114, v114
	v_fma_f32 v135, v135, v114, v114
	v_rcp_f32 v132, v132
	ds_read_b64_tr_b16 v[214:215], v12 offset:49632
	s_waitcnt lgkmcnt(7)
	s_waitcnt lgkmcnt(4)
	v_mfma_f32_32x32x16_bf16 v[40:55], a[120:123], v[72:75], v[40:55]
	s_barrier
	ds_read_b128 v[84:87], v5 offset:0
	ds_read_b128 v[88:91], v5 offset:1024
	ds_read_b128 v[92:95], v5 offset:2048
	ds_read_b128 v[96:99], v5 offset:3072
	ds_read_b128 v[100:103], v5 offset:4096
	v_rcp_f32 v133, v133
	v_rcp_f32 v134, v134
	v_rcp_f32 v135, v135
	v_mul_f32 v132, v132, v68
	s_add_u32 m0, s0, 46464
	v_mfma_f32_32x32x16_bf16 v[40:55], a[124:127], v[76:79], v[40:55]
	ds_read_b128 v[72:75], v5 offset:5120
	v_mul_f32 v133, v133, v69
	v_mul_f32 v134, v134, v70
	v_mul_f32 v135, v135, v71
	v_cvt_pk_bf16_f32 v122, v132, v133
	s_mov_b32 s1, 425984
	buffer_load_dwordx4 v10, s[24:27], s1 offen lds
	v_mfma_f32_32x32x16_bf16 v[40:55], v[124:127], v[80:83], v[40:55]
	ds_read_b128 v[76:79], v5 offset:6144
	v_cvt_pk_bf16_f32 v123, v134, v135
	s_mov_b32 s54, 229376
	buffer_store_dwordx4 v[120:123], v19, s[44:47], s54 offen offset:1024 sc1
	ds_read_b128 v[112:115], v18 offset:1024
	buffer_load_dwordx4 v23, s[24:27], s1 offen offset:1056 lds
	s_waitcnt lgkmcnt(5)
	v_mfma_f32_32x32x16_bf16 v[56:71], a[0:3], v[84:87], 0
	ds_read_b128 v[80:83], v5 offset:7168
	s_waitcnt vmcnt(8)
	ds_read_b64_tr_b16 v[216:217], v11 offset:50688
	v_mfma_f32_32x32x16_bf16 v[56:71], a[4:7], v[88:91], v[56:71]
	ds_read_b128 v[84:87], v5 offset:8192
	v_mul_f32 v128, v40, v40
	v_mul_f32 v129, v41, v41
	v_mul_f32 v130, v42, v42
	v_mul_f32 v131, v43, v43
	ds_read_b64_tr_b16 v[218:219], v11 offset:51744
	v_mfma_f32_32x32x16_bf16 v[56:71], a[8:11], v[92:95], v[56:71]
	ds_read_b128 v[88:91], v5 offset:9216
	s_waitcnt lgkmcnt(5)
	v_fma_f32 v128, v128, v113, v112
	v_fma_f32 v129, v129, v113, v112
	v_fma_f32 v130, v130, v113, v112
	v_fma_f32 v131, v131, v113, v112
	ds_read_b64_tr_b16 v[220:221], v12 offset:50688
	v_mfma_f32_32x32x16_bf16 v[56:71], a[12:15], v[96:99], v[56:71]
	ds_read_b128 v[92:95], v5 offset:10240
	v_mul_f32 v128, v128, v40
	v_mul_f32 v129, v129, v41
	v_mul_f32 v130, v130, v42
	v_mul_f32 v131, v131, v43
	ds_read_b64_tr_b16 v[222:223], v12 offset:51744
	v_mfma_f32_32x32x16_bf16 v[56:71], a[16:19], v[100:103], v[56:71]
	ds_read_b128 v[96:99], v5 offset:11264
	v_exp_f32 v128, v128
	v_exp_f32 v129, v129
	v_exp_f32 v130, v130
	v_exp_f32 v131, v131
	s_add_u32 m0, s0, 48576
	v_mfma_f32_32x32x16_bf16 v[56:71], a[20:23], v[72:75], v[56:71]
	ds_read_b128 v[100:103], v5 offset:12288
	v_fma_f32 v128, v128, v114, v114
	v_fma_f32 v129, v129, v114, v114
	v_fma_f32 v130, v130, v114, v114
	v_fma_f32 v131, v131, v114, v114
	s_mov_b32 s1, 442368
	s_waitcnt lgkmcnt(7)
	v_mfma_f32_32x32x16_bf16 v[56:71], a[24:27], v[76:79], v[56:71]
	ds_read_b128 v[72:75], v5 offset:13312
	v_rcp_f32 v128, v128
	v_rcp_f32 v129, v129
	v_rcp_f32 v130, v130
	v_rcp_f32 v131, v131
	buffer_load_dwordx4 v10, s[24:27], s1 offen lds
	v_mfma_f32_32x32x16_bf16 v[56:71], a[28:31], v[80:83], v[56:71]
	ds_read_b128 v[76:79], v5 offset:14336
	v_mul_f32 v128, v128, v40
	v_mul_f32 v129, v129, v41
	v_mul_f32 v130, v130, v42
	buffer_load_dwordx4 v23, s[24:27], s1 offen offset:1056 lds
	v_mfma_f32_32x32x16_bf16 v[56:71], a[32:35], v[84:87], v[56:71]
	ds_read_b128 v[80:83], v5 offset:15360
	v_mul_f32 v131, v131, v43
	v_cvt_pk_bf16_f32 v116, v128, v129
	v_cvt_pk_bf16_f32 v117, v130, v131
	v_mul_f32 v132, v44, v44
	s_waitcnt vmcnt(7)
	ds_read_b64_tr_b16 v[224:225], v11 offset:42240
	s_waitcnt lgkmcnt(5)
	v_mfma_f32_32x32x16_bf16 v[56:71], a[36:39], v[88:91], v[56:71]
	ds_read_b128 v[84:87], v5 offset:16384
	v_mul_f32 v133, v45, v45
	v_mul_f32 v134, v46, v46
	v_mul_f32 v135, v47, v47
	v_fma_f32 v132, v132, v113, v112
	ds_read_b64_tr_b16 v[226:227], v11 offset:43296
	v_mfma_f32_32x32x16_bf16 v[56:71], a[40:43], v[92:95], v[56:71]
	ds_read_b128 v[88:91], v5 offset:17408
	v_fma_f32 v133, v133, v113, v112
	v_fma_f32 v134, v134, v113, v112
	v_fma_f32 v135, v135, v113, v112
	v_mul_f32 v132, v132, v44
	ds_read_b64_tr_b16 v[228:229], v12 offset:42240
	v_mfma_f32_32x32x16_bf16 v[56:71], a[44:47], v[96:99], v[56:71]
	ds_read_b128 v[92:95], v5 offset:18432
	v_mul_f32 v133, v133, v45
	v_mul_f32 v134, v134, v46
	v_mul_f32 v135, v135, v47
	v_exp_f32 v132, v132
	ds_read_b64_tr_b16 v[230:231], v12 offset:43296
	s_waitcnt lgkmcnt(8)
	v_mfma_f32_32x32x16_bf16 v[56:71], a[48:51], v[100:103], v[56:71]
	ds_read_b128 v[96:99], v5 offset:19456
	v_exp_f32 v133, v133
	v_exp_f32 v134, v134
	v_exp_f32 v135, v135
	v_fma_f32 v132, v132, v114, v114
	s_waitcnt vmcnt(5)
	ds_read_b64_tr_b16 v[232:233], v11 offset:44352
	v_mfma_f32_32x32x16_bf16 v[56:71], a[52:55], v[72:75], v[56:71]
	ds_read_b128 v[100:103], v5 offset:20480
	v_fma_f32 v133, v133, v114, v114
	v_fma_f32 v134, v134, v114, v114
	v_fma_f32 v135, v135, v114, v114
	ds_read_b64_tr_b16 v[234:235], v11 offset:45408
	v_mfma_f32_32x32x16_bf16 v[56:71], a[56:59], v[76:79], v[56:71]
	ds_read_b128 v[72:75], v5 offset:21504
	v_rcp_f32 v132, v132
	v_rcp_f32 v133, v133
	v_rcp_f32 v134, v134
	v_rcp_f32 v135, v135
	s_waitcnt vmcnt(3)
	buffer_store_dword v8, v20, s[44:47], 0 offen offset:512
	ds_read_b64_tr_b16 v[236:237], v12 offset:44352
	s_waitcnt lgkmcnt(9)
	v_mfma_f32_32x32x16_bf16 v[56:71], a[60:63], v[80:83], v[56:71]
	ds_read_b128 v[76:79], v5 offset:22528
	v_mul_f32 v132, v132, v44
	v_mul_f32 v133, v133, v45
	v_mul_f32 v134, v134, v46
	v_mul_f32 v135, v135, v47
	ds_read_b64_tr_b16 v[238:239], v12 offset:45408
	v_mfma_f32_32x32x16_bf16 v[56:71], a[64:67], v[84:87], v[56:71]
	ds_read_b128 v[80:83], v5 offset:23552
	v_cvt_pk_bf16_f32 v118, v132, v133
	v_cvt_pk_bf16_f32 v119, v134, v135
	s_mov_b32 s54, 114688
	buffer_store_dwordx4 v[116:119], v19, s[44:47], s54 offen offset:0 sc1
	v_mul_f32 v128, v48, v48
	s_waitcnt vmcnt(4)
	ds_read_b64_tr_b16 v[240:241], v11 offset:46464
	v_mfma_f32_32x32x16_bf16 v[56:71], a[68:71], v[88:91], v[56:71]
	ds_read_b128 v[84:87], v5 offset:24576
	v_mul_f32 v129, v49, v49
	v_mul_f32 v130, v50, v50
	v_mul_f32 v131, v51, v51
	v_fma_f32 v128, v128, v113, v112
	ds_read_b64_tr_b16 v[242:243], v11 offset:47520
	s_waitcnt lgkmcnt(9)
	v_mfma_f32_32x32x16_bf16 v[56:71], a[72:75], v[92:95], v[56:71]
	ds_read_b128 v[88:91], v5 offset:25600
	v_fma_f32 v129, v129, v113, v112
	v_fma_f32 v130, v130, v113, v112
	v_fma_f32 v131, v131, v113, v112
	v_mul_f32 v128, v128, v48
	ds_read_b64_tr_b16 v[244:245], v12 offset:46464
	v_mfma_f32_32x32x16_bf16 v[56:71], a[76:79], v[96:99], v[56:71]
	ds_read_b128 v[92:95], v5 offset:26624
	v_mul_f32 v129, v129, v49
	v_mul_f32 v130, v130, v50
	v_mul_f32 v131, v131, v51
	v_exp_f32 v128, v128
	ds_read_b64_tr_b16 v[246:247], v12 offset:47520
	v_mfma_f32_32x32x16_bf16 v[56:71], a[80:83], v[100:103], v[56:71]
	ds_read_b128 v[96:99], v5 offset:27648
	v_exp_f32 v129, v129
	v_exp_f32 v130, v130
	v_exp_f32 v131, v131
	s_waitcnt vmcnt(2)
	ds_read_b64_tr_b16 v[248:249], v11 offset:48576
	s_waitcnt lgkmcnt(9)
	v_mfma_f32_32x32x16_bf16 v[56:71], a[84:87], v[72:75], v[56:71]
	ds_read_b128 v[100:103], v5 offset:28672
	v_fma_f32 v128, v128, v114, v114
	v_fma_f32 v129, v129, v114, v114
	v_fma_f32 v130, v130, v114, v114
	v_fma_f32 v131, v131, v114, v114
	ds_read_b64_tr_b16 v[250:251], v11 offset:49632
	v_mfma_f32_32x32x16_bf16 v[56:71], a[88:91], v[76:79], v[56:71]
	ds_read_b128 v[72:75], v5 offset:29696
	v_rcp_f32 v128, v128
	v_rcp_f32 v129, v129
	v_rcp_f32 v130, v130
	v_rcp_f32 v131, v131
	ds_read_b64_tr_b16 v[252:253], v12 offset:48576
	v_mfma_f32_32x32x16_bf16 v[56:71], a[92:95], v[80:83], v[56:71]
	ds_read_b128 v[76:79], v5 offset:30720
	v_mul_f32 v128, v128, v48
	v_mul_f32 v129, v129, v49
	v_mul_f32 v130, v130, v50
	v_mul_f32 v131, v131, v51
	ds_read_b64_tr_b16 v[254:255], v12 offset:49632
	s_waitcnt lgkmcnt(9)
	v_mfma_f32_32x32x16_bf16 v[56:71], a[96:99], v[84:87], v[56:71]
	ds_read_b128 v[80:83], v5 offset:31744
	v_cvt_pk_bf16_f32 v120, v128, v129
	v_cvt_pk_bf16_f32 v121, v130, v131
	v_mul_f32 v132, v52, v52
	v_mul_f32 v133, v53, v53
	buffer_load_dword v4, v7, s[44:47], 0 offen sc1
	v_mfma_f32_32x32x16_bf16 v[56:71], a[100:103], v[88:91], v[56:71]
	ds_read_b128 v[84:87], v17 offset:3072
	v_mul_f32 v134, v54, v54
	v_mul_f32 v135, v55, v55
	v_fma_f32 v132, v132, v113, v112
	v_fma_f32 v133, v133, v113, v112
	v_mfma_f32_32x32x16_bf16 v[56:71], a[104:107], v[92:95], v[56:71]
	v_fma_f32 v134, v134, v113, v112
	v_fma_f32 v135, v135, v113, v112
	v_mul_f32 v132, v132, v52
	s_waitcnt lgkmcnt(5)
	v_mfma_f32_32x32x16_bf16 v[56:71], a[108:111], v[96:99], v[56:71]
	v_mul_f32 v133, v133, v53
	v_mul_f32 v134, v134, v54
	v_mul_f32 v135, v135, v55
	v_exp_f32 v132, v132
	v_mfma_f32_32x32x16_bf16 v[56:71], a[112:115], v[100:103], v[56:71]
	v_exp_f32 v133, v133
	v_exp_f32 v134, v134
	v_exp_f32 v135, v135
	v_fma_f32 v132, v132, v114, v114
	v_mfma_f32_32x32x16_bf16 v[56:71], a[116:119], v[72:75], v[56:71]
	v_fma_f32 v133, v133, v114, v114
	v_fma_f32 v134, v134, v114, v114
	v_fma_f32 v135, v135, v114, v114
	v_rcp_f32 v132, v132
	s_waitcnt lgkmcnt(0)
	v_mfma_f32_32x32x16_bf16 v[56:71], a[120:123], v[76:79], v[56:71]
	v_rcp_f32 v133, v133
	v_rcp_f32 v134, v134
	v_rcp_f32 v135, v135
	v_mul_f32 v132, v132, v52
	v_mfma_f32_32x32x16_bf16 v[56:71], a[124:127], v[80:83], v[56:71]
	v_mul_f32 v133, v133, v53
	v_mul_f32 v134, v134, v54
	v_mul_f32 v135, v135, v55
	v_cvt_pk_bf16_f32 v122, v132, v133
	v_mfma_f32_32x32x16_bf16 v[56:71], v[124:127], v[84:87], v[56:71]
	v_cvt_pk_bf16_f32 v123, v134, v135
	s_mov_b32 s54, 114688
	buffer_store_dwordx4 v[120:123], v19, s[44:47], s54 offen offset:1024 sc1
	ds_read_b128 v[112:115], v18 offset:1536
	s_mul_i32 s57, s50, 229376
	s_mul_i32 s55, s52, 28672
	s_add_u32 s57, s57, s55
	s_add_u32 s57, s57, 8388608
	s_waitcnt vmcnt(1)
	v_cmp_ne_u32 vcc, s53, v4
	s_cbranch_vccz ok_16
	s_mov_b32 s58, 200000
poll_17:
	buffer_load_dword v4, v7, s[44:47], 0 offen sc1
	s_waitcnt vmcnt(0)
	v_cmp_ne_u32 vcc, s53, v4
	s_cbranch_vccz pdone_18
	s_sub_u32 s58, s58, 1
	s_cbranch_scc0 poll_17
pdone_18:
ok_16:
P4F:
	s_nop 0
	v_mul_f32 v72, v56, v56
	s_add_u32 s56, s57, 0
	buffer_load_dwordx4 a[0:3], v5, s[44:47], s56 offen offset:0 sc1
	v_mul_f32 v73, v57, v57
	v_mul_f32 v74, v58, v58
	v_mul_f32 v75, v59, v59
	s_waitcnt lgkmcnt(0)
	v_fma_f32 v72, v72, v113, v112
	v_fma_f32 v73, v73, v113, v112
	v_fma_f32 v74, v74, v113, v112
	v_fma_f32 v75, v75, v113, v112
	v_mul_f32 v72, v72, v56
	v_mul_f32 v73, v73, v57
	v_mul_f32 v74, v74, v58
	v_mul_f32 v75, v75, v59
	buffer_load_dwordx4 a[4:7], v5, s[44:47], s56 offen offset:1024 sc1
	v_exp_f32 v72, v72
	v_exp_f32 v73, v73
	v_exp_f32 v74, v74
	v_exp_f32 v75, v75
	v_fma_f32 v72, v72, v114, v114
	v_fma_f32 v73, v73, v114, v114
	v_fma_f32 v74, v74, v114, v114
	v_fma_f32 v75, v75, v114, v114
	v_rcp_f32 v72, v72
	v_rcp_f32 v73, v73
	v_rcp_f32 v74, v74
	buffer_load_dwordx4 a[8:11], v5, s[44:47], s56 offen offset:2048 sc1
	v_rcp_f32 v75, v75
	v_mul_f32 v72, v72, v56
	v_mul_f32 v73, v73, v57
	v_mul_f32 v74, v74, v58
	v_mul_f32 v75, v75, v59
	v_cvt_pk_bf16_f32 v116, v72, v73
	v_cvt_pk_bf16_f32 v117, v74, v75
	v_mul_f32 v76, v60, v60
	v_mul_f32 v77, v61, v61
	v_mul_f32 v78, v62, v62
	v_mul_f32 v79, v63, v63
	buffer_load_dwordx4 a[12:15], v5, s[44:47], s56 offen offset:3072 sc1
	v_fma_f32 v76, v76, v113, v112
	v_fma_f32 v77, v77, v113, v112
	v_fma_f32 v78, v78, v113, v112
	v_fma_f32 v79, v79, v113, v112
	v_mul_f32 v76, v76, v60
	v_mul_f32 v77, v77, v61
	v_mul_f32 v78, v78, v62
	s_waitcnt vmcnt(4)
	buffer_store_dword v8, v20, s[44:47], 0 offen offset:256
	v_mul_f32 v79, v79, v63
	v_exp_f32 v76, v76
	v_exp_f32 v77, v77
	v_exp_f32 v78, v78
	s_add_u32 s56, s57, 4096
	buffer_load_dwordx4 a[16:19], v5, s[44:47], s56 offen offset:0 sc1
	v_exp_f32 v79, v79
	v_fma_f32 v76, v76, v114, v114
	v_fma_f32 v77, v77, v114, v114
	v_fma_f32 v78, v78, v114, v114
	v_fma_f32 v79, v79, v114, v114
	v_rcp_f32 v76, v76
	v_rcp_f32 v77, v77
	v_rcp_f32 v78, v78
	v_rcp_f32 v79, v79
	v_mul_f32 v76, v76, v60
	v_mul_f32 v77, v77, v61
	buffer_load_dwordx4 a[20:23], v5, s[44:47], s56 offen offset:1024 sc1
	v_mul_f32 v78, v78, v62
	v_mul_f32 v79, v79, v63
	v_cvt_pk_bf16_f32 v118, v76, v77
	v_cvt_pk_bf16_f32 v119, v78, v79
	s_mov_b32 s54, 344064
	buffer_store_dwordx4 v[116:119], v19, s[44:47], s54 offen offset:0 sc1
	v_mul_f32 v72, v64, v64
	v_mul_f32 v73, v65, v65
	v_mul_f32 v74, v66, v66
	v_mul_f32 v75, v67, v67
	v_fma_f32 v72, v72, v113, v112
	v_fma_f32 v73, v73, v113, v112
	buffer_load_dwordx4 a[24:27], v5, s[44:47], s56 offen offset:2048 sc1
	v_fma_f32 v74, v74, v113, v112
	v_fma_f32 v75, v75, v113, v112
	v_mul_f32 v72, v72, v64
	v_mul_f32 v73, v73, v65
	v_mul_f32 v74, v74, v66
	v_mul_f32 v75, v75, v67
	v_exp_f32 v72, v72
	v_exp_f32 v73, v73
	v_exp_f32 v74, v74
	v_exp_f32 v75, v75
	v_fma_f32 v72, v72, v114, v114
	buffer_load_dwordx4 a[28:31], v5, s[44:47], s56 offen offset:3072 sc1
	v_fma_f32 v73, v73, v114, v114
	v_fma_f32 v74, v74, v114, v114
	v_fma_f32 v75, v75, v114, v114
	v_rcp_f32 v72, v72
	v_rcp_f32 v73, v73
	v_rcp_f32 v74, v74
	v_rcp_f32 v75, v75
	v_mul_f32 v72, v72, v64
	v_mul_f32 v73, v73, v65
	v_mul_f32 v74, v74, v66
	v_mul_f32 v75, v75, v67
	s_add_u32 s56, s57, 8192
	buffer_load_dwordx4 a[32:35], v5, s[44:47], s56 offen offset:0 sc1
	v_cvt_pk_bf16_f32 v120, v72, v73
	v_cvt_pk_bf16_f32 v121, v74, v75
	v_mul_f32 v76, v68, v68
	v_mul_f32 v77, v69, v69
	v_mul_f32 v78, v70, v70
	v_mul_f32 v79, v71, v71
	v_fma_f32 v76, v76, v113, v112
	v_fma_f32 v77, v77, v113, v112
	v_fma_f32 v78, v78, v113, v112
	v_fma_f32 v79, v79, v113, v112
	v_mul_f32 v76, v76, v68
	buffer_load_dwordx4 a[36:39], v5, s[44:47], s56 offen offset:1024 sc1
	v_mul_f32 v77, v77, v69
	v_mul_f32 v78, v78, v70
	v_mul_f32 v79, v79, v71
	v_exp_f32 v76, v76
	v_exp_f32 v77, v77
	v_exp_f32 v78, v78
	v_exp_f32 v79, v79
	v_fma_f32 v76, v76, v114, v114
	v_fma_f32 v77, v77, v114, v114
	v_fma_f32 v78, v78, v114, v114
	v_fma_f32 v79, v79, v114, v114
	buffer_load_dwordx4 a[40:43], v5, s[44:47], s56 offen offset:2048 sc1
	v_rcp_f32 v76, v76
	v_rcp_f32 v77, v77
	v_rcp_f32 v78, v78
	v_rcp_f32 v79, v79
	v_mul_f32 v76, v76, v68
	v_mul_f32 v77, v77, v69
	v_mul_f32 v78, v78, v70
	v_mul_f32 v79, v79, v71
	v_cvt_pk_bf16_f32 v122, v76, v77
	v_cvt_pk_bf16_f32 v123, v78, v79
	s_mov_b32 s54, 344064
	buffer_store_dwordx4 v[120:123], v19, s[44:47], s54 offen offset:1024 sc1
	s_waitcnt vmcnt(13)
	v_mfma_f32_32x32x16_bf16 v[128:143], a[128:131], a[0:3], 0
	buffer_load_dwordx4 a[44:47], v5, s[44:47], s56 offen offset:3072 sc1
	v_mfma_f32_32x32x16_bf16 v[144:159], a[132:135], a[0:3], 0
	s_waitcnt vmcnt(13)
	v_mfma_f32_32x32x16_bf16 v[128:143], a[136:139], a[4:7], v[128:143]
	s_add_u32 s56, s57, 12288
	v_mfma_f32_32x32x16_bf16 v[144:159], a[140:143], a[4:7], v[144:159]
	buffer_load_dwordx4 a[48:51], v5, s[44:47], s56 offen offset:0 sc1
	s_waitcnt vmcnt(13)
	v_mfma_f32_32x32x16_bf16 v[128:143], a[144:147], a[8:11], v[128:143]
	buffer_load_dwordx4 a[52:55], v5, s[44:47], s56 offen offset:1024 sc1
	v_mfma_f32_32x32x16_bf16 v[144:159], a[148:151], a[8:11], v[144:159]
	s_waitcnt vmcnt(13)
	v_mfma_f32_32x32x16_bf16 v[128:143], a[152:155], a[12:15], v[128:143]
	buffer_load_dwordx4 a[56:59], v5, s[44:47], s56 offen offset:2048 sc1
	v_mfma_f32_32x32x16_bf16 v[144:159], a[156:159], a[12:15], v[144:159]
	s_waitcnt vmcnt(12)
	v_mfma_f32_32x32x16_bf16 v[128:143], a[160:163], a[16:19], v[128:143]
	buffer_load_dwordx4 a[60:63], v5, s[44:47], s56 offen offset:3072 sc1
	v_mfma_f32_32x32x16_bf16 v[144:159], a[164:167], a[16:19], v[144:159]
	s_waitcnt vmcnt(12)
	v_mfma_f32_32x32x16_bf16 v[128:143], a[168:171], a[20:23], v[128:143]
	s_add_u32 s56, s57, 16384
	v_mfma_f32_32x32x16_bf16 v[144:159], a[172:175], a[20:23], v[144:159]
	buffer_load_dwordx4 a[64:67], v5, s[44:47], s56 offen offset:0 sc1
	s_waitcnt vmcnt(11)
	v_mfma_f32_32x32x16_bf16 v[128:143], a[176:179], a[24:27], v[128:143]
	buffer_load_dwordx4 a[68:71], v5, s[44:47], s56 offen offset:1024 sc1
	v_mfma_f32_32x32x16_bf16 v[144:159], a[180:183], a[24:27], v[144:159]
	s_waitcnt vmcnt(7)
	buffer_store_dword v8, v20, s[44:47], 0 offen offset:768
	v_mfma_f32_32x32x16_bf16 v[128:143], a[184:187], a[28:31], v[128:143]
	buffer_load_dwordx4 a[72:75], v5, s[44:47], s56 offen offset:2048 sc1
	v_mfma_f32_32x32x16_bf16 v[144:159], a[188:191], a[28:31], v[144:159]
	v_mfma_f32_32x32x16_bf16 v[128:143], a[192:195], a[32:35], v[128:143]
	buffer_load_dwordx4 a[76:79], v5, s[44:47], s56 offen offset:3072 sc1
	v_mfma_f32_32x32x16_bf16 v[144:159], a[196:199], a[32:35], v[144:159]
	v_mfma_f32_32x32x16_bf16 v[128:143], a[200:203], a[36:39], v[128:143]
	s_add_u32 s56, s57, 20480
	v_mfma_f32_32x32x16_bf16 v[144:159], a[204:207], a[36:39], v[144:159]
	buffer_load_dwordx4 a[80:83], v5, s[44:47], s56 offen offset:0 sc1
	v_mfma_f32_32x32x16_bf16 v[128:143], a[208:211], a[40:43], v[128:143]
	buffer_load_dwordx4 a[84:87], v5, s[44:47], s56 offen offset:1024 sc1
	v_mfma_f32_32x32x16_bf16 v[144:159], a[212:215], a[40:43], v[144:159]
	buffer_load_dword v4, v7, s[44:47], 0 offen offset:256 sc1
	s_waitcnt vmcnt(12)
	v_mfma_f32_32x32x16_bf16 v[128:143], a[216:219], a[44:47], v[128:143]
	buffer_load_dwordx4 a[88:91], v5, s[44:47], s56 offen offset:2048 sc1
	v_mfma_f32_32x32x16_bf16 v[144:159], a[220:223], a[44:47], v[144:159]
	s_waitcnt vmcnt(12)
	v_mfma_f32_32x32x16_bf16 v[128:143], a[224:227], a[48:51], v[128:143]
	buffer_load_dwordx4 a[92:95], v5, s[44:47], s56 offen offset:3072 sc1
	v_mfma_f32_32x32x16_bf16 v[144:159], a[228:231], a[48:51], v[144:159]
	s_waitcnt vmcnt(12)
	v_mfma_f32_32x32x16_bf16 v[128:143], a[232:235], a[52:55], v[128:143]
	s_add_u32 s56, s57, 24576
	v_mfma_f32_32x32x16_bf16 v[144:159], a[236:239], a[52:55], v[144:159]
	buffer_load_dwordx4 a[96:99], v5, s[44:47], s56 offen offset:0 sc1
	s_waitcnt vmcnt(12)
	v_mfma_f32_32x32x16_bf16 v[128:143], a[240:243], a[56:59], v[128:143]
	buffer_load_dwordx4 a[100:103], v5, s[44:47], s56 offen offset:1024 sc1
	v_mfma_f32_32x32x16_bf16 v[144:159], a[244:247], a[56:59], v[144:159]
	s_waitcnt vmcnt(12)
	v_mfma_f32_32x32x16_bf16 v[128:143], a[248:251], a[60:63], v[128:143]
	buffer_load_dwordx4 a[104:107], v5, s[44:47], s56 offen offset:2048 sc1
	v_mfma_f32_32x32x16_bf16 v[144:159], a[252:255], a[60:63], v[144:159]
	s_waitcnt vmcnt(12)
	v_mfma_f32_32x32x16_bf16 v[128:143], v[160:163], a[64:67], v[128:143]
	buffer_load_dwordx4 a[108:111], v5, s[44:47], s56 offen offset:3072 sc1
	v_mfma_f32_32x32x16_bf16 v[144:159], v[164:167], a[64:67], v[144:159]
	s_waitcnt vmcnt(6)
	v_cmp_ne_u32 vcc, s53, v4
	s_cbranch_vccz ok_19
	s_mov_b32 s58, 200000
poll_20:
	buffer_load_dword v4, v7, s[44:47], 0 offen offset:256 sc1
	s_waitcnt vmcnt(0)
	v_cmp_ne_u32 vcc, s53, v4
	s_cbranch_vccz pdone_21
	s_sub_u32 s58, s58, 1
	s_cbranch_scc0 poll_20
pdone_21:
ok_19:
	v_mfma_f32_32x32x16_bf16 v[128:143], v[168:171], a[68:71], v[128:143]
	s_add_u32 s56, s57, 114688
	v_mfma_f32_32x32x16_bf16 v[144:159], v[172:175], a[68:71], v[144:159]
	buffer_load_dwordx4 a[112:115], v5, s[44:47], s56 offen offset:0 sc1
	v_mfma_f32_32x32x16_bf16 v[128:143], v[176:179], a[72:75], v[128:143]
	buffer_load_dwordx4 a[116:119], v5, s[44:47], s56 offen offset:1024 sc1
	v_mfma_f32_32x32x16_bf16 v[144:159], v[180:183], a[72:75], v[144:159]
	v_mfma_f32_32x32x16_bf16 v[128:143], v[184:187], a[76:79], v[128:143]
	buffer_load_dwordx4 a[120:123], v5, s[44:47], s56 offen offset:2048 sc1
	v_mfma_f32_32x32x16_bf16 v[144:159], v[188:191], a[76:79], v[144:159]
	v_mfma_f32_32x32x16_bf16 v[128:143], v[192:195], a[80:83], v[128:143]
	buffer_load_dwordx4 a[124:127], v5, s[44:47], s56 offen offset:3072 sc1
	v_lshlrev_b32 v96, 16, v104
	v_and_b32 v97, s67, v104
	v_mfma_f32_32x32x16_bf16 v[144:159], v[196:199], a[80:83], v[144:159]
	v_lshlrev_b32 v98, 16, v105
	v_and_b32 v99, s67, v105
	v_lshlrev_b32 v100, 16, v106
	v_mfma_f32_32x32x16_bf16 v[128:143], v[200:203], a[84:87], v[128:143]
	s_add_u32 s56, s57, 118784
	buffer_load_dwordx4 a[0:3], v5, s[44:47], s56 offen offset:0 sc1
	v_and_b32 v101, s67, v106
	v_lshlrev_b32 v102, 16, v107
	v_mfma_f32_32x32x16_bf16 v[144:159], v[204:207], a[84:87], v[144:159]
	v_and_b32 v103, s67, v107
	v_lshlrev_b32 v112, 16, v108
	v_and_b32 v113, s67, v108
	s_waitcnt vmcnt(10)
	v_mfma_f32_32x32x16_bf16 v[128:143], v[208:211], a[88:91], v[128:143]
	buffer_load_dwordx4 a[4:7], v5, s[44:47], s56 offen offset:1024 sc1
	v_lshlrev_b32 v114, 16, v109
	v_and_b32 v115, s67, v109
	v_mfma_f32_32x32x16_bf16 v[144:159], v[212:215], a[88:91], v[144:159]
	v_lshlrev_b32 v116, 16, v110
	v_and_b32 v117, s67, v110
	v_lshlrev_b32 v118, 16, v111
	s_waitcnt vmcnt(10)
	v_mfma_f32_32x32x16_bf16 v[128:143], v[216:219], a[92:95], v[128:143]
	buffer_load_dwordx4 a[8:11], v5, s[44:47], s56 offen offset:2048 sc1
	v_and_b32 v119, s67, v111
	s_xor_b32 s54, s52, 1
	v_mfma_f32_32x32x16_bf16 v[144:159], v[220:223], a[92:95], v[144:159]
	s_mul_i32 s54, s54, 6144
	s_add_u32 s54, s54, 0
	v_add_u32 v16, s54, v5
	s_waitcnt vmcnt(10)
	v_mfma_f32_32x32x16_bf16 v[128:143], v[224:227], a[96:99], v[128:143]
	buffer_load_dwordx4 a[12:15], v5, s[44:47], s56 offen offset:3072 sc1
	s_xor_b32 s54, s52, 2
	s_mul_i32 s54, s54, 6144
	v_mfma_f32_32x32x16_bf16 v[144:159], v[228:231], a[96:99], v[144:159]
	s_add_u32 s54, s54, 2048
	v_add_u32 v17, s54, v5
	s_xor_b32 s54, s52, 3
	s_waitcnt vmcnt(10)
	v_mfma_f32_32x32x16_bf16 v[128:143], v[232:235], a[100:103], v[128:143]
	s_add_u32 s56, s57, 122880
	buffer_load_dwordx4 a[16:19], v5, s[44:47], s56 offen offset:0 sc1
	s_mul_i32 s54, s54, 6144
	s_add_u32 s54, s54, 4096
	v_mfma_f32_32x32x16_bf16 v[144:159], v[236:239], a[100:103], v[144:159]
	v_add_u32 v18, s54, v5
	s_mul_i32 s54, s52, 6144
	v_add_u32 v6, s54, v5
	s_waitcnt vmcnt(10)
	v_mfma_f32_32x32x16_bf16 v[128:143], v[240:243], a[104:107], v[128:143]
	buffer_load_dwordx4 a[20:23], v5, s[44:47], s56 offen offset:1024 sc1
	v_and_b32 v9, 31, v0
	v_lshl_add_u32 v9, v9, 1, s59
	v_mfma_f32_32x32x16_bf16 v[144:159], v[244:247], a[104:107], v[144:159]
	v_lshlrev_b32 v9, 10, v9
	v_lshrrev_b32 v21, 5, v0
	v_lshl_add_u32 v9, v21, 4, v9
	s_waitcnt vmcnt(10)
	v_mfma_f32_32x32x16_bf16 v[128:143], v[248:251], a[108:111], v[128:143]
	buffer_load_dwordx4 a[24:27], v5, s[44:47], s56 offen offset:2048 sc1
	s_lshl_b32 s54, s51, 7
	s_lshl_b32 s55, s52, 5
	v_mfma_f32_32x32x16_bf16 v[144:159], v[252:255], a[108:111], v[144:159]
	s_add_u32 s54, s54, s55
	v_add_u32 v9, s54, v9
	s_waitcnt vmcnt(10)
	v_mfma_f32_32x32x16_bf16 v[40:55], a[128:131], a[112:115], 0
	buffer_load_dwordx4 a[28:31], v5, s[44:47], s56 offen offset:3072 sc1
	v_mfma_f32_32x32x16_bf16 v[56:71], a[132:135], a[112:115], 0
	s_waitcnt vmcnt(10)
	v_mfma_f32_32x32x16_bf16 v[40:55], a[136:139], a[116:119], v[40:55]
	s_add_u32 s56, s57, 126976
	buffer_load_dwordx4 a[32:35], v5, s[44:47], s56 offen offset:0 sc1
	ds_write_b128 v16, v[136:139] offset:32768
	ds_write_b128 v16, v[140:143] offset:33792
	v_mfma_f32_32x32x16_bf16 v[56:71], a[140:143], a[116:119], v[56:71]
	ds_write_b128 v17, v[144:147] offset:32768
	ds_write_b128 v17, v[148:151] offset:33792
	ds_write_b128 v18, v[152:155] offset:32768
	ds_write_b128 v18, v[156:159] offset:33792
	s_waitcnt vmcnt(10)
	v_mfma_f32_32x32x16_bf16 v[40:55], a[144:147], a[120:123], v[40:55]
	buffer_load_dwordx4 a[36:39], v5, s[44:47], s56 offen offset:1024 sc1
	v_mfma_f32_32x32x16_bf16 v[56:71], a[148:151], a[120:123], v[56:71]
	s_waitcnt vmcnt(10)
	v_mfma_f32_32x32x16_bf16 v[40:55], a[152:155], a[124:127], v[40:55]
	buffer_load_dwordx4 a[40:43], v5, s[44:47], s56 offen offset:2048 sc1
	v_mfma_f32_32x32x16_bf16 v[56:71], a[156:159], a[124:127], v[56:71]
	s_waitcnt vmcnt(10)
	v_mfma_f32_32x32x16_bf16 v[40:55], a[160:163], a[0:3], v[40:55]
	buffer_load_dwordx4 a[44:47], v5, s[44:47], s56 offen offset:3072 sc1
	v_mfma_f32_32x32x16_bf16 v[56:71], a[164:167], a[0:3], v[56:71]
	s_waitcnt vmcnt(10)
	v_mfma_f32_32x32x16_bf16 v[40:55], a[168:171], a[4:7], v[40:55]
	s_add_u32 s56, s57, 131072
	buffer_load_dwordx4 a[48:51], v5, s[44:47], s56 offen offset:0 sc1
	s_waitcnt lgkmcnt(0)
	s_barrier
	ds_read_b128 v[72:75], v6 offset:32768
	v_mfma_f32_32x32x16_bf16 v[56:71], a[172:175], a[4:7], v[56:71]
	ds_read_b128 v[76:79], v6 offset:33792
	ds_read_b128 v[80:83], v6 offset:34816
	ds_read_b128 v[84:87], v6 offset:35840
	ds_read_b128 v[88:91], v6 offset:36864
	ds_read_b128 v[92:95], v6 offset:37888
	s_waitcnt vmcnt(10)
	v_mfma_f32_32x32x16_bf16 v[40:55], a[176:179], a[8:11], v[40:55]
	buffer_load_dwordx4 a[52:55], v5, s[44:47], s56 offen offset:1024 sc1
	v_mfma_f32_32x32x16_bf16 v[56:71], a[180:183], a[8:11], v[56:71]
	s_waitcnt vmcnt(10)
	v_mfma_f32_32x32x16_bf16 v[40:55], a[184:187], a[12:15], v[40:55]
	buffer_load_dwordx4 a[56:59], v5, s[44:47], s56 offen offset:2048 sc1
	v_add_f32 v128, v128, v112
	v_add_f32 v129, v129, v113
	v_mfma_f32_32x32x16_bf16 v[56:71], a[188:191], a[12:15], v[56:71]
	v_add_f32 v130, v130, v114
	v_add_f32 v131, v131, v115
	v_add_f32 v132, v132, v116
	s_waitcnt vmcnt(10)
	v_mfma_f32_32x32x16_bf16 v[40:55], a[192:195], a[16:19], v[40:55]
	buffer_load_dwordx4 a[60:63], v5, s[44:47], s56 offen offset:3072 sc1
	v_add_f32 v133, v133, v117
	v_add_f32 v134, v134, v118
	v_mfma_f32_32x32x16_bf16 v[56:71], a[196:199], a[16:19], v[56:71]
	v_add_f32 v135, v135, v119
	s_waitcnt lgkmcnt(3)
	v_add_f32 v72, v72, v80
	v_add_f32 v73, v73, v81
	s_waitcnt vmcnt(10)
	v_mfma_f32_32x32x16_bf16 v[40:55], a[200:203], a[20:23], v[40:55]
	s_add_u32 s56, s57, 135168
	buffer_load_dwordx4 a[64:67], v5, s[44:47], s56 offen offset:0 sc1
	v_add_f32 v74, v74, v82
	v_add_f32 v75, v75, v83
	v_mfma_f32_32x32x16_bf16 v[56:71], a[204:207], a[20:23], v[56:71]
	s_waitcnt lgkmcnt(2)
	v_add_f32 v76, v76, v84
	v_add_f32 v77, v77, v85
	v_add_f32 v78, v78, v86
	s_waitcnt vmcnt(10)
	v_mfma_f32_32x32x16_bf16 v[40:55], a[208:211], a[24:27], v[40:55]
	buffer_load_dwordx4 a[68:71], v5, s[44:47], s56 offen offset:1024 sc1
	v_add_f32 v79, v79, v87
	s_waitcnt lgkmcnt(1)
	v_add_f32 v128, v128, v88
	v_mfma_f32_32x32x16_bf16 v[56:71], a[212:215], a[24:27], v[56:71]
	v_add_f32 v129, v129, v89
	v_add_f32 v130, v130, v90
	v_add_f32 v131, v131, v91
	s_waitcnt vmcnt(10)
	v_mfma_f32_32x32x16_bf16 v[40:55], a[216:219], a[28:31], v[40:55]
	buffer_load_dwordx4 a[72:75], v5, s[44:47], s56 offen offset:2048 sc1
	s_waitcnt lgkmcnt(0)
	v_add_f32 v132, v132, v92
	v_add_f32 v133, v133, v93
	v_mfma_f32_32x32x16_bf16 v[56:71], a[220:223], a[28:31], v[56:71]
	v_add_f32 v134, v134, v94
	v_add_f32 v135, v135, v95
	v_add_f32 v128, v128, v72
	s_waitcnt vmcnt(10)
	v_mfma_f32_32x32x16_bf16 v[40:55], a[224:227], a[32:35], v[40:55]
	buffer_load_dwordx4 a[76:79], v5, s[44:47], s56 offen offset:3072 sc1
	v_add_f32 v129, v129, v73
	v_add_f32 v130, v130, v74
	v_mfma_f32_32x32x16_bf16 v[56:71], a[228:231], a[32:35], v[56:71]
	v_add_f32 v131, v131, v75
	v_add_f32 v132, v132, v76
	v_add_f32 v133, v133, v77
	s_waitcnt vmcnt(10)
	v_mfma_f32_32x32x16_bf16 v[40:55], a[232:235], a[36:39], v[40:55]
	s_add_u32 s56, s57, 139264
	buffer_load_dwordx4 a[80:83], v5, s[44:47], s56 offen offset:0 sc1
	v_add_f32 v134, v134, v78
	v_add_f32 v135, v135, v79
	v_mfma_f32_32x32x16_bf16 v[56:71], a[236:239], a[36:39], v[56:71]
	v_fma_f32 v128, v128, v96, v24
	v_fma_f32 v129, v129, v97, v25
	v_fma_f32 v130, v130, v98, v26
	s_waitcnt vmcnt(10)
	v_mfma_f32_32x32x16_bf16 v[40:55], a[240:243], a[40:43], v[40:55]
	buffer_load_dwordx4 a[84:87], v5, s[44:47], s56 offen offset:1024 sc1
	v_fma_f32 v131, v131, v99, v27
	v_fma_f32 v132, v132, v100, v28
	v_mfma_f32_32x32x16_bf16 v[56:71], a[244:247], a[40:43], v[56:71]
	v_fma_f32 v133, v133, v101, v29
	v_fma_f32 v134, v134, v102, v30
	v_fma_f32 v135, v135, v103, v31
	s_waitcnt vmcnt(10)
	v_mfma_f32_32x32x16_bf16 v[40:55], a[248:251], a[44:47], v[40:55]
	buffer_load_dwordx4 a[88:91], v5, s[44:47], s56 offen offset:2048 sc1
	v_cvt_pk_bf16_f32 v128, v128, v129
	v_cvt_pk_bf16_f32 v129, v130, v131
	v_mfma_f32_32x32x16_bf16 v[56:71], a[252:255], a[44:47], v[56:71]
	v_cvt_pk_bf16_f32 v130, v132, v133
	v_cvt_pk_bf16_f32 v131, v134, v135
	s_nop 0
	v_permlane32_swap_b32 v128, v130
	s_waitcnt vmcnt(10)
	v_mfma_f32_32x32x16_bf16 v[40:55], v[160:163], a[48:51], v[40:55]
	buffer_load_dwordx4 a[92:95], v5, s[44:47], s56 offen offset:3072 sc1
	v_permlane32_swap_b32 v129, v131
	v_mfma_f32_32x32x16_bf16 v[56:71], v[164:167], a[48:51], v[56:71]
	buffer_store_dwordx4 v[128:131], v9, s[40:43], 0 offen offset:0
	s_waitcnt vmcnt(11)
	v_mfma_f32_32x32x16_bf16 v[40:55], v[168:171], a[52:55], v[40:55]
	v_mfma_f32_32x32x16_bf16 v[56:71], v[172:175], a[52:55], v[56:71]
	s_waitcnt vmcnt(10)
	v_mfma_f32_32x32x16_bf16 v[40:55], v[176:179], a[56:59], v[40:55]
	v_mfma_f32_32x32x16_bf16 v[56:71], v[180:183], a[56:59], v[56:71]
	s_waitcnt vmcnt(9)
	v_mfma_f32_32x32x16_bf16 v[40:55], v[184:187], a[60:63], v[40:55]
	v_mfma_f32_32x32x16_bf16 v[56:71], v[188:191], a[60:63], v[56:71]
	s_waitcnt vmcnt(8)
	v_mfma_f32_32x32x16_bf16 v[40:55], v[192:195], a[64:67], v[40:55]
	v_mfma_f32_32x32x16_bf16 v[56:71], v[196:199], a[64:67], v[56:71]
	s_waitcnt vmcnt(7)
	v_mfma_f32_32x32x16_bf16 v[40:55], v[200:203], a[68:71], v[40:55]
	v_mfma_f32_32x32x16_bf16 v[56:71], v[204:207], a[68:71], v[56:71]
	s_waitcnt vmcnt(6)
	v_mfma_f32_32x32x16_bf16 v[40:55], v[208:211], a[72:75], v[40:55]
	v_mfma_f32_32x32x16_bf16 v[56:71], v[212:215], a[72:75], v[56:71]
	s_waitcnt vmcnt(5)
	v_mfma_f32_32x32x16_bf16 v[40:55], v[216:219], a[76:79], v[40:55]
	v_mfma_f32_32x32x16_bf16 v[56:71], v[220:223], a[76:79], v[56:71]
	s_waitcnt vmcnt(4)
	v_mfma_f32_32x32x16_bf16 v[40:55], v[224:227], a[80:83], v[40:55]
	v_mfma_f32_32x32x16_bf16 v[56:71], v[228:231], a[80:83], v[56:71]
	s_waitcnt vmcnt(3)
	v_mfma_f32_32x32x16_bf16 v[40:55], v[232:235], a[84:87], v[40:55]
	v_mfma_f32_32x32x16_bf16 v[56:71], v[236:239], a[84:87], v[56:71]
	s_waitcnt vmcnt(2)
	v_mfma_f32_32x32x16_bf16 v[40:55], v[240:243], a[88:91], v[40:55]
	v_mfma_f32_32x32x16_bf16 v[56:71], v[244:247], a[88:91], v[56:71]
	s_waitcnt vmcnt(1)
	v_mfma_f32_32x32x16_bf16 v[40:55], v[248:251], a[92:95], v[40:55]
	v_mfma_f32_32x32x16_bf16 v[56:71], v[252:255], a[92:95], v[56:71]
	s_nop 4
	ds_write_b128 v16, v[48:51] offset:0
	ds_write_b128 v16, v[52:55] offset:1024
	s_nop 4
	ds_write_b128 v17, v[56:59] offset:0
	ds_write_b128 v17, v[60:63] offset:1024
	ds_write_b128 v18, v[64:67] offset:0
	ds_write_b128 v18, v[68:71] offset:1024
	s_waitcnt lgkmcnt(0)
	s_barrier
	ds_read_b128 v[72:75], v6 offset:0
	ds_read_b128 v[76:79], v6 offset:1024
	ds_read_b128 v[80:83], v6 offset:2048
	ds_read_b128 v[84:87], v6 offset:3072
	ds_read_b128 v[88:91], v6 offset:4096
	ds_read_b128 v[92:95], v6 offset:5120
	v_pk_add_f32 v[40:41], v[40:41], v[112:113]
	v_pk_add_f32 v[42:43], v[42:43], v[114:115]
	v_pk_add_f32 v[44:45], v[44:45], v[116:117]
	v_pk_add_f32 v[46:47], v[46:47], v[118:119]
	s_waitcnt lgkmcnt(3)
	v_pk_add_f32 v[72:73], v[72:73], v[80:81]
	v_pk_add_f32 v[74:75], v[74:75], v[82:83]
	s_waitcnt lgkmcnt(2)
	v_pk_add_f32 v[76:77], v[76:77], v[84:85]
	v_pk_add_f32 v[78:79], v[78:79], v[86:87]
	s_waitcnt lgkmcnt(1)
	v_pk_add_f32 v[40:41], v[40:41], v[88:89]
	v_pk_add_f32 v[42:43], v[42:43], v[90:91]
	s_waitcnt lgkmcnt(0)
	v_pk_add_f32 v[44:45], v[44:45], v[92:93]
	v_pk_add_f32 v[46:47], v[46:47], v[94:95]
	v_pk_add_f32 v[40:41], v[40:41], v[72:73]
	v_pk_add_f32 v[42:43], v[42:43], v[74:75]
	v_pk_add_f32 v[44:45], v[44:45], v[76:77]
	v_pk_add_f32 v[46:47], v[46:47], v[78:79]
	v_pk_fma_f32 v[40:41], v[40:41], v[96:97], v[32:33]
	v_pk_fma_f32 v[42:43], v[42:43], v[98:99], v[34:35]
	v_pk_fma_f32 v[44:45], v[44:45], v[100:101], v[36:37]
	v_pk_fma_f32 v[46:47], v[46:47], v[102:103], v[38:39]
	v_cvt_pk_bf16_f32 v40, v40, v41
	v_cvt_pk_bf16_f32 v41, v42, v43
	v_cvt_pk_bf16_f32 v42, v44, v45
	v_cvt_pk_bf16_f32 v43, v46, v47
	s_nop 0
	v_permlane32_swap_b32 v40, v42
	v_permlane32_swap_b32 v41, v43
	buffer_store_dwordx4 v[40:43], v9, s[40:43], 0 offen offset:1024
FINF:
	s_endpgm
IDLEF:
	s_waitcnt lgkmcnt(4)
	s_add_u32 m0, s0, 48576
	s_mov_b32 s1, 196608
	buffer_load_dwordx4 v10, s[24:27], s1 offen lds
	buffer_load_dwordx4 v23, s[24:27], s1 offen offset:1056 lds
	s_waitcnt vmcnt(9)
	ds_read_b64_tr_b16 a[192:193], v11 offset:50688
	ds_read_b64_tr_b16 a[194:195], v11 offset:51744
	ds_read_b64_tr_b16 a[196:197], v12 offset:50688
	ds_read_b64_tr_b16 a[198:199], v12 offset:51744
	s_waitcnt vmcnt(7)
	ds_read_b64_tr_b16 a[200:201], v11 offset:42240
	ds_read_b64_tr_b16 a[202:203], v11 offset:43296
	ds_read_b64_tr_b16 a[204:205], v12 offset:42240
	ds_read_b64_tr_b16 a[206:207], v12 offset:43296
	s_waitcnt lgkmcnt(4)
	s_add_u32 m0, s0, 50688
	s_mov_b32 s1, 212992
	buffer_load_dwordx4 v10, s[24:27], s1 offen lds
	buffer_load_dwordx4 v23, s[24:27], s1 offen offset:1056 lds
	s_waitcnt vmcnt(7)
	ds_read_b64_tr_b16 a[208:209], v11 offset:44352
	ds_read_b64_tr_b16 a[210:211], v11 offset:45408
	ds_read_b64_tr_b16 a[212:213], v12 offset:44352
	ds_read_b64_tr_b16 a[214:215], v12 offset:45408
	s_waitcnt lgkmcnt(4)
	s_add_u32 m0, s0, 42240
	s_mov_b32 s1, 229376
	buffer_load_dwordx4 v10, s[24:27], s1 offen lds
	buffer_load_dwordx4 v23, s[24:27], s1 offen offset:1056 lds
	s_waitcnt vmcnt(7)
	ds_read_b64_tr_b16 a[216:217], v11 offset:46464
	ds_read_b64_tr_b16 a[218:219], v11 offset:47520
	ds_read_b64_tr_b16 a[220:221], v12 offset:46464
	ds_read_b64_tr_b16 a[222:223], v12 offset:47520
	s_waitcnt lgkmcnt(4)
	s_add_u32 m0, s0, 44352
	s_mov_b32 s1, 245760
	buffer_load_dwordx4 v10, s[24:27], s1 offen lds
	buffer_load_dwordx4 v23, s[24:27], s1 offen offset:1056 lds
	s_waitcnt vmcnt(6)
	ds_read_b64_tr_b16 a[224:225], v11 offset:48576
	ds_read_b64_tr_b16 a[226:227], v11 offset:49632
	ds_read_b64_tr_b16 a[228:229], v12 offset:48576
	ds_read_b64_tr_b16 a[230:231], v12 offset:49632
	s_waitcnt lgkmcnt(4)
	s_add_u32 m0, s0, 46464
	s_mov_b32 s1, 262144
	buffer_load_dwordx4 v10, s[24:27], s1 offen lds
	buffer_load_dwordx4 v23, s[24:27], s1 offen offset:1056 lds
	s_waitcnt vmcnt(6)
	ds_read_b64_tr_b16 a[232:233], v11 offset:50688
	ds_read_b64_tr_b16 a[234:235], v11 offset:51744
	ds_read_b64_tr_b16 a[236:237], v12 offset:50688
	ds_read_b64_tr_b16 a[238:239], v12 offset:51744
	s_waitcnt lgkmcnt(4)
	s_add_u32 m0, s0, 48576
	s_mov_b32 s1, 278528
	buffer_load_dwordx4 v10, s[24:27], s1 offen lds
	buffer_load_dwordx4 v23, s[24:27], s1 offen offset:1056 lds
	s_waitcnt vmcnt(6)
	ds_read_b64_tr_b16 a[240:241], v11 offset:42240
	ds_read_b64_tr_b16 a[242:243], v11 offset:43296
	ds_read_b64_tr_b16 a[244:245], v12 offset:42240
	ds_read_b64_tr_b16 a[246:247], v12 offset:43296
	s_waitcnt lgkmcnt(4)
	s_add_u32 m0, s0, 50688
	s_mov_b32 s1, 294912
	buffer_load_dwordx4 v10, s[24:27], s1 offen lds
	buffer_load_dwordx4 v23, s[24:27], s1 offen offset:1056 lds
	s_waitcnt vmcnt(6)
	ds_read_b64_tr_b16 a[248:249], v11 offset:44352
	ds_read_b64_tr_b16 a[250:251], v11 offset:45408
	ds_read_b64_tr_b16 a[252:253], v12 offset:44352
	ds_read_b64_tr_b16 a[254:255], v12 offset:45408
	s_waitcnt lgkmcnt(4)
	s_add_u32 m0, s0, 42240
	s_mov_b32 s1, 311296
	buffer_load_dwordx4 v10, s[24:27], s1 offen lds
	buffer_load_dwordx4 v23, s[24:27], s1 offen offset:1056 lds
	s_waitcnt vmcnt(6)
	ds_read_b64_tr_b16 v[160:161], v11 offset:46464
	ds_read_b64_tr_b16 v[162:163], v11 offset:47520
	ds_read_b64_tr_b16 v[164:165], v12 offset:46464
	ds_read_b64_tr_b16 v[166:167], v12 offset:47520
	s_waitcnt lgkmcnt(4)
	s_add_u32 m0, s0, 44352
	s_mov_b32 s1, 327680
	buffer_load_dwordx4 v10, s[24:27], s1 offen lds
	buffer_load_dwordx4 v23, s[24:27], s1 offen offset:1056 lds
	s_waitcnt vmcnt(6)
	ds_read_b64_tr_b16 v[168:169], v11 offset:48576
	ds_read_b64_tr_b16 v[170:171], v11 offset:49632
	ds_read_b64_tr_b16 v[172:173], v12 offset:48576
	ds_read_b64_tr_b16 v[174:175], v12 offset:49632
	s_waitcnt lgkmcnt(4)
	s_add_u32 m0, s0, 46464
	s_mov_b32 s1, 344064
	buffer_load_dwordx4 v10, s[24:27], s1 offen lds
	buffer_load_dwordx4 v23, s[24:27], s1 offen offset:1056 lds
	s_waitcnt vmcnt(6)
	ds_read_b64_tr_b16 v[176:177], v11 offset:50688
	ds_read_b64_tr_b16 v[178:179], v11 offset:51744
	ds_read_b64_tr_b16 v[180:181], v12 offset:50688
	ds_read_b64_tr_b16 v[182:183], v12 offset:51744
	s_waitcnt lgkmcnt(4)
	s_add_u32 m0, s0, 48576
	s_mov_b32 s1, 360448
	buffer_load_dwordx4 v10, s[24:27], s1 offen lds
	buffer_load_dwordx4 v23, s[24:27], s1 offen offset:1056 lds
	s_waitcnt vmcnt(6)
	ds_read_b64_tr_b16 v[184:185], v11 offset:42240
	ds_read_b64_tr_b16 v[186:187], v11 offset:43296
	ds_read_b64_tr_b16 v[188:189], v12 offset:42240
	ds_read_b64_tr_b16 v[190:191], v12 offset:43296
	s_waitcnt lgkmcnt(4)
	s_add_u32 m0, s0, 50688
	s_mov_b32 s1, 376832
	buffer_load_dwordx4 v10, s[24:27], s1 offen lds
	buffer_load_dwordx4 v23, s[24:27], s1 offen offset:1056 lds
	s_waitcnt vmcnt(6)
	ds_read_b64_tr_b16 v[192:193], v11 offset:44352
	ds_read_b64_tr_b16 v[194:195], v11 offset:45408
	ds_read_b64_tr_b16 v[196:197], v12 offset:44352
	ds_read_b64_tr_b16 v[198:199], v12 offset:45408
	s_waitcnt lgkmcnt(4)
	s_add_u32 m0, s0, 42240
	s_mov_b32 s1, 393216
	buffer_load_dwordx4 v10, s[24:27], s1 offen lds
	buffer_load_dwordx4 v23, s[24:27], s1 offen offset:1056 lds
	s_waitcnt vmcnt(6)
	ds_read_b64_tr_b16 v[200:201], v11 offset:46464
	ds_read_b64_tr_b16 v[202:203], v11 offset:47520
	ds_read_b64_tr_b16 v[204:205], v12 offset:46464
	ds_read_b64_tr_b16 v[206:207], v12 offset:47520
	s_waitcnt lgkmcnt(4)
	s_add_u32 m0, s0, 44352
	s_mov_b32 s1, 409600
	buffer_load_dwordx4 v10, s[24:27], s1 offen lds
	buffer_load_dwordx4 v23, s[24:27], s1 offen offset:1056 lds
	s_waitcnt vmcnt(6)
	ds_read_b64_tr_b16 v[208:209], v11 offset:48576
	ds_read_b64_tr_b16 v[210:211], v11 offset:49632
	ds_read_b64_tr_b16 v[212:213], v12 offset:48576
	ds_read_b64_tr_b16 v[214:215], v12 offset:49632
	s_waitcnt lgkmcnt(4)
	s_add_u32 m0, s0, 46464
	s_mov_b32 s1, 425984
	buffer_load_dwordx4 v10, s[24:27], s1 offen lds
	buffer_load_dwordx4 v23, s[24:27], s1 offen offset:1056 lds
	s_waitcnt vmcnt(6)
	ds_read_b64_tr_b16 v[216:217], v11 offset:50688
	ds_read_b64_tr_b16 v[218:219], v11 offset:51744
	ds_read_b64_tr_b16 v[220:221], v12 offset:50688
	ds_read_b64_tr_b16 v[222:223], v12 offset:51744
	s_waitcnt lgkmcnt(4)
	s_add_u32 m0, s0, 48576
	s_mov_b32 s1, 442368
	buffer_load_dwordx4 v10, s[24:27], s1 offen lds
	buffer_load_dwordx4 v23, s[24:27], s1 offen offset:1056 lds
	s_waitcnt vmcnt(6)
	ds_read_b64_tr_b16 v[224:225], v11 offset:42240
	ds_read_b64_tr_b16 v[226:227], v11 offset:43296
	ds_read_b64_tr_b16 v[228:229], v12 offset:42240
	ds_read_b64_tr_b16 v[230:231], v12 offset:43296
	s_waitcnt vmcnt(4)
	ds_read_b64_tr_b16 v[232:233], v11 offset:44352
	ds_read_b64_tr_b16 v[234:235], v11 offset:45408
	ds_read_b64_tr_b16 v[236:237], v12 offset:44352
	ds_read_b64_tr_b16 v[238:239], v12 offset:45408
	s_waitcnt vmcnt(2)
	ds_read_b64_tr_b16 v[240:241], v11 offset:46464
	ds_read_b64_tr_b16 v[242:243], v11 offset:47520
	ds_read_b64_tr_b16 v[244:245], v12 offset:46464
	ds_read_b64_tr_b16 v[246:247], v12 offset:47520
	s_waitcnt vmcnt(0)
	ds_read_b64_tr_b16 v[248:249], v11 offset:48576
	ds_read_b64_tr_b16 v[250:251], v11 offset:49632
	ds_read_b64_tr_b16 v[252:253], v12 offset:48576
	ds_read_b64_tr_b16 v[254:255], v12 offset:49632
	v_bfrev_b32 v19, 1
	v_bfrev_b32 v20, 1
	s_lshl_b32 s54, s49, 3
	s_add_u32 s54, s54, s48
	s_cmp_eq_u32 s54, 248
	s_cbranch_scc0 noE_22
	s_lshl_b32 s56, s52, 9
	s_add_u32 s56, s56, 4096
	v_lshl_add_u32 v13, v0, 3, s56
	s_mov_b32 s58, 200000
poll_23:
	buffer_load_dwordx2 v[40:41], v13, s[44:47], 0 offen sc1
	s_waitcnt vmcnt(0)
	v_cmp_ne_u32 vcc, s53, v41
	s_cbranch_vccz pdone_24
	s_sub_u32 s58, s58, 1
	s_cbranch_scc0 poll_23
pdone_24:
	s_barrier
	v_mov_b32 v13, 0
	buffer_store_dword v8, v13, s[44:47], 0 offen sc1
noE_22:
	s_mul_i32 s57, s50, 229376
	s_mul_i32 s55, s52, 28672
	s_add_u32 s57, s57, s55
	s_add_u32 s57, s57, 8388608
	s_mov_b32 s58, 200000
poll_25:
	buffer_load_dword v4, v7, s[44:47], 0 offen sc1
	s_waitcnt vmcnt(0)
	v_cmp_ne_u32 vcc, s53, v4
	s_cbranch_vccz pdone_26
	s_sub_u32 s58, s58, 1
	s_cbranch_scc0 poll_25
pdone_26:
	s_waitcnt vmcnt(0) lgkmcnt(0)
	s_branch P4F
SLOW:
	buffer_store_dwordx4 v[160:163], v47, s[44:47], 0 offen sc1
	buffer_store_dwordx4 v[164:167], v47, s[44:47], s57 offen sc1
	v_mov_b32 v8, s53
	s_lshl_b32 s54, s50, 7
	s_lshl_b32 s55, s51, 4
	s_add_u32 s54, s54, s55
	s_lshl_b32 s55, s52, 2
	s_add_u32 s54, s54, s55
	s_add_u32 s54, s54, 24576
	v_mov_b32 v4, s54
	v_accvgpr_read_b32 v32, a216
	v_accvgpr_read_b32 v33, a217
	v_accvgpr_read_b32 v34, a218
	v_accvgpr_read_b32 v35, a219
	v_accvgpr_read_b32 v36, a220
	v_accvgpr_read_b32 v37, a221
	v_accvgpr_read_b32 v38, a222
	v_accvgpr_read_b32 v39, a223
	v_accvgpr_read_b32 v108, a224
	v_accvgpr_read_b32 v109, a225
	v_accvgpr_read_b32 v110, a226
	v_accvgpr_read_b32 v111, a227
	v_accvgpr_read_b32 v22, a228
	v_lshrrev_b32 v21, 4, v0
	v_mul_u32_u24 v48, 1056, v21
	v_mov_b32 v49, 0
	v_bfe_u32 v52, v0, 1, 1
	v_lshl_add_u32 v52, v49, 1, v52
	v_lshrrev_b32 v51, 1, v0
	v_and_b32 v51, 4, v51
	v_xor_b32 v52, v52, v51
	v_lshlrev_b32 v52, 4, v52
	v_and_b32 v51, 1, v0
	v_lshl_add_u32 v52, v51, 3, v52
	v_bfe_u32 v51, v0, 2, 2
	v_lshl_add_u32 v52, v51, 7, v52
	v_add_u32 v6, v52, v48
	v_sub_u32 v7, v6, v48
	v_xor_b32 v7, 64, v7
	v_add_u32 v7, v7, v48
	s_waitcnt vmcnt(22)
	v_cmp_ne_u32 vcc, s53, v75
	s_waitcnt vmcnt(21)
	v_cmp_ne_u32 s[54:55], s53, v79
	s_or_b64 vcc, vcc, s[54:55]
	s_waitcnt vmcnt(16)
	v_cmp_ne_u32 s[54:55], s53, v83
	s_or_b64 vcc, vcc, s[54:55]
	s_waitcnt vmcnt(15)
	v_cmp_ne_u32 s[54:55], s53, v87
	s_or_b64 vcc, vcc, s[54:55]
	s_cbranch_vccz ok_27
	s_mov_b32 s58, 200000
poll_28:
	buffer_load_dwordx4 v[72:75], v198, s[44:47], 0 offen sc1
	buffer_load_dwordx4 v[76:79], v198, s[44:47], 0 offen offset:1024 sc1
	buffer_load_dwordx4 v[80:83], v198, s[44:47], s65 offen sc1
	buffer_load_dwordx4 v[84:87], v198, s[44:47], s65 offen offset:1024 sc1
	s_waitcnt vmcnt(0)
	v_cmp_ne_u32 vcc, s53, v75
	v_cmp_ne_u32 s[54:55], s53, v79
	s_or_b64 vcc, vcc, s[54:55]
	v_cmp_ne_u32 s[54:55], s53, v83
	s_or_b64 vcc, vcc, s[54:55]
	v_cmp_ne_u32 s[54:55], s53, v87
	s_or_b64 vcc, vcc, s[54:55]
	s_cbranch_vccz pdone_29
	s_sub_u32 s58, s58, 1
	s_cbranch_scc0 poll_28
pdone_29:
ok_27:
	s_cmp_eq_u32 s52, 2
	s_cselect_b32 s57, 1.0, 0
	s_mov_b32 s54, 0x04000c0c
	s_mov_b32 s55, 0x0302040c
	v_perm_b32 v75, v74, v73, s54
	v_perm_b32 v83, v82, v81, s54
	v_perm_b32 v75, v72, v75, s55
	v_perm_b32 v83, v80, v83, s55
	v_add_f32 v52, v72, v80
	v_add_f32 v53, v73, v81
	v_add_f32 v54, v74, v82
	v_add_f32 v55, v75, v83
	v_perm_b32 v79, v78, v77, s54
	v_perm_b32 v87, v86, v85, s54
	v_perm_b32 v79, v76, v79, s55
	v_perm_b32 v87, v84, v87, s55
	v_add_f32 v56, v76, v84
	v_add_f32 v57, v77, v85
	v_add_f32 v58, v78, v86
	v_add_f32 v59, v79, v87
	v_add_f32 v52, s57, v52
	v_add_f32 v53, s57, v53
	v_add_f32 v54, s57, v54
	v_add_f32 v55, s57, v55
	v_add_f32 v56, s57, v56
	v_add_f32 v57, s57, v57
	v_add_f32 v58, s57, v58
	v_add_f32 v59, s57, v59
	v_cvt_pk_bf16_f32 v52, v52, v53
	v_cvt_pk_bf16_f32 v53, v54, v55
	v_cvt_pk_bf16_f32 v54, v56, v57
	v_cvt_pk_bf16_f32 v55, v58, v59
	v_lshrrev_b32 v48, 3, v0
	v_lshlrev_b32 v48, 6, v48
	v_and_b32 v49, 3, v0
	v_lshl_add_u32 v48, v49, 4, v48
	v_bfe_u32 v49, v0, 2, 1
	v_lshl_add_u32 v48, v49, 3, v48
	s_lshl_b32 s54, s52, 10
	s_add_u32 s54, s54, 157440
	v_add_u32 v48, s54, v48
	ds_write_b64 v48, v[52:53]
	ds_write_b64 v48, v[54:55] offset:512
	s_cmp_lt_u32 s52, 2
	s_cselect_b32 s55, 0x3f803f80, 0
	s_lshl_b32 s54, s52, 9
	s_add_u32 s54, s54, 161536
	v_lshl_add_u32 v49, v0, 3, s54
	v_mov_b32 v56, s55
	v_mov_b32 v57, s55
	ds_write_b64 v49, v[56:57]
	v_lshrrev_b32 v40, 2, v0
	v_and_b32 v40, 4, v40
	v_and_b32 v10, 7, v0
	v_xor_b32 v10, v10, v40
	v_lshlrev_b32 v10, 4, v10
	v_lshrrev_b32 v40, 3, v0
	v_mul_u32_u24 v40, 1024, v40
	v_add_u32 v10, v10, v40
	s_lshl_b32 s54, s51, 7
	s_mul_i32 s55, s52, 458752
	s_add_u32 s54, s54, s55
	v_add_u32 v10, s54, v10
	v_add_u32 v23, 7136, v10
	v_and_b32 v40, 1, v21
	v_xor_b32 v40, s52, v40
	v_lshrrev_b32 v41, 5, v0
	v_lshlrev_b32 v41, 9, v41
	v_bfe_u32 v42, v0, 1, 1
	v_lshl_add_u32 v42, v40, 1, v42
	v_lshrrev_b32 v43, 1, v0
	v_and_b32 v43, 4, v43
	v_xor_b32 v42, v42, v43
	v_lshlrev_b32 v42, 4, v42
	v_and_b32 v43, 1, v0
	v_lshl_add_u32 v42, v43, 3, v42
	v_bfe_u32 v43, v0, 2, 2
	v_lshl_add_u32 v42, v43, 7, v42
	v_add_u32 v11, v42, v41
	v_xor_b32 v12, 64, v11
	v_add_u32 v11, s0, v11
	v_add_u32 v12, s0, v12
	s_waitcnt vmcnt(0)
	buffer_store_dword v8, v4, s[44:47], 0 offen sc1
	s_waitcnt lgkmcnt(0)
	s_barrier
	s_lshl_b32 s54, s51, 7
	ds_read_b64_tr_b16 a[128:129], v6 offset:0
	s_add_u32 s54, s54, 157440
	ds_read_b64_tr_b16 a[0:1], v3 offset:0
	v_lshl_add_u32 v49, v21, 4, s54
	ds_read_b64_tr_b16 a[130:131], v6 offset:512
	ds_read_b64_tr_b16 a[2:3], v3 offset:1024
	ds_read_b128 v[44:47], v49 offset:0
	ds_read_b64_tr_b16 a[4:5], v3 offset:512
	ds_read_b128 v[52:55], v49 offset:64
	ds_read_b64_tr_b16 a[132:133], v6 offset:32
	ds_read_b128 v[60:63], v49 offset:2048
	ds_read_b64_tr_b16 a[6:7], v3 offset:1536
	ds_read_b128 v[68:71], v49 offset:2112
	ds_read_b64_tr_b16 a[134:135], v6 offset:544
	ds_read_b128 v[76:79], v49 offset:1024
	ds_read_b64_tr_b16 a[8:9], v3 offset:2112
	ds_read_b128 v[84:87], v49 offset:1088
	s_lshr_b32 s55, s52, 1
	ds_read_b64_tr_b16 a[136:137], v6 offset:4224
	ds_read_b64_tr_b16 a[10:11], v3 offset:3136
	s_lshl_b32 s55, s55, 6
	ds_read_b64_tr_b16 a[12:13], v3 offset:2624
	s_add_u32 s54, s54, s55
	ds_read_b64_tr_b16 a[138:139], v6 offset:4736
	ds_read_b64_tr_b16 a[14:15], v3 offset:3648
	s_and_b32 s55, s52, 1
	s_lshl_b32 s55, s55, 3
	s_waitcnt lgkmcnt(10)
	ds_read_b64_tr_b16 a[140:141], v6 offset:4256
	s_add_u32 s54, s54, s55
	s_add_u32 m0, s0, 0
	v_lshrrev_b32 v17, 5, v0
	s_mov_b32 s1, 1146880
	ds_read_b64_tr_b16 a[142:143], v6 offset:4768
	v_lshl_add_u32 v16, v17, 4, s54
	ds_read_b64 v[104:105], v16 offset:3072
	buffer_load_dwordx4 v1, s[16:19], s1 offen lds
	ds_read_b64 v[106:107], v16 offset:3104
	ds_read_b64_tr_b16 a[144:145], v6 offset:8448
	buffer_load_dwordx4 v2, s[16:19], s1 offen offset:1024 lds
	v_and_b32 v18, 15, v0
	v_lshrrev_b32 v16, 1, v21
	ds_read_b64_tr_b16 a[146:147], v6 offset:8960
	v_lshlrev_b32 v240, 10, v16
	ds_read_b64_tr_b16 a[16:17], v3 offset:4224
	v_and_b32 v16, 1, v21
	ds_read_b64_tr_b16 a[18:19], v3 offset:5248
	ds_read_b64_tr_b16 a[148:149], v6 offset:8480
	v_lshl_add_u32 v240, v16, 9, v240
	ds_read_b64_tr_b16 a[20:21], v3 offset:4736
	v_lshl_add_u32 v240, v18, 4, v240
	s_lshl_b32 s54, s50, 1
	ds_read_b64_tr_b16 a[150:151], v6 offset:8992
	ds_read_b64_tr_b16 a[22:23], v3 offset:5760
	s_lshr_b32 s55, s52, 1
	s_waitcnt lgkmcnt(12)
	s_add_u32 s54, s54, s55
	ds_read_b64_tr_b16 a[152:153], v6 offset:12672
	s_add_u32 m0, s0, 2112
	s_lshl_b32 s54, s54, 15
	s_lshl_b32 s55, s51, 12
	s_mov_b32 s1, 1261568
	ds_read_b64_tr_b16 a[154:155], v6 offset:13184
	s_add_u32 s54, s54, s55
	buffer_load_dwordx4 v1, s[16:19], s1 offen lds
	s_and_b32 s55, s52, 1
	buffer_load_dwordx4 v2, s[16:19], s1 offen offset:1024 lds
	ds_read_b64_tr_b16 a[156:157], v6 offset:12704
	s_lshl_b32 s55, s55, 8
	s_add_u32 s54, s54, s55
	s_add_u32 s54, s54, 3145728
	ds_read_b64_tr_b16 a[158:159], v6 offset:13216
	ds_read_b64_tr_b16 a[24:25], v3 offset:6336
	v_add_u32 v240, s54, v240
	ds_read_b64_tr_b16 a[26:27], v3 offset:7360
	s_lshl_b32 s54, s50, 3
	ds_read_b64_tr_b16 a[160:161], v6 offset:16896
	s_add_u32 s54, s54, s51
	ds_read_b64_tr_b16 a[28:29], v3 offset:6848
	s_lshl_b32 s54, s54, 11
	ds_read_b64_tr_b16 a[30:31], v3 offset:7872
	ds_read_b64_tr_b16 a[162:163], v6 offset:17408
	s_lshl_b32 s55, s52, 8
	s_waitcnt lgkmcnt(10)
	s_add_u32 s54, s54, s55
	s_add_u32 s54, s54, 524288
	ds_read_b64_tr_b16 a[164:165], v6 offset:16928
	s_add_u32 m0, s0, 4224
	v_lshl_add_u32 v241, v18, 4, s54
	s_mov_b32 s1, 1376256
	v_lshl_add_u32 v241, v17, 10, v241
	ds_read_b64_tr_b16 a[166:167], v6 offset:17440
	buffer_load_dwordx4 v1, s[16:19], s1 offen lds
	v_and_b32 v16, 31, v0
	s_lshl_b32 s54, s50, 7
	buffer_load_dwordx4 v2, s[16:19], s1 offen offset:1024 lds
	ds_read_b64_tr_b16 a[168:169], v6 offset:21120
	s_add_u32 s54, s54, 24576
	v_lshl_add_u32 v13, v16, 2, s54
	ds_read_b64_tr_b16 a[32:33], v3 offset:8448
	ds_read_b64_tr_b16 a[170:171], v6 offset:21632
	v_lshlrev_b32 v24, 16, v32
	v_and_b32 v25, s67, v32
	ds_read_b64_tr_b16 a[34:35], v3 offset:9472
	v_lshlrev_b32 v26, 16, v33
	ds_read_b64_tr_b16 a[172:173], v6 offset:21152
	ds_read_b64_tr_b16 a[36:37], v3 offset:8960
	v_and_b32 v27, s67, v33
	ds_read_b64_tr_b16 a[38:39], v3 offset:9984
	v_lshlrev_b32 v28, 16, v34
	ds_read_b64_tr_b16 a[174:175], v6 offset:21664
	v_and_b32 v29, s67, v34
	v_lshlrev_b32 v30, 16, v35
	ds_read_b64_tr_b16 a[40:41], v3 offset:42240
	ds_read_b64_tr_b16 a[176:177], v6 offset:25344
	v_and_b32 v31, s67, v35
	ds_read_b64_tr_b16 a[42:43], v3 offset:43264
	v_lshlrev_b32 v32, 16, v36
	v_and_b32 v33, s67, v36
	ds_read_b64_tr_b16 a[178:179], v6 offset:25856
	ds_read_b64_tr_b16 a[44:45], v3 offset:42752
	v_lshlrev_b32 v34, 16, v37
	ds_read_b64_tr_b16 a[46:47], v3 offset:43776
	v_and_b32 v35, s67, v37
	ds_read_b64_tr_b16 a[180:181], v6 offset:25376
	v_lshlrev_b32 v36, 16, v38
	v_and_b32 v37, s67, v38
	ds_read_b64_tr_b16 a[48:49], v3 offset:44352
	ds_read_b64_tr_b16 a[182:183], v6 offset:25888
	v_lshlrev_b32 v38, 16, v39
	ds_read_b64_tr_b16 a[50:51], v3 offset:45376
	v_and_b32 v39, s67, v39
	ds_read_b64_tr_b16 a[52:53], v3 offset:44864
	ds_read_b64_tr_b16 a[184:185], v6 offset:29568
	v_lshlrev_b32 v40, 16, v44
	v_and_b32 v41, s67, v44
	ds_read_b64_tr_b16 a[54:55], v3 offset:45888
	v_lshlrev_b32 v42, 16, v45
	ds_read_b64_tr_b16 a[186:187], v6 offset:30080
	v_and_b32 v43, s67, v45
	ds_read_b64_tr_b16 a[56:57], v3 offset:46464
	v_lshlrev_b32 v44, 16, v46
	ds_read_b64_tr_b16 a[188:189], v6 offset:29600
	v_and_b32 v45, s67, v46
	ds_read_b64_tr_b16 a[58:59], v3 offset:47488
	v_lshlrev_b32 v46, 16, v47
	ds_read_b64_tr_b16 a[60:61], v3 offset:46976
	ds_read_b64_tr_b16 a[190:191], v6 offset:30112
	v_and_b32 v47, s67, v47
	ds_read_b64_tr_b16 a[62:63], v3 offset:48000
	v_lshlrev_b32 v48, 16, v52
	buffer_load_dword v4, v13, s[44:47], 0 offen sc1
	v_and_b32 v49, s67, v52
	ds_read_b64_tr_b16 a[192:193], v6 offset:33792
	v_lshlrev_b32 v50, 16, v53
	ds_read_b64_tr_b16 a[194:195], v6 offset:34304
	v_and_b32 v51, s67, v53
	v_lshlrev_b32 v52, 16, v54
	ds_read_b64_tr_b16 a[196:197], v6 offset:33824
	v_and_b32 v53, s67, v54
	ds_read_b64_tr_b16 a[198:199], v6 offset:34336
	v_lshlrev_b32 v54, 16, v55
	v_and_b32 v55, s67, v55
	ds_read_b64_tr_b16 a[200:201], v6 offset:38016
	v_lshlrev_b32 v56, 16, v60
	ds_read_b64_tr_b16 a[202:203], v6 offset:38528
	v_and_b32 v57, s67, v60
	v_lshlrev_b32 v58, 16, v61
	ds_read_b64_tr_b16 a[204:205], v6 offset:38048
	v_and_b32 v59, s67, v61
	ds_read_b64_tr_b16 a[206:207], v6 offset:38560
	v_lshlrev_b32 v60, 16, v62
	v_and_b32 v61, s67, v62
	ds_read_b64_tr_b16 a[208:209], v6 offset:42240
	v_lshlrev_b32 v62, 16, v63
	v_and_b32 v63, s67, v63
	ds_read_b64_tr_b16 a[210:211], v6 offset:42752
	v_lshlrev_b32 v64, 16, v68
	ds_read_b64_tr_b16 a[212:213], v6 offset:42272
	v_and_b32 v65, s67, v68
	v_lshlrev_b32 v66, 16, v69
	ds_read_b64_tr_b16 a[214:215], v6 offset:42784
	v_and_b32 v67, s67, v69
	ds_read_b64_tr_b16 a[216:217], v6 offset:46464
	v_lshlrev_b32 v68, 16, v70
	v_and_b32 v69, s67, v70
	ds_read_b64_tr_b16 a[218:219], v6 offset:46976
	v_lshlrev_b32 v70, 16, v71
	ds_read_b64_tr_b16 a[220:221], v6 offset:46496
	v_and_b32 v71, s67, v71
	v_lshlrev_b32 v72, 16, v76
	ds_read_b64_tr_b16 a[222:223], v6 offset:47008
	v_and_b32 v73, s67, v76
	v_lshlrev_b32 v74, 16, v77
	ds_read_b64_tr_b16 a[224:225], v6 offset:50688
	v_and_b32 v75, s67, v77
	ds_read_b64_tr_b16 a[226:227], v6 offset:51200
	v_lshlrev_b32 v76, 16, v78
	v_and_b32 v77, s67, v78
	ds_read_b64_tr_b16 a[228:229], v6 offset:50720
	v_lshlrev_b32 v78, 16, v79
	ds_read_b64_tr_b16 a[230:231], v6 offset:51232
	v_and_b32 v79, s67, v79
	v_lshlrev_b32 v80, 16, v84
	ds_read_b64_tr_b16 a[232:233], v6 offset:54912
	v_and_b32 v81, s67, v84
	ds_read_b64_tr_b16 a[234:235], v6 offset:55424
	v_lshlrev_b32 v82, 16, v85
	v_and_b32 v83, s67, v85
	ds_read_b64_tr_b16 a[236:237], v6 offset:54944
	v_lshlrev_b32 v84, 16, v86
	ds_read_b64_tr_b16 a[238:239], v6 offset:55456
	v_and_b32 v85, s67, v86
	v_lshlrev_b32 v86, 16, v87
	ds_read_b64_tr_b16 a[240:241], v6 offset:59136
	v_and_b32 v87, s67, v87
	s_lshl_b32 s54, s50, 7
	ds_read_b64_tr_b16 a[242:243], v6 offset:59648
	s_lshl_b32 s55, s51, 3
	ds_read_b64_tr_b16 a[244:245], v6 offset:59168
	s_add_u32 s54, s54, s55
	s_add_u32 s54, s54, 28672
	ds_read_b64_tr_b16 a[246:247], v6 offset:59680
	v_mov_b32 v242, s54
	ds_read_b64_tr_b16 a[248:249], v6 offset:63360
	s_lshr_b32 s54, s52, 1
	s_lshl_b32 s54, s54, 6
	ds_read_b64_tr_b16 a[250:251], v6 offset:63872
	s_and_b32 s55, s52, 1
	ds_read_b64_tr_b16 a[252:253], v6 offset:63392
	s_lshl_b32 s55, s55, 2
	s_add_u32 s54, s54, s55
	ds_read_b64_tr_b16 a[254:255], v6 offset:63904
	v_add_u32 v242, s54, v242
	ds_read_b64_tr_b16 v[128:129], v7 offset:0
	ds_read_b64_tr_b16 v[130:131], v7 offset:512
	ds_read_b64_tr_b16 v[132:133], v7 offset:32
	ds_read_b64_tr_b16 v[134:135], v7 offset:544
	ds_read_b64_tr_b16 v[136:137], v7 offset:4224
	ds_read_b64_tr_b16 v[138:139], v7 offset:4736
	ds_read_b64_tr_b16 v[140:141], v7 offset:4256
	ds_read_b64_tr_b16 v[142:143], v7 offset:4768
	ds_read_b64_tr_b16 v[144:145], v7 offset:8448
	ds_read_b64_tr_b16 v[146:147], v7 offset:8960
	ds_read_b64_tr_b16 v[148:149], v7 offset:8480
	ds_read_b64_tr_b16 v[150:151], v7 offset:8992
	ds_read_b64_tr_b16 v[152:153], v7 offset:12672
	ds_read_b64_tr_b16 v[154:155], v7 offset:13184
	s_lshl_b32 s56, s50, 2
	s_add_u32 s56, s56, s52
	s_lshl_b32 s56, s56, 14
	s_add_u32 s56, s56, 1048576
	s_waitcnt vmcnt(0)
	v_cmp_ne_u32 vcc, s53, v4
	s_cbranch_vccz ok_30
	s_mov_b32 s58, 200000
poll_31:
	buffer_load_dword v4, v13, s[44:47], 0 offen sc1
	s_waitcnt vmcnt(0)
	v_cmp_ne_u32 vcc, s53, v4
	s_cbranch_vccz pdone_32
	s_sub_u32 s58, s58, 1
	s_cbranch_scc0 poll_31
pdone_32:
ok_30:
	buffer_load_dwordx4 v[160:163], v5, s[44:47], s56 offen offset:0 sc1
	ds_read_b64_tr_b16 a[64:65], v3 offset:48576
	buffer_load_dwordx4 v[164:167], v5, s[44:47], s56 offen offset:1024 sc1
	ds_read_b64_tr_b16 a[66:67], v3 offset:49600
	buffer_load_dwordx4 v[168:171], v5, s[44:47], s56 offen offset:2048 sc1
	ds_read_b64_tr_b16 a[68:69], v3 offset:49088
	buffer_load_dwordx4 v[172:175], v5, s[44:47], s56 offen offset:3072 sc1
	ds_read_b64_tr_b16 a[70:71], v3 offset:50112
	s_add_u32 s56, s56, 4096
	buffer_load_dwordx4 v[176:179], v5, s[44:47], s56 offen offset:0 sc1
	buffer_load_dwordx4 v[180:183], v5, s[44:47], s56 offen offset:1024 sc1
	ds_read_b64_tr_b16 a[72:73], v3 offset:50688
	buffer_load_dwordx4 v[184:187], v5, s[44:47], s56 offen offset:2048 sc1
	ds_read_b64_tr_b16 a[74:75], v3 offset:51712
	buffer_load_dwordx4 v[188:191], v5, s[44:47], s56 offen offset:3072 sc1
	ds_read_b64_tr_b16 a[76:77], v3 offset:51200
	s_add_u32 s56, s56, 4096
	buffer_load_dwordx4 v[192:195], v5, s[44:47], s56 offen offset:0 sc1
	ds_read_b64_tr_b16 a[78:79], v3 offset:52224
	s_waitcnt vmcnt(8)
	v_mfma_f32_16x16x32_bf16 v[88:91], a[128:131], v[160:163], 0
	buffer_load_dwordx4 v[196:199], v5, s[44:47], s56 offen offset:1024 sc1
	v_mfma_f32_16x16x32_bf16 v[92:95], a[132:135], v[160:163], 0
	s_waitcnt lgkmcnt(15)
	v_mfma_f32_16x16x32_bf16 v[96:99], v[128:131], v[160:163], 0
	ds_read_b64_tr_b16 v[156:157], v7 offset:12704
	ds_read_b64_tr_b16 v[158:159], v7 offset:13216
	v_mfma_f32_16x16x32_bf16 v[100:103], v[132:135], v[160:163], 0
	ds_read_b64_tr_b16 v[128:129], v7 offset:16896
	ds_read_b64_tr_b16 v[130:131], v7 offset:17408
	s_waitcnt vmcnt(8)
	v_mfma_f32_16x16x32_bf16 v[88:91], a[136:139], v[164:167], v[88:91]
	buffer_load_dwordx4 v[200:203], v5, s[44:47], s56 offen offset:2048 sc1
	v_mfma_f32_16x16x32_bf16 v[92:95], a[140:143], v[164:167], v[92:95]
	s_waitcnt lgkmcnt(15)
	v_mfma_f32_16x16x32_bf16 v[96:99], v[136:139], v[164:167], v[96:99]
	ds_read_b64_tr_b16 v[132:133], v7 offset:16928
	ds_read_b64_tr_b16 v[134:135], v7 offset:17440
	v_mfma_f32_16x16x32_bf16 v[100:103], v[140:143], v[164:167], v[100:103]
	ds_read_b64_tr_b16 v[136:137], v7 offset:21120
	ds_read_b64_tr_b16 v[138:139], v7 offset:21632
	s_waitcnt vmcnt(8)
	v_mfma_f32_16x16x32_bf16 v[88:91], a[144:147], v[168:171], v[88:91]
	buffer_load_dwordx4 v[204:207], v5, s[44:47], s56 offen offset:3072 sc1
	v_mfma_f32_16x16x32_bf16 v[92:95], a[148:151], v[168:171], v[92:95]
	s_waitcnt lgkmcnt(15)
	v_mfma_f32_16x16x32_bf16 v[96:99], v[144:147], v[168:171], v[96:99]
	ds_read_b64_tr_b16 v[140:141], v7 offset:21152
	ds_read_b64_tr_b16 v[142:143], v7 offset:21664
	v_mfma_f32_16x16x32_bf16 v[100:103], v[148:151], v[168:171], v[100:103]
	ds_read_b64_tr_b16 v[144:145], v7 offset:25344
	ds_read_b64_tr_b16 v[146:147], v7 offset:25856
	s_waitcnt vmcnt(8)
	v_mfma_f32_16x16x32_bf16 v[88:91], a[152:155], v[172:175], v[88:91]
	s_add_u32 s56, s56, 4096
	buffer_load_dwordx4 v[208:211], v5, s[44:47], s56 offen offset:0 sc1
	v_mfma_f32_16x16x32_bf16 v[92:95], a[156:159], v[172:175], v[92:95]
	s_waitcnt lgkmcnt(10)
	v_mfma_f32_16x16x32_bf16 v[96:99], v[152:155], v[172:175], v[96:99]
	ds_read_b64_tr_b16 v[148:149], v7 offset:25376
	ds_read_b64_tr_b16 v[150:151], v7 offset:25888
	v_mfma_f32_16x16x32_bf16 v[100:103], v[156:159], v[172:175], v[100:103]
	ds_read_b64_tr_b16 v[152:153], v7 offset:29568
	ds_read_b64_tr_b16 v[154:155], v7 offset:30080
	s_waitcnt vmcnt(8)
	v_mfma_f32_16x16x32_bf16 v[88:91], a[160:163], v[176:179], v[88:91]
	buffer_load_dwordx4 v[212:215], v5, s[44:47], s56 offen offset:1024 sc1
	v_mfma_f32_16x16x32_bf16 v[92:95], a[164:167], v[176:179], v[92:95]
	s_waitcnt lgkmcnt(10)
	v_mfma_f32_16x16x32_bf16 v[96:99], v[128:131], v[176:179], v[96:99]
	ds_read_b64_tr_b16 v[156:157], v7 offset:29600
	ds_read_b64_tr_b16 v[158:159], v7 offset:30112
	v_mfma_f32_16x16x32_bf16 v[100:103], v[132:135], v[176:179], v[100:103]
	ds_read_b64_tr_b16 v[128:129], v7 offset:33792
	ds_read_b64_tr_b16 v[130:131], v7 offset:34304
	s_waitcnt vmcnt(8)
	v_mfma_f32_16x16x32_bf16 v[88:91], a[168:171], v[180:183], v[88:91]
	buffer_load_dwordx4 v[216:219], v5, s[44:47], s56 offen offset:2048 sc1
	v_mfma_f32_16x16x32_bf16 v[92:95], a[172:175], v[180:183], v[92:95]
	s_waitcnt lgkmcnt(10)
	v_mfma_f32_16x16x32_bf16 v[96:99], v[136:139], v[180:183], v[96:99]
	ds_read_b64_tr_b16 v[132:133], v7 offset:33824
	ds_read_b64_tr_b16 v[134:135], v7 offset:34336
	v_mfma_f32_16x16x32_bf16 v[100:103], v[140:143], v[180:183], v[100:103]
	ds_read_b64_tr_b16 v[136:137], v7 offset:38016
	ds_read_b64_tr_b16 v[138:139], v7 offset:38528
	s_waitcnt vmcnt(8)
	v_mfma_f32_16x16x32_bf16 v[88:91], a[176:179], v[184:187], v[88:91]
	buffer_load_dwordx4 v[220:223], v5, s[44:47], s56 offen offset:3072 sc1
	v_mfma_f32_16x16x32_bf16 v[92:95], a[180:183], v[184:187], v[92:95]
	s_waitcnt lgkmcnt(10)
	v_mfma_f32_16x16x32_bf16 v[96:99], v[144:147], v[184:187], v[96:99]
	ds_read_b64_tr_b16 v[140:141], v7 offset:38048
	ds_read_b64_tr_b16 v[142:143], v7 offset:38560
	v_mfma_f32_16x16x32_bf16 v[100:103], v[148:151], v[184:187], v[100:103]
	ds_read_b64_tr_b16 v[144:145], v7 offset:42240
	ds_read_b64_tr_b16 v[146:147], v7 offset:42752
	s_waitcnt vmcnt(8)
	v_mfma_f32_16x16x32_bf16 v[88:91], a[184:187], v[188:191], v[88:91]
	v_mfma_f32_16x16x32_bf16 v[92:95], a[188:191], v[188:191], v[92:95]
	s_waitcnt lgkmcnt(10)
	v_mfma_f32_16x16x32_bf16 v[96:99], v[152:155], v[188:191], v[96:99]
	ds_read_b64_tr_b16 v[148:149], v7 offset:42272
	ds_read_b64_tr_b16 v[150:151], v7 offset:42784
	v_mfma_f32_16x16x32_bf16 v[100:103], v[156:159], v[188:191], v[100:103]
	ds_read_b64_tr_b16 v[152:153], v7 offset:46464
	ds_read_b64_tr_b16 v[154:155], v7 offset:46976
	s_waitcnt vmcnt(7)
	v_mfma_f32_16x16x32_bf16 v[88:91], a[192:195], v[192:195], v[88:91]
	v_mfma_f32_16x16x32_bf16 v[92:95], a[196:199], v[192:195], v[92:95]
	s_add_u32 m0, s0, 6336
	s_waitcnt lgkmcnt(10)
	v_mfma_f32_16x16x32_bf16 v[96:99], v[128:131], v[192:195], v[96:99]
	ds_read_b64_tr_b16 v[156:157], v7 offset:46496
	ds_read_b64_tr_b16 v[158:159], v7 offset:47008
	s_mov_b32 s1, 1490944
	v_mfma_f32_16x16x32_bf16 v[100:103], v[132:135], v[192:195], v[100:103]
	ds_read_b64_tr_b16 v[128:129], v7 offset:50688
	ds_read_b64_tr_b16 v[130:131], v7 offset:51200
	buffer_load_dwordx4 v1, s[16:19], s1 offen lds
	s_waitcnt vmcnt(7)
	v_mfma_f32_16x16x32_bf16 v[88:91], a[200:203], v[196:199], v[88:91]
	buffer_load_dwordx4 v2, s[16:19], s1 offen offset:1024 lds
	v_mfma_f32_16x16x32_bf16 v[92:95], a[204:207], v[196:199], v[92:95]
	s_waitcnt lgkmcnt(10)
	v_mfma_f32_16x16x32_bf16 v[96:99], v[136:139], v[196:199], v[96:99]
	ds_read_b64_tr_b16 v[132:133], v7 offset:50720
	ds_read_b64_tr_b16 v[134:135], v7 offset:51232
	s_add_u32 m0, s0, 8448
	v_mfma_f32_16x16x32_bf16 v[100:103], v[140:143], v[196:199], v[100:103]
	ds_read_b64_tr_b16 v[136:137], v7 offset:54912
	ds_read_b64_tr_b16 v[138:139], v7 offset:55424
	s_mov_b32 s1, 1605632
	s_waitcnt vmcnt(7)
	v_mfma_f32_16x16x32_bf16 v[88:91], a[208:211], v[200:203], v[88:91]
	buffer_load_dwordx4 v1, s[16:19], s1 offen lds
	v_mfma_f32_16x16x32_bf16 v[92:95], a[212:215], v[200:203], v[92:95]
	buffer_load_dwordx4 v2, s[16:19], s1 offen offset:1024 lds
	s_waitcnt lgkmcnt(10)
	v_mfma_f32_16x16x32_bf16 v[96:99], v[144:147], v[200:203], v[96:99]
	ds_read_b64_tr_b16 v[140:141], v7 offset:54944
	ds_read_b64_tr_b16 v[142:143], v7 offset:55456
	v_mfma_f32_16x16x32_bf16 v[100:103], v[148:151], v[200:203], v[100:103]
	ds_read_b64_tr_b16 v[144:145], v7 offset:59136
	ds_read_b64_tr_b16 v[146:147], v7 offset:59648
	s_add_u32 m0, s0, 42240
	s_waitcnt vmcnt(8)
	v_mfma_f32_16x16x32_bf16 v[88:91], a[216:219], v[204:207], v[88:91]
	s_mov_b32 s1, 1720320
	v_mfma_f32_16x16x32_bf16 v[92:95], a[220:223], v[204:207], v[92:95]
	buffer_load_dwordx4 v1, s[16:19], s1 offen lds
	s_waitcnt lgkmcnt(10)
	v_mfma_f32_16x16x32_bf16 v[96:99], v[152:155], v[204:207], v[96:99]
	ds_read_b64_tr_b16 v[148:149], v7 offset:59168
	ds_read_b64_tr_b16 v[150:151], v7 offset:59680
	buffer_load_dwordx4 v2, s[16:19], s1 offen offset:1024 lds
	v_mfma_f32_16x16x32_bf16 v[100:103], v[156:159], v[204:207], v[100:103]
	ds_read_b64_tr_b16 v[152:153], v7 offset:63360
	ds_read_b64_tr_b16 v[154:155], v7 offset:63872
	s_waitcnt vmcnt(9)
	v_mfma_f32_16x16x32_bf16 v[88:91], a[224:227], v[208:211], v[88:91]
	v_mfma_f32_16x16x32_bf16 v[92:95], a[228:231], v[208:211], v[92:95]
	s_add_u32 m0, s0, 44352
	s_waitcnt lgkmcnt(10)
	v_mfma_f32_16x16x32_bf16 v[96:99], v[128:131], v[208:211], v[96:99]
	ds_read_b64_tr_b16 v[156:157], v7 offset:63392
	ds_read_b64_tr_b16 v[158:159], v7 offset:63904
	s_mov_b32 s1, 0
	v_mfma_f32_16x16x32_bf16 v[100:103], v[132:135], v[208:211], v[100:103]
	buffer_load_dwordx4 v10, s[24:27], s1 offen lds
	s_waitcnt vmcnt(9)
	v_mfma_f32_16x16x32_bf16 v[88:91], a[232:235], v[212:215], v[88:91]
	buffer_load_dwordx4 v23, s[24:27], s1 offen offset:1056 lds
	v_mfma_f32_16x16x32_bf16 v[92:95], a[236:239], v[212:215], v[92:95]
	s_waitcnt lgkmcnt(8)
	v_mfma_f32_16x16x32_bf16 v[96:99], v[136:139], v[212:215], v[96:99]
	ds_read_b64_tr_b16 a[80:81], v3 offset:0
	v_mfma_f32_16x16x32_bf16 v[100:103], v[140:143], v[212:215], v[100:103]
	ds_read_b64_tr_b16 a[82:83], v3 offset:1024
	s_waitcnt vmcnt(9)
	v_mfma_f32_16x16x32_bf16 v[88:91], a[240:243], v[216:219], v[88:91]
	ds_read_b64_tr_b16 a[84:85], v3 offset:512
	v_mfma_f32_16x16x32_bf16 v[92:95], a[244:247], v[216:219], v[92:95]
	ds_read_b64_tr_b16 a[86:87], v3 offset:1536
	s_waitcnt lgkmcnt(8)
	v_mfma_f32_16x16x32_bf16 v[96:99], v[144:147], v[216:219], v[96:99]
	v_mfma_f32_16x16x32_bf16 v[100:103], v[148:151], v[216:219], v[100:103]
	ds_read_b64_tr_b16 a[88:89], v3 offset:2112
	s_waitcnt vmcnt(8)
	v_mfma_f32_16x16x32_bf16 v[88:91], a[248:251], v[220:223], v[88:91]
	ds_read_b64_tr_b16 a[90:91], v3 offset:3136
	v_mfma_f32_16x16x32_bf16 v[92:95], a[252:255], v[220:223], v[92:95]
	ds_read_b64_tr_b16 a[92:93], v3 offset:2624
	s_waitcnt lgkmcnt(7)
	v_mfma_f32_16x16x32_bf16 v[96:99], v[152:155], v[220:223], v[96:99]
	ds_read_b64_tr_b16 a[94:95], v3 offset:3648
	v_mfma_f32_16x16x32_bf16 v[100:103], v[156:159], v[220:223], v[100:103]
	v_pk_fma_f32 v[24:25], v[88:89], v[40:41], v[24:25]
	v_pk_fma_f32 v[26:27], v[90:91], v[42:43], v[26:27]
	v_pk_fma_f32 v[28:29], v[92:93], v[44:45], v[28:29]
	v_pk_fma_f32 v[30:31], v[94:95], v[46:47], v[30:31]
	s_nop 0
	v_pk_fma_f32 v[32:33], v[96:97], v[48:49], v[32:33]
	v_pk_fma_f32 v[34:35], v[98:99], v[50:51], v[34:35]
	s_nop 0
	v_pk_fma_f32 v[36:37], v[100:101], v[52:53], v[36:37]
	v_pk_fma_f32 v[38:39], v[102:103], v[54:55], v[38:39]
	v_pk_mul_f32 v[224:225], v[24:25], v[56:57]
	v_pk_mul_f32 v[226:227], v[26:27], v[58:59]
	v_pk_mul_f32 v[228:229], v[28:29], v[60:61]
	v_pk_mul_f32 v[230:231], v[30:31], v[62:63]
	v_pk_mul_f32 v[232:233], v[32:33], v[64:65]
	v_pk_mul_f32 v[234:235], v[34:35], v[66:67]
	v_pk_mul_f32 v[236:237], v[36:37], v[68:69]
	v_pk_mul_f32 v[238:239], v[38:39], v[70:71]
	v_cvt_pk_bf16_f32 v88, v224, v225
	v_cvt_pk_bf16_f32 v89, v226, v227
	v_cvt_pk_bf16_f32 v90, v228, v229
	v_cvt_pk_bf16_f32 v91, v230, v231
	v_cvt_pk_bf16_f32 v92, v232, v233
	v_cvt_pk_bf16_f32 v93, v234, v235
	v_cvt_pk_bf16_f32 v94, v236, v237
	v_cvt_pk_bf16_f32 v95, v238, v239
	buffer_store_dwordx4 v[88:91], v240, s[44:47], 0 offen sc1
	buffer_store_dwordx4 v[92:95], v240, s[44:47], 0 offen offset:2048 sc1
	v_pk_mul_f32 v[130:131], v[24:25], v[24:25]
	v_pk_mul_f32 v[134:135], v[224:225], v[224:225]
	v_pk_mul_f32 v[136:137], v[224:225], v[56:57]
	v_pk_mul_f32 v[138:139], v[224:225], v[72:73]
	v_pk_add_f32 v[128:129], v[26:27], v[24:25]
	v_pk_fma_f32 v[130:131], v[26:27], v[26:27], v[130:131]
	v_pk_add_f32 v[132:133], v[226:227], v[224:225]
	v_pk_fma_f32 v[134:135], v[226:227], v[226:227], v[134:135]
	v_pk_fma_f32 v[136:137], v[226:227], v[58:59], v[136:137]
	v_pk_fma_f32 v[138:139], v[226:227], v[74:75], v[138:139]
	v_pk_add_f32 v[128:129], v[28:29], v[128:129]
	v_pk_fma_f32 v[130:131], v[28:29], v[28:29], v[130:131]
	v_pk_add_f32 v[132:133], v[228:229], v[132:133]
	v_pk_fma_f32 v[134:135], v[228:229], v[228:229], v[134:135]
	v_pk_fma_f32 v[136:137], v[228:229], v[60:61], v[136:137]
	v_pk_fma_f32 v[138:139], v[228:229], v[76:77], v[138:139]
	v_pk_add_f32 v[128:129], v[30:31], v[128:129]
	v_pk_fma_f32 v[130:131], v[30:31], v[30:31], v[130:131]
	v_pk_add_f32 v[132:133], v[230:231], v[132:133]
	v_pk_fma_f32 v[134:135], v[230:231], v[230:231], v[134:135]
	v_pk_fma_f32 v[136:137], v[230:231], v[62:63], v[136:137]
	v_pk_fma_f32 v[138:139], v[230:231], v[78:79], v[138:139]
	v_pk_add_f32 v[128:129], v[32:33], v[128:129]
	v_pk_fma_f32 v[130:131], v[32:33], v[32:33], v[130:131]
	v_pk_add_f32 v[132:133], v[232:233], v[132:133]
	v_pk_fma_f32 v[134:135], v[232:233], v[232:233], v[134:135]
	v_pk_fma_f32 v[136:137], v[232:233], v[64:65], v[136:137]
	v_pk_fma_f32 v[138:139], v[232:233], v[80:81], v[138:139]
	v_pk_add_f32 v[128:129], v[34:35], v[128:129]
	v_pk_fma_f32 v[130:131], v[34:35], v[34:35], v[130:131]
	v_pk_add_f32 v[132:133], v[234:235], v[132:133]
	v_pk_fma_f32 v[134:135], v[234:235], v[234:235], v[134:135]
	v_pk_fma_f32 v[136:137], v[234:235], v[66:67], v[136:137]
	v_pk_fma_f32 v[138:139], v[234:235], v[82:83], v[138:139]
	v_pk_add_f32 v[128:129], v[36:37], v[128:129]
	v_pk_fma_f32 v[130:131], v[36:37], v[36:37], v[130:131]
	v_pk_add_f32 v[132:133], v[236:237], v[132:133]
	v_pk_fma_f32 v[134:135], v[236:237], v[236:237], v[134:135]
	v_pk_fma_f32 v[136:137], v[236:237], v[68:69], v[136:137]
	v_pk_fma_f32 v[138:139], v[236:237], v[84:85], v[138:139]
	v_pk_add_f32 v[128:129], v[38:39], v[128:129]
	v_pk_fma_f32 v[130:131], v[38:39], v[38:39], v[130:131]
	v_pk_add_f32 v[132:133], v[238:239], v[132:133]
	v_pk_fma_f32 v[134:135], v[238:239], v[238:239], v[134:135]
	v_pk_fma_f32 v[136:137], v[238:239], v[70:71], v[136:137]
	v_pk_fma_f32 v[138:139], v[238:239], v[86:87], v[138:139]
	v_add_f32 v96, v128, v129
	v_add_f32 v97, v130, v131
	v_add_f32 v98, v132, v133
	v_add_f32 v99, v134, v135
	v_add_f32 v100, v136, v137
	v_add_f32 v101, v138, v139
	v_permlane32_swap_b32 v96, v97
	v_permlane32_swap_b32 v98, v99
	v_permlane32_swap_b32 v100, v101
	v_add_f32 v16, v96, v97
	v_add_f32 v17, v98, v99
	v_add_f32 v18, v100, v101
	v_mov_b32 v100, v16
	v_mov_b32 v101, v17
	v_mov_b32 v102, v18
	v_permlane16_swap_b32 v16, v100
	v_permlane16_swap_b32 v17, v101
	v_permlane16_swap_b32 v18, v102
	v_add_f32 v16, v16, v100
	v_add_f32 v17, v17, v101
	v_add_f32 v18, v18, v102
	buffer_store_dwordx4 v[16:19], v241, s[44:47], 0 offen sc1
	s_add_u32 m0, s0, 46464
	s_mov_b32 s1, 16384
	buffer_load_dwordx4 v10, s[24:27], s1 offen lds
	buffer_load_dwordx4 v23, s[24:27], s1 offen offset:1056 lds
	s_add_u32 m0, s0, 48576
	s_mov_b32 s1, 32768
	buffer_load_dwordx4 v10, s[24:27], s1 offen lds
	buffer_load_dwordx4 v23, s[24:27], s1 offen offset:1056 lds
	s_add_u32 m0, s0, 50688
	s_mov_b32 s1, 49152
	buffer_load_dwordx4 v10, s[24:27], s1 offen lds
	buffer_load_dwordx4 v23, s[24:27], s1 offen offset:1056 lds
	ds_read_b64_tr_b16 a[96:97], v3 offset:4224
	ds_read_b64_tr_b16 a[98:99], v3 offset:5248
	ds_read_b64_tr_b16 a[100:101], v3 offset:4736
	ds_read_b64_tr_b16 a[102:103], v3 offset:5760
	s_waitcnt vmcnt(15)
	ds_read_b64_tr_b16 a[104:105], v3 offset:6336
	ds_read_b64_tr_b16 a[106:107], v3 offset:7360
	ds_read_b64_tr_b16 a[108:109], v3 offset:6848
	ds_read_b64_tr_b16 a[110:111], v3 offset:7872
	s_waitcnt vmcnt(13)
	ds_read_b64_tr_b16 a[112:113], v3 offset:8448
	ds_read_b64_tr_b16 a[114:115], v3 offset:9472
	ds_read_b64_tr_b16 a[116:117], v3 offset:8960
	ds_read_b64_tr_b16 a[118:119], v3 offset:9984
	s_waitcnt vmcnt(11)
	ds_read_b64_tr_b16 a[120:121], v3 offset:42240
	ds_read_b64_tr_b16 a[122:123], v3 offset:43264
	ds_read_b64_tr_b16 a[124:125], v3 offset:42752
	ds_read_b64_tr_b16 a[126:127], v3 offset:43776
	s_lshl_b32 s54, s52, 10
	s_add_u32 s54, s54, 32768
	v_add_u32 v40, s54, v5
	v_bfe_u32 v41, v0, 4, 1
	v_lshlrev_b32 v41, 10, v41
	v_lshrrev_b32 v42, 5, v0
	v_lshl_add_u32 v41, v42, 8, v41
	v_and_b32 v43, 15, v0
	v_lshl_add_u32 v41, v43, 4, v41
	s_lshl_b32 s54, s52, 12
	s_add_u32 s54, s54, 32768
	v_add_u32 v41, s54, v41
	v_and_b32 v49, 3, v0
	v_lshlrev_b32 v51, 2, v49
	s_mov_b32 s54, 0x5412
	v_lshrrev_b32 v51, v51, s54
	v_and_b32 v51, 7, v51
	v_lshrrev_b32 v52, 2, v0
	v_xor_b32 v52, v52, v21
	v_and_b32 v52, 1, v52
	v_cmp_eq_u32 vcc, 0, v52
	s_nop 1
	v_cndmask_b32 v51, 5, v51, vcc
	v_lshlrev_b32 v51, 10, v51
	v_lshl_add_u32 v51, v42, 4, v51
	v_add_u32 v9, 157440, v51
	v_add_u32 v43, 157440, v5
	s_barrier
	ds_write_b128 v40, v[24:27] offset:0
	ds_write_b128 v40, v[28:31] offset:4096
	ds_write_b128 v40, v[32:35] offset:8192
	ds_write_b128 v40, v[36:39] offset:12288
	ds_read_b128 v[44:47], v43 offset:2048
	ds_read_b128 v[48:51], v43 offset:1024
	ds_read_b128 v[224:227], v9 offset:0
	ds_read_b128 v[228:231], v9 offset:32
	ds_read_b128 v[232:235], v9 offset:64
	ds_read_b128 v[236:239], v9 offset:96
	s_waitcnt lgkmcnt(3)
	v_mfma_f32_16x16x32_bf16 v[120:123], v[224:227], a[0:3], 0
	ds_read_b128 v[224:227], v9 offset:128
	s_waitcnt lgkmcnt(3)
	v_mfma_f32_16x16x32_bf16 v[124:127], v[228:231], a[4:7], 0
	ds_read_b128 v[228:231], v9 offset:160
	s_waitcnt lgkmcnt(3)
	v_mfma_f32_16x16x32_bf16 v[120:123], v[232:235], a[8:11], v[120:123]
	ds_read_b128 v[232:235], v9 offset:192
	s_waitcnt lgkmcnt(3)
	v_mfma_f32_16x16x32_bf16 v[124:127], v[236:239], a[12:15], v[124:127]
	ds_read_b128 v[236:239], v9 offset:224
	s_waitcnt lgkmcnt(3)
	v_mfma_f32_16x16x32_bf16 v[120:123], v[224:227], a[16:19], v[120:123]
	ds_read_b128 v[224:227], v9 offset:256
	s_waitcnt lgkmcnt(3)
	v_mfma_f32_16x16x32_bf16 v[124:127], v[228:231], a[20:23], v[124:127]
	ds_read_b128 v[228:231], v9 offset:288
	s_waitcnt lgkmcnt(3)
	v_mfma_f32_16x16x32_bf16 v[120:123], v[232:235], a[24:27], v[120:123]
	ds_read_b128 v[232:235], v9 offset:320
	s_waitcnt lgkmcnt(3)
	v_mfma_f32_16x16x32_bf16 v[124:127], v[236:239], a[28:31], v[124:127]
	ds_read_b128 v[236:239], v9 offset:352
	s_waitcnt lgkmcnt(3)
	v_mfma_f32_16x16x32_bf16 v[120:123], v[224:227], a[32:35], v[120:123]
	ds_read_b128 v[224:227], v9 offset:384
	s_waitcnt lgkmcnt(3)
	v_mfma_f32_16x16x32_bf16 v[124:127], v[228:231], a[36:39], v[124:127]
	ds_read_b128 v[228:231], v9 offset:416
	s_waitcnt lgkmcnt(3)
	v_mfma_f32_16x16x32_bf16 v[120:123], v[232:235], a[40:43], v[120:123]
	ds_read_b128 v[232:235], v9 offset:448
	s_waitcnt lgkmcnt(3)
	v_mfma_f32_16x16x32_bf16 v[124:127], v[236:239], a[44:47], v[124:127]
	ds_read_b128 v[236:239], v9 offset:480
	s_waitcnt lgkmcnt(3)
	v_mfma_f32_16x16x32_bf16 v[120:123], v[224:227], a[48:51], v[120:123]
	ds_read_b128 v[224:227], v9 offset:512
	s_waitcnt lgkmcnt(3)
	v_mfma_f32_16x16x32_bf16 v[124:127], v[228:231], a[52:55], v[124:127]
	s_waitcnt vmcnt(6)
	buffer_store_dword v8, v242, s[44:47], 0 offen sc1
	ds_read_b128 v[228:231], v9 offset:544
	s_waitcnt lgkmcnt(3)
	v_mfma_f32_16x16x32_bf16 v[120:123], v[232:235], a[56:59], v[120:123]
	ds_read_b128 v[232:235], v9 offset:576
	s_waitcnt lgkmcnt(3)
	v_mfma_f32_16x16x32_bf16 v[124:127], v[236:239], a[60:63], v[124:127]
	s_add_u32 m0, s0, 42240
	ds_read_b128 v[236:239], v9 offset:608
	s_waitcnt lgkmcnt(3)
	v_mfma_f32_16x16x32_bf16 v[120:123], v[224:227], a[64:67], v[120:123]
	s_mov_b32 s1, 65536
	ds_read_b128 v[224:227], v9 offset:640
	s_waitcnt lgkmcnt(3)
	v_mfma_f32_16x16x32_bf16 v[124:127], v[228:231], a[68:71], v[124:127]
	buffer_load_dwordx4 v10, s[24:27], s1 offen lds
	ds_read_b128 v[228:231], v9 offset:672
	s_waitcnt lgkmcnt(3)
	v_mfma_f32_16x16x32_bf16 v[120:123], v[232:235], a[72:75], v[120:123]
	buffer_load_dwordx4 v23, s[24:27], s1 offen offset:1056 lds
	ds_read_b128 v[232:235], v9 offset:704
	s_waitcnt lgkmcnt(3)
	v_mfma_f32_16x16x32_bf16 v[124:127], v[236:239], a[76:79], v[124:127]
	ds_read_b128 v[236:239], v9 offset:736
	s_waitcnt lgkmcnt(3)
	v_mfma_f32_16x16x32_bf16 v[120:123], v[224:227], a[80:83], v[120:123]
	ds_read_b128 v[224:227], v9 offset:768
	s_waitcnt lgkmcnt(3)
	v_mfma_f32_16x16x32_bf16 v[124:127], v[228:231], a[84:87], v[124:127]
	ds_read_b64_tr_b16 a[128:129], v11 offset:44352
	ds_read_b128 v[228:231], v9 offset:800
	s_waitcnt lgkmcnt(4)
	v_mfma_f32_16x16x32_bf16 v[120:123], v[232:235], a[88:91], v[120:123]
	ds_read_b64_tr_b16 a[130:131], v11 offset:45408
	ds_read_b128 v[232:235], v9 offset:832
	s_waitcnt lgkmcnt(5)
	v_mfma_f32_16x16x32_bf16 v[124:127], v[236:239], a[92:95], v[124:127]
	ds_read_b64_tr_b16 a[132:133], v12 offset:44352
	ds_read_b128 v[236:239], v9 offset:864
	s_waitcnt lgkmcnt(6)
	v_mfma_f32_16x16x32_bf16 v[120:123], v[224:227], a[96:99], v[120:123]
	ds_read_b64_tr_b16 a[134:135], v12 offset:45408
	ds_read_b128 v[224:227], v9 offset:896
	s_waitcnt lgkmcnt(6)
	v_mfma_f32_16x16x32_bf16 v[124:127], v[228:231], a[100:103], v[124:127]
	ds_read_b128 v[228:231], v9 offset:928
	s_waitcnt lgkmcnt(5)
	v_mfma_f32_16x16x32_bf16 v[120:123], v[232:235], a[104:107], v[120:123]
	s_waitcnt vmcnt(7)
	ds_read_b128 v[232:235], v9 offset:960
	s_waitcnt lgkmcnt(4)
	v_mfma_f32_16x16x32_bf16 v[124:127], v[236:239], a[108:111], v[124:127]
	ds_read_b64_tr_b16 a[136:137], v11 offset:46464
	ds_read_b128 v[236:239], v9 offset:992
	s_waitcnt lgkmcnt(4)
	v_mfma_f32_16x16x32_bf16 v[120:123], v[224:227], a[112:115], v[120:123]
	ds_read_b64_tr_b16 a[138:139], v11 offset:47520
	s_waitcnt lgkmcnt(4)
	v_mfma_f32_16x16x32_bf16 v[124:127], v[228:231], a[116:119], v[124:127]
	ds_read_b64_tr_b16 a[140:141], v12 offset:46464
	s_waitcnt lgkmcnt(4)
	v_mfma_f32_16x16x32_bf16 v[120:123], v[232:235], a[120:123], v[120:123]
	ds_read_b64_tr_b16 a[142:143], v12 offset:47520
	s_waitcnt lgkmcnt(3)
	v_mfma_f32_16x16x32_bf16 v[124:127], v[236:239], a[124:127], v[124:127]
	s_mov_b32 s54, 0x3f803f80
	v_dot2_f32_bf16 v72, v44, s54, 0
	s_add_u32 m0, s0, 44352
	v_dot2_f32_bf16 v73, v44, v44, 0
	s_mov_b32 s1, 81920
	v_dot2_f32_bf16 v74, v48, s54, 0
	buffer_load_dwordx4 v10, s[24:27], s1 offen lds
	v_dot2_f32_bf16 v75, v48, v48, 0
	v_dot2_f32_bf16 v76, v44, v48, 0
	buffer_load_dwordx4 v23, s[24:27], s1 offen offset:1056 lds
	v_dot2_f32_bf16 v72, v45, s54, v72
	s_waitcnt vmcnt(7)
	v_dot2_f32_bf16 v73, v45, v45, v73
	ds_read_b64_tr_b16 a[144:145], v11 offset:48576
	v_dot2_f32_bf16 v74, v49, s54, v74
	ds_read_b64_tr_b16 a[146:147], v11 offset:49632
	v_dot2_f32_bf16 v75, v49, v49, v75
	ds_read_b64_tr_b16 a[148:149], v12 offset:48576
	v_dot2_f32_bf16 v76, v45, v49, v76
	v_dot2_f32_bf16 v72, v46, s54, v72
	ds_read_b64_tr_b16 a[150:151], v12 offset:49632
	v_dot2_f32_bf16 v73, v46, v46, v73
	s_waitcnt lgkmcnt(4)
	v_dot2_f32_bf16 v74, v50, s54, v74
	s_add_u32 m0, s0, 46464
	v_dot2_f32_bf16 v75, v50, v50, v75
	s_mov_b32 s1, 98304
	v_dot2_f32_bf16 v76, v46, v50, v76
	buffer_load_dwordx4 v10, s[24:27], s1 offen lds
	v_dot2_f32_bf16 v72, v47, s54, v72
	v_dot2_f32_bf16 v73, v47, v47, v73
	buffer_load_dwordx4 v23, s[24:27], s1 offen offset:1056 lds
	v_dot2_f32_bf16 v74, v51, s54, v74
	s_waitcnt vmcnt(7)
	v_dot2_f32_bf16 v75, v51, v51, v75
	ds_read_b64_tr_b16 a[152:153], v11 offset:50688
	v_dot2_f32_bf16 v76, v47, v51, v76
	ds_read_b64_tr_b16 a[154:155], v11 offset:51744
	v_add_f32_dpp v72, v72, v72 row_ror:8 row_mask:0xf bank_mask:0xf
	v_add_f32_dpp v73, v73, v73 row_ror:8 row_mask:0xf bank_mask:0xf
	ds_read_b64_tr_b16 a[156:157], v12 offset:50688
	v_add_f32_dpp v74, v74, v74 row_ror:8 row_mask:0xf bank_mask:0xf
	ds_read_b64_tr_b16 a[158:159], v12 offset:51744
	v_add_f32_dpp v75, v75, v75 row_ror:8 row_mask:0xf bank_mask:0xf
	s_waitcnt lgkmcnt(4)
	v_add_f32_dpp v76, v76, v76 row_ror:8 row_mask:0xf bank_mask:0xf
	s_add_u32 m0, s0, 48576
	v_add_f32_dpp v72, v72, v72 row_ror:4 row_mask:0xf bank_mask:0xf
	s_mov_b32 s1, 114688
	v_add_f32_dpp v73, v73, v73 row_ror:4 row_mask:0xf bank_mask:0xf
	v_add_f32_dpp v74, v74, v74 row_ror:4 row_mask:0xf bank_mask:0xf
	buffer_load_dwordx4 v10, s[24:27], s1 offen lds
	v_add_f32_dpp v75, v75, v75 row_ror:4 row_mask:0xf bank_mask:0xf
	buffer_load_dwordx4 v23, s[24:27], s1 offen offset:1056 lds
	v_add_f32_dpp v76, v76, v76 row_ror:4 row_mask:0xf bank_mask:0xf
	s_waitcnt vmcnt(6)
	v_add_f32_dpp v72, v72, v72 row_ror:2 row_mask:0xf bank_mask:0xf
	ds_read_b64_tr_b16 a[160:161], v11 offset:42240
	v_add_f32_dpp v73, v73, v73 row_ror:2 row_mask:0xf bank_mask:0xf
	ds_read_b64_tr_b16 a[162:163], v11 offset:43296
	v_add_f32_dpp v74, v74, v74 row_ror:2 row_mask:0xf bank_mask:0xf
	v_add_f32_dpp v75, v75, v75 row_ror:2 row_mask:0xf bank_mask:0xf
	ds_read_b64_tr_b16 a[164:165], v12 offset:42240
	v_add_f32_dpp v76, v76, v76 row_ror:2 row_mask:0xf bank_mask:0xf
	ds_read_b64_tr_b16 a[166:167], v12 offset:43296
	v_add_f32_dpp v72, v72, v72 row_ror:1 row_mask:0xf bank_mask:0xf
	s_waitcnt lgkmcnt(4)
	v_add_f32_dpp v73, v73, v73 row_ror:1 row_mask:0xf bank_mask:0xf
	s_add_u32 m0, s0, 50688
	v_add_f32_dpp v74, v74, v74 row_ror:1 row_mask:0xf bank_mask:0xf
	s_mov_b32 s1, 131072
	v_add_f32_dpp v75, v75, v75 row_ror:1 row_mask:0xf bank_mask:0xf
	v_add_f32_dpp v76, v76, v76 row_ror:1 row_mask:0xf bank_mask:0xf
	buffer_load_dwordx4 v10, s[24:27], s1 offen lds
	v_mov_b32 v80, v72
	buffer_load_dwordx4 v23, s[24:27], s1 offen offset:1056 lds
	v_mov_b32 v81, v73
	s_waitcnt vmcnt(6)
	v_mov_b32 v82, v74
	ds_read_b64_tr_b16 a[168:169], v11 offset:44352
	v_mov_b32 v83, v75
	v_mov_b32 v84, v76
	ds_read_b64_tr_b16 a[170:171], v11 offset:45408
	v_permlane16_swap_b32 v72, v80
	ds_read_b64_tr_b16 a[172:173], v12 offset:44352
	v_permlane16_swap_b32 v73, v81
	ds_read_b64_tr_b16 a[174:175], v12 offset:45408
	v_permlane16_swap_b32 v74, v82
	s_waitcnt lgkmcnt(4)
	v_permlane16_swap_b32 v75, v83
	s_add_u32 m0, s0, 42240
	v_permlane16_swap_b32 v76, v84
	v_add_f32 v72, v72, v80
	s_mov_b32 s1, 147456
	v_add_f32 v73, v73, v81
	buffer_load_dwordx4 v10, s[24:27], s1 offen lds
	v_add_f32 v74, v74, v82
	buffer_load_dwordx4 v23, s[24:27], s1 offen offset:1056 lds
	v_add_f32 v75, v75, v83
	s_waitcnt vmcnt(6)
	v_add_f32 v76, v76, v84
	ds_read_b64_tr_b16 a[176:177], v11 offset:46464
	v_mov_b32 v80, v72
	v_mov_b32 v81, v73
	ds_read_b64_tr_b16 a[178:179], v11 offset:47520
	v_mov_b32 v82, v74
	ds_read_b64_tr_b16 a[180:181], v12 offset:46464
	v_mov_b32 v83, v75
	ds_read_b64_tr_b16 a[182:183], v12 offset:47520
	v_mov_b32 v84, v76
	s_waitcnt lgkmcnt(4)
	v_permlane32_swap_b32 v72, v80
	v_permlane32_swap_b32 v73, v81
	s_add_u32 m0, s0, 44352
	v_permlane32_swap_b32 v74, v82
	s_mov_b32 s1, 163840
	v_permlane32_swap_b32 v75, v83
	buffer_load_dwordx4 v10, s[24:27], s1 offen lds
	v_permlane32_swap_b32 v76, v84
	buffer_load_dwordx4 v23, s[24:27], s1 offen offset:1056 lds
	v_add_f32 v72, v72, v80
	s_waitcnt vmcnt(6)
	v_add_f32 v73, v73, v81
	v_add_f32 v74, v74, v82
	ds_read_b64_tr_b16 a[184:185], v11 offset:48576
	v_add_f32 v75, v75, v83
	ds_read_b64_tr_b16 a[186:187], v11 offset:49632
	v_add_f32 v76, v76, v84
	ds_read_b64_tr_b16 a[188:189], v12 offset:48576
	v_readfirstlane_b32 s62, v72
	ds_read_b64_tr_b16 a[190:191], v12 offset:49632
	v_readfirstlane_b32 s63, v73
	s_waitcnt lgkmcnt(4)
	v_readfirstlane_b32 s64, v74
	v_readfirstlane_b32 s65, v75
	s_add_u32 m0, s0, 46464
	v_readfirstlane_b32 s66, v76
	s_mov_b32 s1, 180224
	s_lshl_b32 s54, s61, 7
	buffer_load_dwordx4 v10, s[24:27], s1 offen lds
	s_add_u32 s54, s54, 28672
	buffer_load_dwordx4 v23, s[24:27], s1 offen offset:1056 lds
	v_lshl_add_u32 v13, v0, 2, s54
	buffer_load_dword v4, v13, s[44:47], 0 offen sc1
	s_barrier
	ds_read_b128 v[24:27], v41 offset:0
	ds_read_b128 v[28:31], v41 offset:512
	ds_read_b128 v[32:35], v41 offset:2048
	ds_read_b128 v[36:39], v41 offset:2560
	v_add_f32 v124, v124, v120
	v_add_f32 v125, v125, v121
	v_add_f32 v126, v126, v122
	v_lshlrev_b32 v127, 16, v22
	v_cvt_pk_bf16_f32 v72, v124, v125
	v_cvt_pk_bf16_f32 v73, v126, v127
	v_lshlrev_b32 v74, 16, v72
	v_and_b32 v75, s67, v72
	v_lshlrev_b32 v76, 16, v73
	v_sub_f32 v74, v124, v74
	v_sub_f32 v75, v125, v75
	v_sub_f32 v76, v126, v76
	v_cvt_pk_bf16_f32 v74, v74, v75
	v_cvt_pk_bf16_f32 v75, v76, 0
	v_cndmask_b32 v124, v72, v74, s[2:3]
	v_cndmask_b32 v125, v73, v75, s[2:3]
	v_cndmask_b32 v126, v72, 0, s[2:3]
	v_cndmask_b32 v127, v73, 0, s[2:3]
	s_lshl_b32 s68, s52, 12
	v_add_u32 v21, s68, v5
	v_add_u32 v16, 65536, v5
	v_add_u32 v17, 157440, v5
	v_and_b32 v18, 31, v0
	v_lshlrev_b32 v18, 4, v18
	v_lshl_add_u32 v6, v42, 10, v18
	v_add_u32 v18, 161536, v18
	s_mul_i32 s54, s61, 229376
	s_lshl_b32 s55, s60, 13
	s_add_u32 s54, s54, s55
	s_lshl_b32 s55, s52, 11
	s_add_u32 s54, s54, s55
	s_add_u32 s54, s54, 8388608
	v_add_u32 v19, s54, v5
	s_lshl_b32 s54, s52, 10
	v_add_u32 v1, s54, v17
	s_lshl_b32 s54, s52, 9
	v_add_u32 v3, s54, v18
	s_lshl_b32 s54, s61, 9
	s_lshl_b32 s55, s60, 4
	s_add_u32 s54, s54, s55
	s_lshl_b32 s55, s52, 2
	s_add_u32 s54, s54, s55
	s_add_u32 s54, s54, 32768
	v_mov_b32 v20, s54
	v_min_u32 v7, 13, v0
	s_mul_i32 s54, s52, 56
	s_lshl_b32 s55, s50, 9
	s_add_u32 s54, s54, s55
	s_add_u32 s54, s54, 32768
	v_lshl_add_u32 v7, v7, 2, s54
	s_lshl_b32 s57, s61, 16
	s_add_u32 s57, s57, 3145728
	s_and_b32 s56, s52, 1
	s_add_u32 s56, s56, s61
	s_lshl_b32 s56, s56, 14
	s_lshr_b32 s55, s52, 1
	s_lshl_b32 s55, s55, 9
	s_add_u32 s56, s56, s55
	s_add_u32 s56, s56, 524288
	s_cmp_ge_u32 s49, 28
	s_cbranch_scc1 IDLES
	s_waitcnt vmcnt(0)
	v_cmp_ne_u32 vcc, s53, v4
	s_cbranch_vccz ok_33
	s_mov_b32 s58, 200000
poll_34:
	buffer_load_dword v4, v13, s[44:47], 0 offen sc1
	s_waitcnt vmcnt(0)
	v_cmp_ne_u32 vcc, s53, v4
	s_cbranch_vccz pdone_35
	s_sub_u32 s58, s58, 1
	s_cbranch_scc0 poll_34
pdone_35:
ok_33:
	s_add_u32 m0, s68, 0
	s_add_u32 s1, s57, 0
	ds_read_b64_tr_b16 a[192:193], v11 offset:50688
	buffer_load_dwordx4 v21, s[44:47], s1 offen offset:0 sc1 lds
	ds_read_b64_tr_b16 a[194:195], v11 offset:51744
	buffer_load_dwordx4 v21, s[44:47], s1 offen offset:1024 sc1 lds
	ds_read_b64_tr_b16 a[196:197], v12 offset:50688
	buffer_load_dwordx4 v21, s[44:47], s1 offen offset:2048 sc1 lds
	ds_read_b64_tr_b16 a[198:199], v12 offset:51744
	buffer_load_dwordx4 v21, s[44:47], s1 offen offset:3072 sc1 lds
	s_add_u32 m0, s68, 16384
	ds_read_b64_tr_b16 a[200:201], v11 offset:42240
	s_add_u32 s1, s57, 16384
	ds_read_b64_tr_b16 a[202:203], v11 offset:43296
	buffer_load_dwordx4 v21, s[44:47], s1 offen offset:0 sc1 lds
	buffer_load_dwordx4 v21, s[44:47], s1 offen offset:1024 sc1 lds
	ds_read_b64_tr_b16 a[204:205], v12 offset:42240
	buffer_load_dwordx4 v21, s[44:47], s1 offen offset:2048 sc1 lds
	ds_read_b64_tr_b16 a[206:207], v12 offset:43296
	buffer_load_dwordx4 v21, s[44:47], s1 offen offset:3072 sc1 lds
	buffer_load_dwordx4 v[128:131], v6, s[44:47], s56 offen offset:0 sc1
	ds_read_b64_tr_b16 a[208:209], v11 offset:44352
	buffer_load_dwordx4 v[132:135], v6, s[44:47], s56 offen offset:2048 sc1
	ds_read_b64_tr_b16 a[210:211], v11 offset:45408
	s_add_u32 s56, s56, 4096
	ds_read_b64_tr_b16 a[212:213], v12 offset:44352
	buffer_load_dwordx4 v[136:139], v6, s[44:47], s56 offen offset:0 sc1
	ds_read_b64_tr_b16 a[214:215], v12 offset:45408
	buffer_load_dwordx4 v[140:143], v6, s[44:47], s56 offen offset:2048 sc1
	s_waitcnt vmcnt(8)
	s_waitcnt lgkmcnt(0)
	s_barrier
	ds_read_b128 v[72:75], v5 offset:0
	ds_read_b128 v[76:79], v5 offset:1024
	ds_read_b128 v[80:83], v5 offset:2048
	ds_read_b128 v[84:87], v5 offset:3072
	ds_read_b128 v[88:91], v5 offset:4096
	ds_read_b128 v[92:95], v5 offset:5120
	ds_read_b128 v[96:99], v5 offset:6144
	s_waitcnt lgkmcnt(6)
	v_mfma_f32_32x32x16_bf16 v[40:55], a[0:3], v[72:75], 0
	ds_read_b128 v[100:103], v5 offset:7168
	s_add_u32 s56, s56, 4096
	buffer_load_dwordx4 v[144:147], v6, s[44:47], s56 offen offset:0 sc1
	s_waitcnt lgkmcnt(6)
	v_mfma_f32_32x32x16_bf16 v[40:55], a[4:7], v[76:79], v[40:55]
	ds_read_b128 v[72:75], v5 offset:8192
	buffer_load_dwordx4 v[148:151], v6, s[44:47], s56 offen offset:2048 sc1
	s_waitcnt lgkmcnt(6)
	v_mfma_f32_32x32x16_bf16 v[40:55], a[8:11], v[80:83], v[40:55]
	ds_read_b128 v[76:79], v5 offset:9216
	s_add_u32 s56, s56, 4096
	s_waitcnt lgkmcnt(4)
	v_mfma_f32_32x32x16_bf16 v[40:55], a[12:15], v[84:87], v[40:55]
	ds_read_b128 v[80:83], v5 offset:10240
	buffer_load_dwordx4 v[152:155], v6, s[44:47], s56 offen offset:0 sc1
	buffer_load_dwordx4 v[156:159], v6, s[44:47], s56 offen offset:2048 sc1
	v_mfma_f32_32x32x16_bf16 v[40:55], a[16:19], v[88:91], v[40:55]
	ds_read_b128 v[84:87], v5 offset:11264
	s_add_u32 m0, s68, 32768
	v_mfma_f32_32x32x16_bf16 v[40:55], a[20:23], v[92:95], v[40:55]
	ds_read_b128 v[88:91], v5 offset:12288
	s_add_u32 s1, s57, 65536
	s_waitcnt lgkmcnt(4)
	v_mfma_f32_32x32x16_bf16 v[40:55], a[24:27], v[96:99], v[40:55]
	ds_read_b128 v[92:95], v5 offset:13312
	buffer_load_dwordx4 v21, s[44:47], s1 offen offset:0 sc1 lds
	v_mfma_f32_32x32x16_bf16 v[40:55], a[28:31], v[100:103], v[40:55]
	ds_read_b128 v[96:99], v5 offset:14336
	buffer_load_dwordx4 v21, s[44:47], s1 offen offset:1024 sc1 lds
	buffer_load_dwordx4 v21, s[44:47], s1 offen offset:2048 sc1 lds
	v_mfma_f32_32x32x16_bf16 v[40:55], a[32:35], v[72:75], v[40:55]
	ds_read_b128 v[100:103], v5 offset:15360
	buffer_load_dwordx4 v21, s[44:47], s1 offen offset:3072 sc1 lds
	s_waitcnt lgkmcnt(4)
	v_mfma_f32_32x32x16_bf16 v[40:55], a[36:39], v[76:79], v[40:55]
	s_add_u32 m0, s68, 49152
	v_mfma_f32_32x32x16_bf16 v[40:55], a[40:43], v[80:83], v[40:55]
	s_add_u32 s1, s57, 81920
	buffer_load_dwordx4 v21, s[44:47], s1 offen offset:0 sc1 lds
	s_waitcnt vmcnt(11)
	v_add_f32 v128, v128, v132
	s_waitcnt vmcnt(9)
	v_add_f32 v136, v136, v140
	s_waitcnt vmcnt(7)
	v_add_f32 v144, v144, v148
	s_waitcnt vmcnt(5)
	v_add_f32 v152, v152, v156
	v_add_f32 v129, v129, v133
	v_mfma_f32_32x32x16_bf16 v[40:55], a[44:47], v[84:87], v[40:55]
	buffer_load_dwordx4 v21, s[44:47], s1 offen offset:1024 sc1 lds
	v_add_f32 v137, v137, v141
	v_add_f32 v145, v145, v149
	v_add_f32 v153, v153, v157
	v_add_f32 v130, v130, v134
	s_waitcnt lgkmcnt(1)
	v_mfma_f32_32x32x16_bf16 v[40:55], a[48:51], v[88:91], v[40:55]
	buffer_load_dwordx4 v21, s[44:47], s1 offen offset:2048 sc1 lds
	v_add_f32 v138, v138, v142
	v_add_f32 v146, v146, v150
	v_add_f32 v154, v154, v158
	v_add_f32 v128, v128, v136
	v_mfma_f32_32x32x16_bf16 v[40:55], a[52:55], v[92:95], v[40:55]
	s_barrier
	ds_read_b128 v[72:75], v5 offset:16384
	ds_read_b128 v[76:79], v5 offset:17408
	ds_read_b128 v[80:83], v5 offset:18432
	ds_read_b128 v[84:87], v5 offset:19456
	ds_read_b128 v[88:91], v5 offset:20480
	buffer_load_dwordx4 v21, s[44:47], s1 offen offset:3072 sc1 lds
	v_add_f32 v144, v144, v152
	v_add_f32 v129, v129, v137
	v_add_f32 v145, v145, v153
	v_add_f32 v130, v130, v138
	v_add_f32 v146, v146, v154
	v_mfma_f32_32x32x16_bf16 v[40:55], a[56:59], v[96:99], v[40:55]
	ds_read_b128 v[92:95], v5 offset:21504
	s_add_u32 m0, s0, 48576
	s_mov_b32 s1, 196608
	buffer_load_dwordx4 v10, s[24:27], s1 offen lds
	buffer_load_dwordx4 v23, s[24:27], s1 offen offset:1056 lds
	v_add_f32 v56, v128, v144
	v_add_f32 v57, v129, v145
	v_add_f32 v58, v130, v146
	v_mov_b32 v60, v56
	s_waitcnt lgkmcnt(4)
	v_mfma_f32_32x32x16_bf16 v[40:55], a[60:63], v[100:103], v[40:55]
	ds_read_b128 v[96:99], v5 offset:22528
	s_add_u32 m0, s0, 50688
	s_mov_b32 s1, 212992
	buffer_load_dwordx4 v10, s[24:27], s1 offen lds
	v_mov_b32 v61, v57
	v_mov_b32 v62, v58
	s_mov_b32 s54, 0x3b000000
	s_mov_b32 s55, 0x3727c5ac
	v_mfma_f32_32x32x16_bf16 v[40:55], a[64:67], v[72:75], v[40:55]
	ds_read_b128 v[100:103], v5 offset:23552
	buffer_load_dwordx4 v23, s[24:27], s1 offen offset:1056 lds
	s_add_u32 m0, s0, 42240
	s_mov_b32 s1, 229376
	buffer_load_dwordx4 v10, s[24:27], s1 offen lds
	v_permlane32_swap_b32 v56, v60
	v_permlane32_swap_b32 v57, v61
	v_permlane32_swap_b32 v58, v62
	v_mul_f32 v64, s54, v56
	v_mfma_f32_32x32x16_bf16 v[40:55], a[68:71], v[76:79], v[40:55]
	ds_read_b128 v[72:75], v5 offset:24576
	buffer_load_dwordx4 v23, s[24:27], s1 offen offset:1056 lds
	s_add_u32 m0, s0, 44352
	s_mov_b32 s1, 245760
	v_mul_f32 v65, v64, v64
	v_fma_f32 v65, v60, s54, -v65
	v_max_f32 v65, 0, v65
	v_add_f32 v65, s55, v65
	v_rsq_f32 v66, v65
	s_waitcnt lgkmcnt(4)
	v_mfma_f32_32x32x16_bf16 v[40:55], a[72:75], v[80:83], v[40:55]
	ds_read_b128 v[76:79], v5 offset:25600
	buffer_load_dwordx4 v10, s[24:27], s1 offen lds
	buffer_load_dwordx4 v23, s[24:27], s1 offen offset:1056 lds
	ds_read_b64_tr_b16 a[216:217], v11 offset:46464
	v_fma_f32 v57, -v64, s62, v57
	v_mul_f32 v67, v65, v66
	v_fma_f32 v57, v57, v66, s64
	v_mul_f32 v57, s54, v57
	v_mfma_f32_32x32x16_bf16 v[40:55], a[76:79], v[84:87], v[40:55]
	ds_read_b128 v[80:83], v5 offset:26624
	ds_read_b64_tr_b16 a[218:219], v11 offset:47520
	ds_read_b64_tr_b16 a[220:221], v12 offset:46464
	ds_read_b64_tr_b16 a[222:223], v12 offset:47520
	s_waitcnt vmcnt(6)
	ds_read_b64_tr_b16 a[224:225], v11 offset:48576
	v_mul_f32 v68, s63, v64
	v_fma_f32 v68, v58, -2.0, v68
	v_fma_f32 v68, v68, v64, v61
	v_fma_f32 v62, -v64, s66, v62
	v_mfma_f32_32x32x16_bf16 v[40:55], a[80:83], v[88:91], v[40:55]
	ds_read_b128 v[84:87], v5 offset:27648
	ds_read_b64_tr_b16 a[226:227], v11 offset:49632
	ds_read_b64_tr_b16 a[228:229], v12 offset:48576
	ds_read_b64_tr_b16 a[230:231], v12 offset:49632
	s_waitcnt lgkmcnt(5)
	v_add_f32 v62, v62, v62
	v_fma_f32 v68, v68, v66, v62
	v_fma_f32 v68, v68, v66, s65
	v_mul_f32 v69, v57, v57
	v_fma_f32 v68, v68, s54, -v69
	v_mfma_f32_32x32x16_bf16 v[40:55], a[84:87], v[92:95], v[40:55]
	ds_read_b128 v[88:91], v5 offset:28672
	s_add_u32 m0, s0, 46464
	s_mov_b32 s1, 262144
	buffer_load_dwordx4 v10, s[24:27], s1 offen lds
	buffer_load_dwordx4 v23, s[24:27], s1 offen offset:1056 lds
	v_max_f32 v68, 0, v68
	v_add_f32 v68, s55, v68
	v_rsq_f32 v69, v68
	v_sub_f32 v128, 0, v64
	v_mfma_f32_32x32x16_bf16 v[40:55], a[88:91], v[96:99], v[40:55]
	ds_read_b128 v[92:95], v5 offset:29696
	s_add_u32 m0, s68, 65536
	s_add_u32 s1, s57, 32768
	v_mul_f32 v130, -v57, v67
	v_mul_f32 v68, v68, v69
	v_mul_f32 v69, v69, v66
	v_mul_f32 v131, v68, v67
	v_mfma_f32_32x32x16_bf16 v[40:55], a[92:95], v[100:103], v[40:55]
	ds_read_b128 v[96:99], v5 offset:30720
	buffer_load_dwordx4 v21, s[44:47], s1 offen offset:0 sc1 lds
	v_mul_f32 v132, 0xc0135761, v69
	v_mul_f32 v133, v69, v69
	v_mul_f32 v133, v133, v69
	v_mul_f32 v133, 0xbdd2d3e8, v133
	v_mfma_f32_32x32x16_bf16 v[40:55], a[96:99], v[72:75], v[40:55]
	ds_read_b128 v[100:103], v5 offset:31744
	buffer_load_dwordx4 v21, s[44:47], s1 offen offset:1024 sc1 lds
	v_mov_b32 v134, v131
	ds_write_b128 v3, v[132:135]
	v_cvt_pk_bf16_f32 v56, v128, v67
	v_cvt_pk_bf16_f32 v57, v130, v131
	v_lshlrev_b32 v60, 16, v56
	v_mfma_f32_32x32x16_bf16 v[40:55], a[100:103], v[76:79], v[40:55]
	buffer_load_dwordx4 v21, s[44:47], s1 offen offset:2048 sc1 lds
	v_and_b32 v61, s67, v56
	v_lshlrev_b32 v62, 16, v57
	v_and_b32 v63, s67, v57
	v_sub_f32 v60, v128, v60
	v_mfma_f32_32x32x16_bf16 v[40:55], a[104:107], v[80:83], v[40:55]
	buffer_load_dwordx4 v21, s[44:47], s1 offen offset:3072 sc1 lds
	v_sub_f32 v61, v67, v61
	v_sub_f32 v62, v130, v62
	v_sub_f32 v63, v131, v63
	v_cvt_pk_bf16_f32 v58, v60, v61
	s_waitcnt lgkmcnt(3)
	v_mfma_f32_32x32x16_bf16 v[40:55], a[108:111], v[84:87], v[40:55]
	s_add_u32 m0, s68, 81920
	v_cvt_pk_bf16_f32 v59, v62, v63
	v_cndmask_b32 v58, v58, 0, s[2:3]
	v_cndmask_b32 v59, v59, 0, s[2:3]
	ds_write_b128 v1, v[56:59]
	v_mfma_f32_32x32x16_bf16 v[40:55], a[112:115], v[88:91], v[40:55]
	s_add_u32 s1, s57, 49152
	v_mfma_f32_32x32x16_bf16 v[40:55], a[116:119], v[92:95], v[40:55]
	s_waitcnt lgkmcnt(0)
	s_barrier
	ds_read_b128 v[72:75], v17 offset:0
	ds_read_b128 v[76:79], v5 offset:32768
	ds_read_b128 v[80:83], v5 offset:33792
	ds_read_b128 v[84:87], v5 offset:34816
	ds_read_b128 v[88:91], v5 offset:35840
	buffer_load_dwordx4 v21, s[44:47], s1 offen offset:0 sc1 lds
	v_mfma_f32_32x32x16_bf16 v[40:55], a[120:123], v[96:99], v[40:55]
	ds_read_b128 v[92:95], v5 offset:36864
	buffer_load_dwordx4 v21, s[44:47], s1 offen offset:1024 sc1 lds
	v_mfma_f32_32x32x16_bf16 v[40:55], a[124:127], v[100:103], v[40:55]
	ds_read_b128 v[96:99], v5 offset:37888
	buffer_load_dwordx4 v21, s[44:47], s1 offen offset:2048 sc1 lds
	s_waitcnt lgkmcnt(6)
	v_mfma_f32_32x32x16_bf16 v[40:55], v[124:127], v[72:75], v[40:55]
	ds_read_b128 v[100:103], v5 offset:38912
	buffer_load_dwordx4 v21, s[44:47], s1 offen offset:3072 sc1 lds
	s_waitcnt lgkmcnt(4)
	v_mfma_f32_32x32x16_bf16 v[56:71], a[0:3], v[76:79], 0
	ds_read_b128 v[72:75], v5 offset:39936
	s_add_u32 m0, s68, 0
	v_mfma_f32_32x32x16_bf16 v[56:71], a[4:7], v[80:83], v[56:71]
	ds_read_b128 v[76:79], v5 offset:40960
	ds_read_b128 v[112:115], v18 offset:0
	v_mul_f32 v128, v40, v40
	v_mul_f32 v129, v41, v41
	v_mul_f32 v130, v42, v42
	s_add_u32 s1, s57, 98304
	v_mfma_f32_32x32x16_bf16 v[56:71], a[8:11], v[84:87], v[56:71]
	ds_read_b128 v[80:83], v5 offset:41984
	v_mul_f32 v131, v43, v43
	s_waitcnt lgkmcnt(1)
	v_fma_f32 v128, v128, v113, v112
	v_fma_f32 v129, v129, v113, v112
	v_fma_f32 v130, v130, v113, v112
	buffer_load_dwordx4 v21, s[44:47], s1 offen offset:0 sc1 lds
	v_mfma_f32_32x32x16_bf16 v[56:71], a[12:15], v[88:91], v[56:71]
	ds_read_b128 v[84:87], v5 offset:43008
	v_fma_f32 v131, v131, v113, v112
	v_mul_f32 v128, v128, v40
	v_mul_f32 v129, v129, v41
	v_mul_f32 v130, v130, v42
	buffer_load_dwordx4 v21, s[44:47], s1 offen offset:1024 sc1 lds
	v_mfma_f32_32x32x16_bf16 v[56:71], a[16:19], v[92:95], v[56:71]
	ds_read_b128 v[88:91], v5 offset:44032
	v_mul_f32 v131, v131, v43
	v_exp_f32 v128, v128
	v_exp_f32 v129, v129
	v_exp_f32 v130, v130
	buffer_load_dwordx4 v21, s[44:47], s1 offen offset:2048 sc1 lds
	v_mfma_f32_32x32x16_bf16 v[56:71], a[20:23], v[96:99], v[56:71]
	ds_read_b128 v[92:95], v5 offset:45056
	v_exp_f32 v131, v131
	v_fma_f32 v128, v128, v114, v114
	v_fma_f32 v129, v129, v114, v114
	v_fma_f32 v130, v130, v114, v114
	buffer_load_dwordx4 v21, s[44:47], s1 offen offset:3072 sc1 lds
	v_mfma_f32_32x32x16_bf16 v[56:71], a[24:27], v[100:103], v[56:71]
	ds_read_b128 v[96:99], v5 offset:46080
	v_fma_f32 v131, v131, v114, v114
	v_rcp_f32 v128, v128
	v_rcp_f32 v129, v129
	v_rcp_f32 v130, v130
	v_mfma_f32_32x32x16_bf16 v[56:71], a[28:31], v[72:75], v[56:71]
	ds_read_b128 v[100:103], v5 offset:47104
	v_rcp_f32 v131, v131
	v_mul_f32 v128, v128, v40
	v_mul_f32 v129, v129, v41
	v_mul_f32 v130, v130, v42
	s_add_u32 m0, s68, 16384
	v_mfma_f32_32x32x16_bf16 v[56:71], a[32:35], v[76:79], v[56:71]
	ds_read_b128 v[72:75], v5 offset:48128
	v_mul_f32 v131, v131, v43
	v_cvt_pk_bf16_f32 v116, v128, v129
	v_cvt_pk_bf16_f32 v117, v130, v131
	s_add_u32 s1, s57, 114688
	s_waitcnt lgkmcnt(4)
	v_mfma_f32_32x32x16_bf16 v[56:71], a[36:39], v[80:83], v[56:71]
	ds_read_b128 v[76:79], v5 offset:49152
	v_mul_f32 v132, v44, v44
	v_mul_f32 v133, v45, v45
	v_mul_f32 v134, v46, v46
	v_mul_f32 v135, v47, v47
	buffer_load_dwordx4 v21, s[44:47], s1 offen offset:0 sc1 lds
	v_mfma_f32_32x32x16_bf16 v[56:71], a[40:43], v[84:87], v[56:71]
	ds_read_b128 v[80:83], v5 offset:50176
	v_fma_f32 v132, v132, v113, v112
	v_fma_f32 v133, v133, v113, v112
	v_fma_f32 v134, v134, v113, v112
	v_fma_f32 v135, v135, v113, v112
	buffer_load_dwordx4 v21, s[44:47], s1 offen offset:1024 sc1 lds
	v_mfma_f32_32x32x16_bf16 v[56:71], a[44:47], v[88:91], v[56:71]
	ds_read_b128 v[84:87], v5 offset:51200
	v_mul_f32 v132, v132, v44
	v_mul_f32 v133, v133, v45
	v_mul_f32 v134, v134, v46
	v_mul_f32 v135, v135, v47
	buffer_load_dwordx4 v21, s[44:47], s1 offen offset:2048 sc1 lds
	s_waitcnt lgkmcnt(4)
	v_mfma_f32_32x32x16_bf16 v[56:71], a[48:51], v[92:95], v[56:71]
	ds_read_b128 v[88:91], v5 offset:52224
	v_exp_f32 v132, v132
	v_exp_f32 v133, v133
	v_exp_f32 v134, v134
	v_exp_f32 v135, v135
	buffer_load_dwordx4 v21, s[44:47], s1 offen offset:3072 sc1 lds
	v_mfma_f32_32x32x16_bf16 v[56:71], a[52:55], v[96:99], v[56:71]
	ds_read_b128 v[92:95], v5 offset:53248
	v_fma_f32 v132, v132, v114, v114
	v_fma_f32 v133, v133, v114, v114
	v_fma_f32 v134, v134, v114, v114
	v_fma_f32 v135, v135, v114, v114
	v_mfma_f32_32x32x16_bf16 v[56:71], a[56:59], v[100:103], v[56:71]
	ds_read_b128 v[96:99], v5 offset:54272
	v_rcp_f32 v132, v132
	v_rcp_f32 v133, v133
	v_rcp_f32 v134, v134
	v_rcp_f32 v135, v135
	s_waitcnt vmcnt(22)
	ds_read_b64_tr_b16 a[232:233], v11 offset:50688
	ds_read_b64_tr_b16 a[234:235], v11 offset:51744
	s_waitcnt lgkmcnt(6)
	v_mfma_f32_32x32x16_bf16 v[56:71], a[60:63], v[72:75], v[56:71]
	ds_read_b128 v[100:103], v5 offset:55296
	v_mul_f32 v132, v132, v44
	v_mul_f32 v133, v133, v45
	v_mul_f32 v134, v134, v46
	v_mul_f32 v135, v135, v47
	ds_read_b64_tr_b16 a[236:237], v12 offset:50688
	ds_read_b64_tr_b16 a[238:239], v12 offset:51744
	v_mfma_f32_32x32x16_bf16 v[56:71], a[64:67], v[76:79], v[56:71]
	ds_read_b128 v[72:75], v5 offset:56320
	v_cvt_pk_bf16_f32 v118, v132, v133
	v_cvt_pk_bf16_f32 v119, v134, v135
	s_mov_b32 s54, 0
	buffer_store_dwordx4 v[116:119], v19, s[44:47], s54 offen offset:0 sc1
	s_add_u32 m0, s0, 48576
	s_mov_b32 s1, 278528
	v_mfma_f32_32x32x16_bf16 v[56:71], a[68:71], v[80:83], v[56:71]
	ds_read_b128 v[76:79], v5 offset:57344
	v_mul_f32 v128, v48, v48
	v_mul_f32 v129, v49, v49
	v_mul_f32 v130, v50, v50
	v_mul_f32 v131, v51, v51
	buffer_load_dwordx4 v10, s[24:27], s1 offen lds
	buffer_load_dwordx4 v23, s[24:27], s1 offen offset:1056 lds
	s_waitcnt vmcnt(23)
	s_waitcnt lgkmcnt(8)
	v_mfma_f32_32x32x16_bf16 v[56:71], a[72:75], v[84:87], v[56:71]
	ds_read_b128 v[80:83], v5 offset:58368
	v_fma_f32 v128, v128, v113, v112
	v_fma_f32 v129, v129, v113, v112
	v_fma_f32 v130, v130, v113, v112
	v_fma_f32 v131, v131, v113, v112
	ds_read_b64_tr_b16 a[240:241], v11 offset:42240
	ds_read_b64_tr_b16 a[242:243], v11 offset:43296
	ds_read_b64_tr_b16 a[244:245], v12 offset:42240
	v_mfma_f32_32x32x16_bf16 v[56:71], a[76:79], v[88:91], v[56:71]
	ds_read_b128 v[84:87], v5 offset:59392
	v_mul_f32 v128, v128, v48
	v_mul_f32 v129, v129, v49
	v_mul_f32 v130, v130, v50
	v_mul_f32 v131, v131, v51
	ds_read_b64_tr_b16 a[246:247], v12 offset:43296
	s_waitcnt lgkmcnt(8)
	v_mfma_f32_32x32x16_bf16 v[56:71], a[80:83], v[92:95], v[56:71]
	ds_read_b128 v[88:91], v5 offset:60416
	v_exp_f32 v128, v128
	v_exp_f32 v129, v129
	v_exp_f32 v130, v130
	v_exp_f32 v131, v131
	s_add_u32 m0, s0, 50688
	s_mov_b32 s1, 294912
	buffer_load_dwordx4 v10, s[24:27], s1 offen lds
	s_waitcnt lgkmcnt(8)
	v_mfma_f32_32x32x16_bf16 v[56:71], a[84:87], v[96:99], v[56:71]
	ds_read_b128 v[92:95], v5 offset:61440
	v_fma_f32 v128, v128, v114, v114
	v_fma_f32 v129, v129, v114, v114
	v_fma_f32 v130, v130, v114, v114
	v_fma_f32 v131, v131, v114, v114
	buffer_load_dwordx4 v23, s[24:27], s1 offen offset:1056 lds
	s_waitcnt vmcnt(23)
	ds_read_b64_tr_b16 a[248:249], v11 offset:44352
	v_mfma_f32_32x32x16_bf16 v[56:71], a[88:91], v[100:103], v[56:71]
	ds_read_b128 v[96:99], v5 offset:62464
	v_rcp_f32 v128, v128
	v_rcp_f32 v129, v129
	v_rcp_f32 v130, v130
	v_rcp_f32 v131, v131
	ds_read_b64_tr_b16 a[250:251], v11 offset:45408
	ds_read_b64_tr_b16 a[252:253], v12 offset:44352
	v_mfma_f32_32x32x16_bf16 v[56:71], a[92:95], v[72:75], v[56:71]
	ds_read_b128 v[100:103], v5 offset:63488
	v_mul_f32 v128, v128, v48
	v_mul_f32 v129, v129, v49
	v_mul_f32 v130, v130, v50
	v_mul_f32 v131, v131, v51
	ds_read_b64_tr_b16 a[254:255], v12 offset:45408
	s_waitcnt lgkmcnt(8)
	s_add_u32 m0, s0, 42240
	v_mfma_f32_32x32x16_bf16 v[56:71], a[96:99], v[76:79], v[56:71]
	ds_read_b128 v[72:75], v5 offset:64512
	v_cvt_pk_bf16_f32 v120, v128, v129
	v_cvt_pk_bf16_f32 v121, v130, v131
	v_mul_f32 v132, v52, v52
	s_mov_b32 s1, 311296
	buffer_load_dwordx4 v10, s[24:27], s1 offen lds
	v_mfma_f32_32x32x16_bf16 v[56:71], a[100:103], v[80:83], v[56:71]
	ds_read_b128 v[76:79], v17 offset:1024
	v_mul_f32 v133, v53, v53
	v_mul_f32 v134, v54, v54
	v_mul_f32 v135, v55, v55
	v_fma_f32 v132, v132, v113, v112
	buffer_load_dwordx4 v23, s[24:27], s1 offen offset:1056 lds
	s_waitcnt vmcnt(23)
	ds_read_b64_tr_b16 v[160:161], v11 offset:46464
	v_mfma_f32_32x32x16_bf16 v[56:71], a[104:107], v[84:87], v[56:71]
	v_fma_f32 v133, v133, v113, v112
	v_fma_f32 v134, v134, v113, v112
	v_fma_f32 v135, v135, v113, v112
	v_mul_f32 v132, v132, v52
	ds_read_b64_tr_b16 v[162:163], v11 offset:47520
	ds_read_b64_tr_b16 v[164:165], v12 offset:46464
	ds_read_b64_tr_b16 v[166:167], v12 offset:47520
	s_waitcnt lgkmcnt(10)
	v_mfma_f32_32x32x16_bf16 v[56:71], a[108:111], v[88:91], v[56:71]
	v_mul_f32 v133, v133, v53
	v_mul_f32 v134, v134, v54
	v_mul_f32 v135, v135, v55
	v_exp_f32 v132, v132
	s_waitcnt lgkmcnt(6)
	s_add_u32 m0, s0, 44352
	v_mfma_f32_32x32x16_bf16 v[56:71], a[112:115], v[92:95], v[56:71]
	v_exp_f32 v133, v133
	v_exp_f32 v134, v134
	v_exp_f32 v135, v135
	v_fma_f32 v132, v132, v114, v114
	s_mov_b32 s1, 327680
	buffer_load_dwordx4 v10, s[24:27], s1 offen lds
	buffer_load_dwordx4 v23, s[24:27], s1 offen offset:1056 lds
	v_mfma_f32_32x32x16_bf16 v[56:71], a[116:119], v[96:99], v[56:71]
	v_fma_f32 v133, v133, v114, v114
	v_fma_f32 v134, v134, v114, v114
	v_fma_f32 v135, v135, v114, v114
	v_rcp_f32 v132, v132
	s_waitcnt vmcnt(6)
	ds_read_b64_tr_b16 v[168:169], v11 offset:48576
	ds_read_b64_tr_b16 v[170:171], v11 offset:49632
	s_waitcnt lgkmcnt(6)
	v_mfma_f32_32x32x16_bf16 v[56:71], a[120:123], v[100:103], v[56:71]
	s_barrier
	ds_read_b128 v[80:83], v16 offset:0
	ds_read_b128 v[84:87], v16 offset:1024
	ds_read_b128 v[88:91], v16 offset:2048
	ds_read_b128 v[92:95], v16 offset:3072
	ds_read_b128 v[96:99], v16 offset:4096
	v_rcp_f32 v133, v133
	v_rcp_f32 v134, v134
	v_rcp_f32 v135, v135
	v_mul_f32 v132, v132, v52
	ds_read_b64_tr_b16 v[172:173], v12 offset:48576
	ds_read_b64_tr_b16 v[174:175], v12 offset:49632
	v_mfma_f32_32x32x16_bf16 v[56:71], a[124:127], v[72:75], v[56:71]
	ds_read_b128 v[100:103], v16 offset:5120
	v_mul_f32 v133, v133, v53
	v_mul_f32 v134, v134, v54
	v_mul_f32 v135, v135, v55
	v_cvt_pk_bf16_f32 v122, v132, v133
	s_waitcnt lgkmcnt(10)
	s_add_u32 m0, s0, 46464
	s_mov_b32 s1, 344064
	v_mfma_f32_32x32x16_bf16 v[56:71], v[124:127], v[76:79], v[56:71]
	ds_read_b128 v[72:75], v16 offset:6144
	v_cvt_pk_bf16_f32 v123, v134, v135
	s_mov_b32 s54, 0
	buffer_store_dwordx4 v[120:123], v19, s[44:47], s54 offen offset:1024 sc1
	ds_read_b128 v[112:115], v18 offset:512
	buffer_load_dwordx4 v10, s[24:27], s1 offen lds
	buffer_load_dwordx4 v23, s[24:27], s1 offen offset:1056 lds
	s_waitcnt lgkmcnt(7)
	v_mfma_f32_32x32x16_bf16 v[40:55], a[0:3], v[80:83], 0
	ds_read_b128 v[76:79], v16 offset:7168
	s_waitcnt vmcnt(7)
	ds_read_b64_tr_b16 v[176:177], v11 offset:50688
	v_mfma_f32_32x32x16_bf16 v[40:55], a[4:7], v[84:87], v[40:55]
	ds_read_b128 v[80:83], v16 offset:8192
	v_mul_f32 v128, v56, v56
	v_mul_f32 v129, v57, v57
	v_mul_f32 v130, v58, v58
	v_mul_f32 v131, v59, v59
	ds_read_b64_tr_b16 v[178:179], v11 offset:51744
	ds_read_b64_tr_b16 v[180:181], v12 offset:50688
	v_mfma_f32_32x32x16_bf16 v[40:55], a[8:11], v[88:91], v[40:55]
	ds_read_b128 v[84:87], v16 offset:9216
	s_waitcnt lgkmcnt(6)
	v_fma_f32 v128, v128, v113, v112
	v_fma_f32 v129, v129, v113, v112
	v_fma_f32 v130, v130, v113, v112
	v_fma_f32 v131, v131, v113, v112
	ds_read_b64_tr_b16 v[182:183], v12 offset:51744
	v_mfma_f32_32x32x16_bf16 v[40:55], a[12:15], v[92:95], v[40:55]
	ds_read_b128 v[88:91], v16 offset:10240
	v_mul_f32 v128, v128, v56
	v_mul_f32 v129, v129, v57
	v_mul_f32 v130, v130, v58
	v_mul_f32 v131, v131, v59
	s_add_u32 m0, s0, 48576
	v_mfma_f32_32x32x16_bf16 v[40:55], a[16:19], v[96:99], v[40:55]
	ds_read_b128 v[92:95], v16 offset:11264
	v_exp_f32 v128, v128
	v_exp_f32 v129, v129
	v_exp_f32 v130, v130
	v_exp_f32 v131, v131
	s_mov_b32 s1, 360448
	v_mfma_f32_32x32x16_bf16 v[40:55], a[20:23], v[100:103], v[40:55]
	ds_read_b128 v[96:99], v16 offset:12288
	v_fma_f32 v128, v128, v114, v114
	v_fma_f32 v129, v129, v114, v114
	v_fma_f32 v130, v130, v114, v114
	v_fma_f32 v131, v131, v114, v114
	buffer_load_dwordx4 v10, s[24:27], s1 offen lds
	buffer_load_dwordx4 v23, s[24:27], s1 offen offset:1056 lds
	s_waitcnt lgkmcnt(7)
	v_mfma_f32_32x32x16_bf16 v[40:55], a[24:27], v[72:75], v[40:55]
	ds_read_b128 v[100:103], v16 offset:13312
	v_rcp_f32 v128, v128
	v_rcp_f32 v129, v129
	v_rcp_f32 v130, v130
	v_rcp_f32 v131, v131
	s_waitcnt vmcnt(7)
	v_mfma_f32_32x32x16_bf16 v[40:55], a[28:31], v[76:79], v[40:55]
	ds_read_b128 v[72:75], v16 offset:14336
	v_mul_f32 v128, v128, v56
	v_mul_f32 v129, v129, v57
	v_mul_f32 v130, v130, v58
	ds_read_b64_tr_b16 v[184:185], v11 offset:42240
	ds_read_b64_tr_b16 v[186:187], v11 offset:43296
	v_mfma_f32_32x32x16_bf16 v[40:55], a[32:35], v[80:83], v[40:55]
	ds_read_b128 v[76:79], v16 offset:15360
	v_mul_f32 v131, v131, v59
	v_cvt_pk_bf16_f32 v116, v128, v129
	v_cvt_pk_bf16_f32 v117, v130, v131
	v_mul_f32 v132, v60, v60
	ds_read_b64_tr_b16 v[188:189], v12 offset:42240
	s_waitcnt lgkmcnt(7)
	v_mfma_f32_32x32x16_bf16 v[40:55], a[36:39], v[84:87], v[40:55]
	ds_read_b128 v[80:83], v16 offset:16384
	v_mul_f32 v133, v61, v61
	v_mul_f32 v134, v62, v62
	v_mul_f32 v135, v63, v63
	v_fma_f32 v132, v132, v113, v112
	ds_read_b64_tr_b16 v[190:191], v12 offset:43296
	v_mfma_f32_32x32x16_bf16 v[40:55], a[40:43], v[88:91], v[40:55]
	ds_read_b128 v[84:87], v16 offset:17408
	v_fma_f32 v133, v133, v113, v112
	v_fma_f32 v134, v134, v113, v112
	v_fma_f32 v135, v135, v113, v112
	v_mul_f32 v132, v132, v60
	s_add_u32 m0, s0, 50688
	v_mfma_f32_32x32x16_bf16 v[40:55], a[44:47], v[92:95], v[40:55]
	ds_read_b128 v[88:91], v16 offset:18432
	v_mul_f32 v133, v133, v61
	v_mul_f32 v134, v134, v62
	v_mul_f32 v135, v135, v63
	v_exp_f32 v132, v132
	s_mov_b32 s1, 376832
	buffer_load_dwordx4 v10, s[24:27], s1 offen lds
	s_waitcnt lgkmcnt(8)
	v_mfma_f32_32x32x16_bf16 v[40:55], a[48:51], v[96:99], v[40:55]
	ds_read_b128 v[92:95], v16 offset:19456
	v_exp_f32 v133, v133
	v_exp_f32 v134, v134
	v_exp_f32 v135, v135
	v_fma_f32 v132, v132, v114, v114
	s_waitcnt vmcnt(5)
	buffer_store_dword v8, v20, s[44:47], 0 offen offset:0 sc1
	buffer_load_dwordx4 v23, s[24:27], s1 offen offset:1056 lds
	v_mfma_f32_32x32x16_bf16 v[40:55], a[52:55], v[100:103], v[40:55]
	ds_read_b128 v[96:99], v16 offset:20480
	v_fma_f32 v133, v133, v114, v114
	v_fma_f32 v134, v134, v114, v114
	v_fma_f32 v135, v135, v114, v114
	ds_read_b64_tr_b16 v[192:193], v11 offset:44352
	v_mfma_f32_32x32x16_bf16 v[40:55], a[56:59], v[72:75], v[40:55]
	ds_read_b128 v[100:103], v16 offset:21504
	v_rcp_f32 v132, v132
	v_rcp_f32 v133, v133
	v_rcp_f32 v134, v134
	v_rcp_f32 v135, v135
	ds_read_b64_tr_b16 v[194:195], v11 offset:45408
	s_waitcnt lgkmcnt(6)
	v_mfma_f32_32x32x16_bf16 v[40:55], a[60:63], v[76:79], v[40:55]
	ds_read_b128 v[72:75], v16 offset:22528
	v_mul_f32 v132, v132, v60
	v_mul_f32 v133, v133, v61
	v_mul_f32 v134, v134, v62
	v_mul_f32 v135, v135, v63
	ds_read_b64_tr_b16 v[196:197], v12 offset:44352
	ds_read_b64_tr_b16 v[198:199], v12 offset:45408
	v_mfma_f32_32x32x16_bf16 v[40:55], a[64:67], v[80:83], v[40:55]
	ds_read_b128 v[76:79], v16 offset:23552
	v_cvt_pk_bf16_f32 v118, v132, v133
	v_cvt_pk_bf16_f32 v119, v134, v135
	s_mov_b32 s54, 229376
	buffer_store_dwordx4 v[116:119], v19, s[44:47], s54 offen offset:0 sc1
	v_mul_f32 v128, v64, v64
	v_mfma_f32_32x32x16_bf16 v[40:55], a[68:71], v[84:87], v[40:55]
	ds_read_b128 v[80:83], v16 offset:24576
	v_mul_f32 v129, v65, v65
	v_mul_f32 v130, v66, v66
	v_mul_f32 v131, v67, v67
	v_fma_f32 v128, v128, v113, v112
	s_add_u32 m0, s0, 42240
	s_mov_b32 s1, 393216
	s_waitcnt lgkmcnt(8)
	v_mfma_f32_32x32x16_bf16 v[40:55], a[72:75], v[88:91], v[40:55]
	ds_read_b128 v[84:87], v16 offset:25600
	v_fma_f32 v129, v129, v113, v112
	v_fma_f32 v130, v130, v113, v112
	v_fma_f32 v131, v131, v113, v112
	v_mul_f32 v128, v128, v64
	buffer_load_dwordx4 v10, s[24:27], s1 offen lds
	v_mfma_f32_32x32x16_bf16 v[40:55], a[76:79], v[92:95], v[40:55]
	ds_read_b128 v[88:91], v16 offset:26624
	v_mul_f32 v129, v129, v65
	v_mul_f32 v130, v130, v66
	v_mul_f32 v131, v131, v67
	v_exp_f32 v128, v128
	buffer_load_dwordx4 v23, s[24:27], s1 offen offset:1056 lds
	s_waitcnt vmcnt(8)
	v_mfma_f32_32x32x16_bf16 v[40:55], a[80:83], v[96:99], v[40:55]
	ds_read_b128 v[92:95], v16 offset:27648
	v_exp_f32 v129, v129
	v_exp_f32 v130, v130
	v_exp_f32 v131, v131
	ds_read_b64_tr_b16 v[200:201], v11 offset:46464
	s_waitcnt lgkmcnt(5)
	v_mfma_f32_32x32x16_bf16 v[40:55], a[84:87], v[100:103], v[40:55]
	ds_read_b128 v[96:99], v16 offset:28672
	v_fma_f32 v128, v128, v114, v114
	v_fma_f32 v129, v129, v114, v114
	v_fma_f32 v130, v130, v114, v114
	v_fma_f32 v131, v131, v114, v114
	ds_read_b64_tr_b16 v[202:203], v11 offset:47520
	ds_read_b64_tr_b16 v[204:205], v12 offset:46464
	v_mfma_f32_32x32x16_bf16 v[40:55], a[88:91], v[72:75], v[40:55]
	ds_read_b128 v[100:103], v16 offset:29696
	v_rcp_f32 v128, v128
	v_rcp_f32 v129, v129
	v_rcp_f32 v130, v130
	v_rcp_f32 v131, v131
	ds_read_b64_tr_b16 v[206:207], v12 offset:47520
	v_mfma_f32_32x32x16_bf16 v[40:55], a[92:95], v[76:79], v[40:55]
	ds_read_b128 v[72:75], v16 offset:30720
	v_mul_f32 v128, v128, v64
	v_mul_f32 v129, v129, v65
	v_mul_f32 v130, v130, v66
	v_mul_f32 v131, v131, v67
	s_add_u32 m0, s0, 44352
	s_waitcnt lgkmcnt(8)
	v_mfma_f32_32x32x16_bf16 v[40:55], a[96:99], v[80:83], v[40:55]
	ds_read_b128 v[76:79], v16 offset:31744
	v_cvt_pk_bf16_f32 v120, v128, v129
	v_cvt_pk_bf16_f32 v121, v130, v131
	v_mul_f32 v132, v68, v68
	v_mul_f32 v133, v69, v69
	s_mov_b32 s1, 409600
	v_mfma_f32_32x32x16_bf16 v[40:55], a[100:103], v[84:87], v[40:55]
	ds_read_b128 v[80:83], v17 offset:2048
	v_mul_f32 v134, v70, v70
	v_mul_f32 v135, v71, v71
	v_fma_f32 v132, v132, v113, v112
	v_fma_f32 v133, v133, v113, v112
	buffer_load_dwordx4 v10, s[24:27], s1 offen lds
	buffer_load_dwordx4 v23, s[24:27], s1 offen offset:1056 lds
	v_mfma_f32_32x32x16_bf16 v[40:55], a[104:107], v[88:91], v[40:55]
	v_fma_f32 v134, v134, v113, v112
	v_fma_f32 v135, v135, v113, v112
	v_mul_f32 v132, v132, v68
	s_waitcnt vmcnt(8)
	s_waitcnt lgkmcnt(4)
	v_mfma_f32_32x32x16_bf16 v[40:55], a[108:111], v[92:95], v[40:55]
	v_mul_f32 v133, v133, v69
	v_mul_f32 v134, v134, v70
	v_mul_f32 v135, v135, v71
	v_exp_f32 v132, v132
	ds_read_b64_tr_b16 v[208:209], v11 offset:48576
	ds_read_b64_tr_b16 v[210:211], v11 offset:49632
	v_mfma_f32_32x32x16_bf16 v[40:55], a[112:115], v[96:99], v[40:55]
	v_exp_f32 v133, v133
	v_exp_f32 v134, v134
	v_exp_f32 v135, v135
	v_fma_f32 v132, v132, v114, v114
	ds_read_b64_tr_b16 v[212:213], v12 offset:48576
	v_mfma_f32_32x32x16_bf16 v[40:55], a[116:119], v[100:103], v[40:55]
	v_fma_f32 v133, v133, v114, v114
	v_fma_f32 v134, v134, v114, v114
	v_fma_f32 v135, v135, v114, v114
	v_rcp_f32 v132, v132
	ds_read_b64_tr_b16 v[214:215], v12 offset:49632
	s_waitcnt lgkmcnt(7)
	s_waitcnt lgkmcnt(4)
	v_mfma_f32_32x32x16_bf16 v[40:55], a[120:123], v[72:75], v[40:55]
	s_barrier
	ds_read_b128 v[84:87], v5 offset:0
	ds_read_b128 v[88:91], v5 offset:1024
	ds_read_b128 v[92:95], v5 offset:2048
	ds_read_b128 v[96:99], v5 offset:3072
	ds_read_b128 v[100:103], v5 offset:4096
	v_rcp_f32 v133, v133
	v_rcp_f32 v134, v134
	v_rcp_f32 v135, v135
	v_mul_f32 v132, v132, v68
	s_add_u32 m0, s0, 46464
	v_mfma_f32_32x32x16_bf16 v[40:55], a[124:127], v[76:79], v[40:55]
	ds_read_b128 v[72:75], v5 offset:5120
	v_mul_f32 v133, v133, v69
	v_mul_f32 v134, v134, v70
	v_mul_f32 v135, v135, v71
	v_cvt_pk_bf16_f32 v122, v132, v133
	s_mov_b32 s1, 425984
	buffer_load_dwordx4 v10, s[24:27], s1 offen lds
	v_mfma_f32_32x32x16_bf16 v[40:55], v[124:127], v[80:83], v[40:55]
	ds_read_b128 v[76:79], v5 offset:6144
	v_cvt_pk_bf16_f32 v123, v134, v135
	s_mov_b32 s54, 229376
	buffer_store_dwordx4 v[120:123], v19, s[44:47], s54 offen offset:1024 sc1
	ds_read_b128 v[112:115], v18 offset:1024
	buffer_load_dwordx4 v23, s[24:27], s1 offen offset:1056 lds
	s_waitcnt lgkmcnt(5)
	v_mfma_f32_32x32x16_bf16 v[56:71], a[0:3], v[84:87], 0
	ds_read_b128 v[80:83], v5 offset:7168
	s_waitcnt vmcnt(8)
	ds_read_b64_tr_b16 v[216:217], v11 offset:50688
	v_mfma_f32_32x32x16_bf16 v[56:71], a[4:7], v[88:91], v[56:71]
	ds_read_b128 v[84:87], v5 offset:8192
	v_mul_f32 v128, v40, v40
	v_mul_f32 v129, v41, v41
	v_mul_f32 v130, v42, v42
	v_mul_f32 v131, v43, v43
	ds_read_b64_tr_b16 v[218:219], v11 offset:51744
	v_mfma_f32_32x32x16_bf16 v[56:71], a[8:11], v[92:95], v[56:71]
	ds_read_b128 v[88:91], v5 offset:9216
	s_waitcnt lgkmcnt(5)
	v_fma_f32 v128, v128, v113, v112
	v_fma_f32 v129, v129, v113, v112
	v_fma_f32 v130, v130, v113, v112
	v_fma_f32 v131, v131, v113, v112
	ds_read_b64_tr_b16 v[220:221], v12 offset:50688
	v_mfma_f32_32x32x16_bf16 v[56:71], a[12:15], v[96:99], v[56:71]
	ds_read_b128 v[92:95], v5 offset:10240
	v_mul_f32 v128, v128, v40
	v_mul_f32 v129, v129, v41
	v_mul_f32 v130, v130, v42
	v_mul_f32 v131, v131, v43
	ds_read_b64_tr_b16 v[222:223], v12 offset:51744
	v_mfma_f32_32x32x16_bf16 v[56:71], a[16:19], v[100:103], v[56:71]
	ds_read_b128 v[96:99], v5 offset:11264
	v_exp_f32 v128, v128
	v_exp_f32 v129, v129
	v_exp_f32 v130, v130
	v_exp_f32 v131, v131
	s_add_u32 m0, s0, 48576
	v_mfma_f32_32x32x16_bf16 v[56:71], a[20:23], v[72:75], v[56:71]
	ds_read_b128 v[100:103], v5 offset:12288
	v_fma_f32 v128, v128, v114, v114
	v_fma_f32 v129, v129, v114, v114
	v_fma_f32 v130, v130, v114, v114
	v_fma_f32 v131, v131, v114, v114
	s_mov_b32 s1, 442368
	s_waitcnt lgkmcnt(7)
	v_mfma_f32_32x32x16_bf16 v[56:71], a[24:27], v[76:79], v[56:71]
	ds_read_b128 v[72:75], v5 offset:13312
	v_rcp_f32 v128, v128
	v_rcp_f32 v129, v129
	v_rcp_f32 v130, v130
	v_rcp_f32 v131, v131
	buffer_load_dwordx4 v10, s[24:27], s1 offen lds
	v_mfma_f32_32x32x16_bf16 v[56:71], a[28:31], v[80:83], v[56:71]
	ds_read_b128 v[76:79], v5 offset:14336
	v_mul_f32 v128, v128, v40
	v_mul_f32 v129, v129, v41
	v_mul_f32 v130, v130, v42
	buffer_load_dwordx4 v23, s[24:27], s1 offen offset:1056 lds
	v_mfma_f32_32x32x16_bf16 v[56:71], a[32:35], v[84:87], v[56:71]
	ds_read_b128 v[80:83], v5 offset:15360
	v_mul_f32 v131, v131, v43
	v_cvt_pk_bf16_f32 v116, v128, v129
	v_cvt_pk_bf16_f32 v117, v130, v131
	v_mul_f32 v132, v44, v44
	s_waitcnt vmcnt(7)
	ds_read_b64_tr_b16 v[224:225], v11 offset:42240
	s_waitcnt lgkmcnt(5)
	v_mfma_f32_32x32x16_bf16 v[56:71], a[36:39], v[88:91], v[56:71]
	ds_read_b128 v[84:87], v5 offset:16384
	v_mul_f32 v133, v45, v45
	v_mul_f32 v134, v46, v46
	v_mul_f32 v135, v47, v47
	v_fma_f32 v132, v132, v113, v112
	ds_read_b64_tr_b16 v[226:227], v11 offset:43296
	v_mfma_f32_32x32x16_bf16 v[56:71], a[40:43], v[92:95], v[56:71]
	ds_read_b128 v[88:91], v5 offset:17408
	v_fma_f32 v133, v133, v113, v112
	v_fma_f32 v134, v134, v113, v112
	v_fma_f32 v135, v135, v113, v112
	v_mul_f32 v132, v132, v44
	ds_read_b64_tr_b16 v[228:229], v12 offset:42240
	v_mfma_f32_32x32x16_bf16 v[56:71], a[44:47], v[96:99], v[56:71]
	ds_read_b128 v[92:95], v5 offset:18432
	v_mul_f32 v133, v133, v45
	v_mul_f32 v134, v134, v46
	v_mul_f32 v135, v135, v47
	v_exp_f32 v132, v132
	ds_read_b64_tr_b16 v[230:231], v12 offset:43296
	s_waitcnt lgkmcnt(8)
	v_mfma_f32_32x32x16_bf16 v[56:71], a[48:51], v[100:103], v[56:71]
	ds_read_b128 v[96:99], v5 offset:19456
	v_exp_f32 v133, v133
	v_exp_f32 v134, v134
	v_exp_f32 v135, v135
	v_fma_f32 v132, v132, v114, v114
	s_waitcnt vmcnt(5)
	ds_read_b64_tr_b16 v[232:233], v11 offset:44352
	v_mfma_f32_32x32x16_bf16 v[56:71], a[52:55], v[72:75], v[56:71]
	ds_read_b128 v[100:103], v5 offset:20480
	v_fma_f32 v133, v133, v114, v114
	v_fma_f32 v134, v134, v114, v114
	v_fma_f32 v135, v135, v114, v114
	ds_read_b64_tr_b16 v[234:235], v11 offset:45408
	v_mfma_f32_32x32x16_bf16 v[56:71], a[56:59], v[76:79], v[56:71]
	ds_read_b128 v[72:75], v5 offset:21504
	v_rcp_f32 v132, v132
	v_rcp_f32 v133, v133
	v_rcp_f32 v134, v134
	v_rcp_f32 v135, v135
	s_waitcnt vmcnt(3)
	buffer_store_dword v8, v20, s[44:47], 0 offen offset:512 sc1
	ds_read_b64_tr_b16 v[236:237], v12 offset:44352
	s_waitcnt lgkmcnt(9)
	v_mfma_f32_32x32x16_bf16 v[56:71], a[60:63], v[80:83], v[56:71]
	ds_read_b128 v[76:79], v5 offset:22528
	v_mul_f32 v132, v132, v44
	v_mul_f32 v133, v133, v45
	v_mul_f32 v134, v134, v46
	v_mul_f32 v135, v135, v47
	ds_read_b64_tr_b16 v[238:239], v12 offset:45408
	v_mfma_f32_32x32x16_bf16 v[56:71], a[64:67], v[84:87], v[56:71]
	ds_read_b128 v[80:83], v5 offset:23552
	v_cvt_pk_bf16_f32 v118, v132, v133
	v_cvt_pk_bf16_f32 v119, v134, v135
	s_mov_b32 s54, 114688
	buffer_store_dwordx4 v[116:119], v19, s[44:47], s54 offen offset:0 sc1
	v_mul_f32 v128, v48, v48
	s_waitcnt vmcnt(4)
	ds_read_b64_tr_b16 v[240:241], v11 offset:46464
	v_mfma_f32_32x32x16_bf16 v[56:71], a[68:71], v[88:91], v[56:71]
	ds_read_b128 v[84:87], v5 offset:24576
	v_mul_f32 v129, v49, v49
	v_mul_f32 v130, v50, v50
	v_mul_f32 v131, v51, v51
	v_fma_f32 v128, v128, v113, v112
	ds_read_b64_tr_b16 v[242:243], v11 offset:47520
	s_waitcnt lgkmcnt(9)
	v_mfma_f32_32x32x16_bf16 v[56:71], a[72:75], v[92:95], v[56:71]
	ds_read_b128 v[88:91], v5 offset:25600
	v_fma_f32 v129, v129, v113, v112
	v_fma_f32 v130, v130, v113, v112
	v_fma_f32 v131, v131, v113, v112
	v_mul_f32 v128, v128, v48
	ds_read_b64_tr_b16 v[244:245], v12 offset:46464
	v_mfma_f32_32x32x16_bf16 v[56:71], a[76:79], v[96:99], v[56:71]
	ds_read_b128 v[92:95], v5 offset:26624
	v_mul_f32 v129, v129, v49
	v_mul_f32 v130, v130, v50
	v_mul_f32 v131, v131, v51
	v_exp_f32 v128, v128
	ds_read_b64_tr_b16 v[246:247], v12 offset:47520
	v_mfma_f32_32x32x16_bf16 v[56:71], a[80:83], v[100:103], v[56:71]
	ds_read_b128 v[96:99], v5 offset:27648
	v_exp_f32 v129, v129
	v_exp_f32 v130, v130
	v_exp_f32 v131, v131
	s_waitcnt vmcnt(2)
	ds_read_b64_tr_b16 v[248:249], v11 offset:48576
	s_waitcnt lgkmcnt(9)
	v_mfma_f32_32x32x16_bf16 v[56:71], a[84:87], v[72:75], v[56:71]
	ds_read_b128 v[100:103], v5 offset:28672
	v_fma_f32 v128, v128, v114, v114
	v_fma_f32 v129, v129, v114, v114
	v_fma_f32 v130, v130, v114, v114
	v_fma_f32 v131, v131, v114, v114
	ds_read_b64_tr_b16 v[250:251], v11 offset:49632
	v_mfma_f32_32x32x16_bf16 v[56:71], a[88:91], v[76:79], v[56:71]
	ds_read_b128 v[72:75], v5 offset:29696
	v_rcp_f32 v128, v128
	v_rcp_f32 v129, v129
	v_rcp_f32 v130, v130
	v_rcp_f32 v131, v131
	ds_read_b64_tr_b16 v[252:253], v12 offset:48576
	v_mfma_f32_32x32x16_bf16 v[56:71], a[92:95], v[80:83], v[56:71]
	ds_read_b128 v[76:79], v5 offset:30720
	v_mul_f32 v128, v128, v48
	v_mul_f32 v129, v129, v49
	v_mul_f32 v130, v130, v50
	v_mul_f32 v131, v131, v51
	ds_read_b64_tr_b16 v[254:255], v12 offset:49632
	s_waitcnt lgkmcnt(9)
	v_mfma_f32_32x32x16_bf16 v[56:71], a[96:99], v[84:87], v[56:71]
	ds_read_b128 v[80:83], v5 offset:31744
	v_cvt_pk_bf16_f32 v120, v128, v129
	v_cvt_pk_bf16_f32 v121, v130, v131
	v_mul_f32 v132, v52, v52
	v_mul_f32 v133, v53, v53
	buffer_load_dword v4, v7, s[44:47], 0 offen sc1
	v_mfma_f32_32x32x16_bf16 v[56:71], a[100:103], v[88:91], v[56:71]
	ds_read_b128 v[84:87], v17 offset:3072
	v_mul_f32 v134, v54, v54
	v_mul_f32 v135, v55, v55
	v_fma_f32 v132, v132, v113, v112
	v_fma_f32 v133, v133, v113, v112
	v_mfma_f32_32x32x16_bf16 v[56:71], a[104:107], v[92:95], v[56:71]
	v_fma_f32 v134, v134, v113, v112
	v_fma_f32 v135, v135, v113, v112
	v_mul_f32 v132, v132, v52
	s_waitcnt lgkmcnt(5)
	v_mfma_f32_32x32x16_bf16 v[56:71], a[108:111], v[96:99], v[56:71]
	v_mul_f32 v133, v133, v53
	v_mul_f32 v134, v134, v54
	v_mul_f32 v135, v135, v55
	v_exp_f32 v132, v132
	v_mfma_f32_32x32x16_bf16 v[56:71], a[112:115], v[100:103], v[56:71]
	v_exp_f32 v133, v133
	v_exp_f32 v134, v134
	v_exp_f32 v135, v135
	v_fma_f32 v132, v132, v114, v114
	v_mfma_f32_32x32x16_bf16 v[56:71], a[116:119], v[72:75], v[56:71]
	v_fma_f32 v133, v133, v114, v114
	v_fma_f32 v134, v134, v114, v114
	v_fma_f32 v135, v135, v114, v114
	v_rcp_f32 v132, v132
	s_waitcnt lgkmcnt(0)
	v_mfma_f32_32x32x16_bf16 v[56:71], a[120:123], v[76:79], v[56:71]
	v_rcp_f32 v133, v133
	v_rcp_f32 v134, v134
	v_rcp_f32 v135, v135
	v_mul_f32 v132, v132, v52
	v_mfma_f32_32x32x16_bf16 v[56:71], a[124:127], v[80:83], v[56:71]
	v_mul_f32 v133, v133, v53
	v_mul_f32 v134, v134, v54
	v_mul_f32 v135, v135, v55
	v_cvt_pk_bf16_f32 v122, v132, v133
	v_mfma_f32_32x32x16_bf16 v[56:71], v[124:127], v[84:87], v[56:71]
	v_cvt_pk_bf16_f32 v123, v134, v135
	s_mov_b32 s54, 114688
	buffer_store_dwordx4 v[120:123], v19, s[44:47], s54 offen offset:1024 sc1
	ds_read_b128 v[112:115], v18 offset:1536
	s_mul_i32 s57, s50, 229376
	s_mul_i32 s55, s52, 28672
	s_add_u32 s57, s57, s55
	s_add_u32 s57, s57, 8388608
	s_waitcnt vmcnt(1)
	v_cmp_ne_u32 vcc, s53, v4
	s_cbranch_vccz ok_36
	s_mov_b32 s58, 200000
poll_37:
	buffer_load_dword v4, v7, s[44:47], 0 offen sc1
	s_waitcnt vmcnt(0)
	v_cmp_ne_u32 vcc, s53, v4
	s_cbranch_vccz pdone_38
	s_sub_u32 s58, s58, 1
	s_cbranch_scc0 poll_37
pdone_38:
ok_36:
P4S:
	s_nop 0
	v_mul_f32 v72, v56, v56
	s_add_u32 s56, s57, 0
	buffer_load_dwordx4 a[0:3], v5, s[44:47], s56 offen offset:0 sc1
	v_mul_f32 v73, v57, v57
	v_mul_f32 v74, v58, v58
	v_mul_f32 v75, v59, v59
	s_waitcnt lgkmcnt(0)
	v_fma_f32 v72, v72, v113, v112
	v_fma_f32 v73, v73, v113, v112
	v_fma_f32 v74, v74, v113, v112
	v_fma_f32 v75, v75, v113, v112
	v_mul_f32 v72, v72, v56
	v_mul_f32 v73, v73, v57
	v_mul_f32 v74, v74, v58
	v_mul_f32 v75, v75, v59
	buffer_load_dwordx4 a[4:7], v5, s[44:47], s56 offen offset:1024 sc1
	v_exp_f32 v72, v72
	v_exp_f32 v73, v73
	v_exp_f32 v74, v74
	v_exp_f32 v75, v75
	v_fma_f32 v72, v72, v114, v114
	v_fma_f32 v73, v73, v114, v114
	v_fma_f32 v74, v74, v114, v114
	v_fma_f32 v75, v75, v114, v114
	v_rcp_f32 v72, v72
	v_rcp_f32 v73, v73
	v_rcp_f32 v74, v74
	buffer_load_dwordx4 a[8:11], v5, s[44:47], s56 offen offset:2048 sc1
	v_rcp_f32 v75, v75
	v_mul_f32 v72, v72, v56
	v_mul_f32 v73, v73, v57
	v_mul_f32 v74, v74, v58
	v_mul_f32 v75, v75, v59
	v_cvt_pk_bf16_f32 v116, v72, v73
	v_cvt_pk_bf16_f32 v117, v74, v75
	v_mul_f32 v76, v60, v60
	v_mul_f32 v77, v61, v61
	v_mul_f32 v78, v62, v62
	v_mul_f32 v79, v63, v63
	buffer_load_dwordx4 a[12:15], v5, s[44:47], s56 offen offset:3072 sc1
	v_fma_f32 v76, v76, v113, v112
	v_fma_f32 v77, v77, v113, v112
	v_fma_f32 v78, v78, v113, v112
	v_fma_f32 v79, v79, v113, v112
	v_mul_f32 v76, v76, v60
	v_mul_f32 v77, v77, v61
	v_mul_f32 v78, v78, v62
	s_waitcnt vmcnt(4)
	buffer_store_dword v8, v20, s[44:47], 0 offen offset:256 sc1
	v_mul_f32 v79, v79, v63
	v_exp_f32 v76, v76
	v_exp_f32 v77, v77
	v_exp_f32 v78, v78
	s_add_u32 s56, s57, 4096
	buffer_load_dwordx4 a[16:19], v5, s[44:47], s56 offen offset:0 sc1
	v_exp_f32 v79, v79
	v_fma_f32 v76, v76, v114, v114
	v_fma_f32 v77, v77, v114, v114
	v_fma_f32 v78, v78, v114, v114
	v_fma_f32 v79, v79, v114, v114
	v_rcp_f32 v76, v76
	v_rcp_f32 v77, v77
	v_rcp_f32 v78, v78
	v_rcp_f32 v79, v79
	v_mul_f32 v76, v76, v60
	v_mul_f32 v77, v77, v61
	buffer_load_dwordx4 a[20:23], v5, s[44:47], s56 offen offset:1024 sc1
	v_mul_f32 v78, v78, v62
	v_mul_f32 v79, v79, v63
	v_cvt_pk_bf16_f32 v118, v76, v77
	v_cvt_pk_bf16_f32 v119, v78, v79
	s_mov_b32 s54, 344064
	buffer_store_dwordx4 v[116:119], v19, s[44:47], s54 offen offset:0 sc1
	v_mul_f32 v72, v64, v64
	v_mul_f32 v73, v65, v65
	v_mul_f32 v74, v66, v66
	v_mul_f32 v75, v67, v67
	v_fma_f32 v72, v72, v113, v112
	v_fma_f32 v73, v73, v113, v112
	buffer_load_dwordx4 a[24:27], v5, s[44:47], s56 offen offset:2048 sc1
	v_fma_f32 v74, v74, v113, v112
	v_fma_f32 v75, v75, v113, v112
	v_mul_f32 v72, v72, v64
	v_mul_f32 v73, v73, v65
	v_mul_f32 v74, v74, v66
	v_mul_f32 v75, v75, v67
	v_exp_f32 v72, v72
	v_exp_f32 v73, v73
	v_exp_f32 v74, v74
	v_exp_f32 v75, v75
	v_fma_f32 v72, v72, v114, v114
	buffer_load_dwordx4 a[28:31], v5, s[44:47], s56 offen offset:3072 sc1
	v_fma_f32 v73, v73, v114, v114
	v_fma_f32 v74, v74, v114, v114
	v_fma_f32 v75, v75, v114, v114
	v_rcp_f32 v72, v72
	v_rcp_f32 v73, v73
	v_rcp_f32 v74, v74
	v_rcp_f32 v75, v75
	v_mul_f32 v72, v72, v64
	v_mul_f32 v73, v73, v65
	v_mul_f32 v74, v74, v66
	v_mul_f32 v75, v75, v67
	s_add_u32 s56, s57, 8192
	buffer_load_dwordx4 a[32:35], v5, s[44:47], s56 offen offset:0 sc1
	v_cvt_pk_bf16_f32 v120, v72, v73
	v_cvt_pk_bf16_f32 v121, v74, v75
	v_mul_f32 v76, v68, v68
	v_mul_f32 v77, v69, v69
	v_mul_f32 v78, v70, v70
	v_mul_f32 v79, v71, v71
	v_fma_f32 v76, v76, v113, v112
	v_fma_f32 v77, v77, v113, v112
	v_fma_f32 v78, v78, v113, v112
	v_fma_f32 v79, v79, v113, v112
	v_mul_f32 v76, v76, v68
	buffer_load_dwordx4 a[36:39], v5, s[44:47], s56 offen offset:1024 sc1
	v_mul_f32 v77, v77, v69
	v_mul_f32 v78, v78, v70
	v_mul_f32 v79, v79, v71
	v_exp_f32 v76, v76
	v_exp_f32 v77, v77
	v_exp_f32 v78, v78
	v_exp_f32 v79, v79
	v_fma_f32 v76, v76, v114, v114
	v_fma_f32 v77, v77, v114, v114
	v_fma_f32 v78, v78, v114, v114
	v_fma_f32 v79, v79, v114, v114
	buffer_load_dwordx4 a[40:43], v5, s[44:47], s56 offen offset:2048 sc1
	v_rcp_f32 v76, v76
	v_rcp_f32 v77, v77
	v_rcp_f32 v78, v78
	v_rcp_f32 v79, v79
	v_mul_f32 v76, v76, v68
	v_mul_f32 v77, v77, v69
	v_mul_f32 v78, v78, v70
	v_mul_f32 v79, v79, v71
	v_cvt_pk_bf16_f32 v122, v76, v77
	v_cvt_pk_bf16_f32 v123, v78, v79
	s_mov_b32 s54, 344064
	buffer_store_dwordx4 v[120:123], v19, s[44:47], s54 offen offset:1024 sc1
	s_waitcnt vmcnt(13)
	v_mfma_f32_32x32x16_bf16 v[128:143], a[128:131], a[0:3], 0
	buffer_load_dwordx4 a[44:47], v5, s[44:47], s56 offen offset:3072 sc1
	v_mfma_f32_32x32x16_bf16 v[144:159], a[132:135], a[0:3], 0
	s_waitcnt vmcnt(13)
	v_mfma_f32_32x32x16_bf16 v[128:143], a[136:139], a[4:7], v[128:143]
	s_add_u32 s56, s57, 12288
	v_mfma_f32_32x32x16_bf16 v[144:159], a[140:143], a[4:7], v[144:159]
	buffer_load_dwordx4 a[48:51], v5, s[44:47], s56 offen offset:0 sc1
	s_waitcnt vmcnt(13)
	v_mfma_f32_32x32x16_bf16 v[128:143], a[144:147], a[8:11], v[128:143]
	buffer_load_dwordx4 a[52:55], v5, s[44:47], s56 offen offset:1024 sc1
	v_mfma_f32_32x32x16_bf16 v[144:159], a[148:151], a[8:11], v[144:159]
	s_waitcnt vmcnt(13)
	v_mfma_f32_32x32x16_bf16 v[128:143], a[152:155], a[12:15], v[128:143]
	buffer_load_dwordx4 a[56:59], v5, s[44:47], s56 offen offset:2048 sc1
	v_mfma_f32_32x32x16_bf16 v[144:159], a[156:159], a[12:15], v[144:159]
	s_waitcnt vmcnt(12)
	v_mfma_f32_32x32x16_bf16 v[128:143], a[160:163], a[16:19], v[128:143]
	buffer_load_dwordx4 a[60:63], v5, s[44:47], s56 offen offset:3072 sc1
	v_mfma_f32_32x32x16_bf16 v[144:159], a[164:167], a[16:19], v[144:159]
	s_waitcnt vmcnt(12)
	v_mfma_f32_32x32x16_bf16 v[128:143], a[168:171], a[20:23], v[128:143]
	s_add_u32 s56, s57, 16384
	v_mfma_f32_32x32x16_bf16 v[144:159], a[172:175], a[20:23], v[144:159]
	buffer_load_dwordx4 a[64:67], v5, s[44:47], s56 offen offset:0 sc1
	s_waitcnt vmcnt(11)
	v_mfma_f32_32x32x16_bf16 v[128:143], a[176:179], a[24:27], v[128:143]
	buffer_load_dwordx4 a[68:71], v5, s[44:47], s56 offen offset:1024 sc1
	v_mfma_f32_32x32x16_bf16 v[144:159], a[180:183], a[24:27], v[144:159]
	s_waitcnt vmcnt(7)
	buffer_store_dword v8, v20, s[44:47], 0 offen offset:768 sc1
	v_mfma_f32_32x32x16_bf16 v[128:143], a[184:187], a[28:31], v[128:143]
	buffer_load_dwordx4 a[72:75], v5, s[44:47], s56 offen offset:2048 sc1
	v_mfma_f32_32x32x16_bf16 v[144:159], a[188:191], a[28:31], v[144:159]
	v_mfma_f32_32x32x16_bf16 v[128:143], a[192:195], a[32:35], v[128:143]
	buffer_load_dwordx4 a[76:79], v5, s[44:47], s56 offen offset:3072 sc1
	v_mfma_f32_32x32x16_bf16 v[144:159], a[196:199], a[32:35], v[144:159]
	v_mfma_f32_32x32x16_bf16 v[128:143], a[200:203], a[36:39], v[128:143]
	s_add_u32 s56, s57, 20480
	v_mfma_f32_32x32x16_bf16 v[144:159], a[204:207], a[36:39], v[144:159]
	buffer_load_dwordx4 a[80:83], v5, s[44:47], s56 offen offset:0 sc1
	v_mfma_f32_32x32x16_bf16 v[128:143], a[208:211], a[40:43], v[128:143]
	buffer_load_dwordx4 a[84:87], v5, s[44:47], s56 offen offset:1024 sc1
	v_mfma_f32_32x32x16_bf16 v[144:159], a[212:215], a[40:43], v[144:159]
	buffer_load_dword v4, v7, s[44:47], 0 offen offset:256 sc1
	s_waitcnt vmcnt(12)
	v_mfma_f32_32x32x16_bf16 v[128:143], a[216:219], a[44:47], v[128:143]
	buffer_load_dwordx4 a[88:91], v5, s[44:47], s56 offen offset:2048 sc1
	v_mfma_f32_32x32x16_bf16 v[144:159], a[220:223], a[44:47], v[144:159]
	s_waitcnt vmcnt(12)
	v_mfma_f32_32x32x16_bf16 v[128:143], a[224:227], a[48:51], v[128:143]
	buffer_load_dwordx4 a[92:95], v5, s[44:47], s56 offen offset:3072 sc1
	v_mfma_f32_32x32x16_bf16 v[144:159], a[228:231], a[48:51], v[144:159]
	s_waitcnt vmcnt(12)
	v_mfma_f32_32x32x16_bf16 v[128:143], a[232:235], a[52:55], v[128:143]
	s_add_u32 s56, s57, 24576
	v_mfma_f32_32x32x16_bf16 v[144:159], a[236:239], a[52:55], v[144:159]
	buffer_load_dwordx4 a[96:99], v5, s[44:47], s56 offen offset:0 sc1
	s_waitcnt vmcnt(12)
	v_mfma_f32_32x32x16_bf16 v[128:143], a[240:243], a[56:59], v[128:143]
	buffer_load_dwordx4 a[100:103], v5, s[44:47], s56 offen offset:1024 sc1
	v_mfma_f32_32x32x16_bf16 v[144:159], a[244:247], a[56:59], v[144:159]
	s_waitcnt vmcnt(12)
	v_mfma_f32_32x32x16_bf16 v[128:143], a[248:251], a[60:63], v[128:143]
	buffer_load_dwordx4 a[104:107], v5, s[44:47], s56 offen offset:2048 sc1
	v_mfma_f32_32x32x16_bf16 v[144:159], a[252:255], a[60:63], v[144:159]
	s_waitcnt vmcnt(12)
	v_mfma_f32_32x32x16_bf16 v[128:143], v[160:163], a[64:67], v[128:143]
	buffer_load_dwordx4 a[108:111], v5, s[44:47], s56 offen offset:3072 sc1
	v_mfma_f32_32x32x16_bf16 v[144:159], v[164:167], a[64:67], v[144:159]
	s_waitcnt vmcnt(6)
	v_cmp_ne_u32 vcc, s53, v4
	s_cbranch_vccz ok_39
	s_mov_b32 s58, 200000
poll_40:
	buffer_load_dword v4, v7, s[44:47], 0 offen offset:256 sc1
	s_waitcnt vmcnt(0)
	v_cmp_ne_u32 vcc, s53, v4
	s_cbranch_vccz pdone_41
	s_sub_u32 s58, s58, 1
	s_cbranch_scc0 poll_40
pdone_41:
ok_39:
	v_mfma_f32_32x32x16_bf16 v[128:143], v[168:171], a[68:71], v[128:143]
	s_add_u32 s56, s57, 114688
	v_mfma_f32_32x32x16_bf16 v[144:159], v[172:175], a[68:71], v[144:159]
	buffer_load_dwordx4 a[112:115], v5, s[44:47], s56 offen offset:0 sc1
	v_mfma_f32_32x32x16_bf16 v[128:143], v[176:179], a[72:75], v[128:143]
	buffer_load_dwordx4 a[116:119], v5, s[44:47], s56 offen offset:1024 sc1
	v_mfma_f32_32x32x16_bf16 v[144:159], v[180:183], a[72:75], v[144:159]
	v_mfma_f32_32x32x16_bf16 v[128:143], v[184:187], a[76:79], v[128:143]
	buffer_load_dwordx4 a[120:123], v5, s[44:47], s56 offen offset:2048 sc1
	v_mfma_f32_32x32x16_bf16 v[144:159], v[188:191], a[76:79], v[144:159]
	v_mfma_f32_32x32x16_bf16 v[128:143], v[192:195], a[80:83], v[128:143]
	buffer_load_dwordx4 a[124:127], v5, s[44:47], s56 offen offset:3072 sc1
	v_lshlrev_b32 v96, 16, v104
	v_and_b32 v97, s67, v104
	v_mfma_f32_32x32x16_bf16 v[144:159], v[196:199], a[80:83], v[144:159]
	v_lshlrev_b32 v98, 16, v105
	v_and_b32 v99, s67, v105
	v_lshlrev_b32 v100, 16, v106
	v_mfma_f32_32x32x16_bf16 v[128:143], v[200:203], a[84:87], v[128:143]
	s_add_u32 s56, s57, 118784
	buffer_load_dwordx4 a[0:3], v5, s[44:47], s56 offen offset:0 sc1
	v_and_b32 v101, s67, v106
	v_lshlrev_b32 v102, 16, v107
	v_mfma_f32_32x32x16_bf16 v[144:159], v[204:207], a[84:87], v[144:159]
	v_and_b32 v103, s67, v107
	v_lshlrev_b32 v112, 16, v108
	v_and_b32 v113, s67, v108
	s_waitcnt vmcnt(10)
	v_mfma_f32_32x32x16_bf16 v[128:143], v[208:211], a[88:91], v[128:143]
	buffer_load_dwordx4 a[4:7], v5, s[44:47], s56 offen offset:1024 sc1
	v_lshlrev_b32 v114, 16, v109
	v_and_b32 v115, s67, v109
	v_mfma_f32_32x32x16_bf16 v[144:159], v[212:215], a[88:91], v[144:159]
	v_lshlrev_b32 v116, 16, v110
	v_and_b32 v117, s67, v110
	v_lshlrev_b32 v118, 16, v111
	s_waitcnt vmcnt(10)
	v_mfma_f32_32x32x16_bf16 v[128:143], v[216:219], a[92:95], v[128:143]
	buffer_load_dwordx4 a[8:11], v5, s[44:47], s56 offen offset:2048 sc1
	v_and_b32 v119, s67, v111
	s_xor_b32 s54, s52, 1
	v_mfma_f32_32x32x16_bf16 v[144:159], v[220:223], a[92:95], v[144:159]
	s_mul_i32 s54, s54, 6144
	s_add_u32 s54, s54, 0
	v_add_u32 v16, s54, v5
	s_waitcnt vmcnt(10)
	v_mfma_f32_32x32x16_bf16 v[128:143], v[224:227], a[96:99], v[128:143]
	buffer_load_dwordx4 a[12:15], v5, s[44:47], s56 offen offset:3072 sc1
	s_xor_b32 s54, s52, 2
	s_mul_i32 s54, s54, 6144
	v_mfma_f32_32x32x16_bf16 v[144:159], v[228:231], a[96:99], v[144:159]
	s_add_u32 s54, s54, 2048
	v_add_u32 v17, s54, v5
	s_xor_b32 s54, s52, 3
	s_waitcnt vmcnt(10)
	v_mfma_f32_32x32x16_bf16 v[128:143], v[232:235], a[100:103], v[128:143]
	s_add_u32 s56, s57, 122880
	buffer_load_dwordx4 a[16:19], v5, s[44:47], s56 offen offset:0 sc1
	s_mul_i32 s54, s54, 6144
	s_add_u32 s54, s54, 4096
	v_mfma_f32_32x32x16_bf16 v[144:159], v[236:239], a[100:103], v[144:159]
	v_add_u32 v18, s54, v5
	s_mul_i32 s54, s52, 6144
	v_add_u32 v6, s54, v5
	s_waitcnt vmcnt(10)
	v_mfma_f32_32x32x16_bf16 v[128:143], v[240:243], a[104:107], v[128:143]
	buffer_load_dwordx4 a[20:23], v5, s[44:47], s56 offen offset:1024 sc1
	v_and_b32 v9, 31, v0
	v_lshl_add_u32 v9, v9, 1, s59
	v_mfma_f32_32x32x16_bf16 v[144:159], v[244:247], a[104:107], v[144:159]
	v_lshlrev_b32 v9, 10, v9
	v_lshrrev_b32 v21, 5, v0
	v_lshl_add_u32 v9, v21, 4, v9
	s_waitcnt vmcnt(10)
	v_mfma_f32_32x32x16_bf16 v[128:143], v[248:251], a[108:111], v[128:143]
	buffer_load_dwordx4 a[24:27], v5, s[44:47], s56 offen offset:2048 sc1
	s_lshl_b32 s54, s51, 7
	s_lshl_b32 s55, s52, 5
	v_mfma_f32_32x32x16_bf16 v[144:159], v[252:255], a[108:111], v[144:159]
	s_add_u32 s54, s54, s55
	v_add_u32 v9, s54, v9
	s_waitcnt vmcnt(10)
	v_mfma_f32_32x32x16_bf16 v[40:55], a[128:131], a[112:115], 0
	buffer_load_dwordx4 a[28:31], v5, s[44:47], s56 offen offset:3072 sc1
	v_mfma_f32_32x32x16_bf16 v[56:71], a[132:135], a[112:115], 0
	s_waitcnt vmcnt(10)
	v_mfma_f32_32x32x16_bf16 v[40:55], a[136:139], a[116:119], v[40:55]
	s_add_u32 s56, s57, 126976
	buffer_load_dwordx4 a[32:35], v5, s[44:47], s56 offen offset:0 sc1
	ds_write_b128 v16, v[136:139] offset:32768
	ds_write_b128 v16, v[140:143] offset:33792
	v_mfma_f32_32x32x16_bf16 v[56:71], a[140:143], a[116:119], v[56:71]
	ds_write_b128 v17, v[144:147] offset:32768
	ds_write_b128 v17, v[148:151] offset:33792
	ds_write_b128 v18, v[152:155] offset:32768
	ds_write_b128 v18, v[156:159] offset:33792
	s_waitcnt vmcnt(10)
	v_mfma_f32_32x32x16_bf16 v[40:55], a[144:147], a[120:123], v[40:55]
	buffer_load_dwordx4 a[36:39], v5, s[44:47], s56 offen offset:1024 sc1
	v_mfma_f32_32x32x16_bf16 v[56:71], a[148:151], a[120:123], v[56:71]
	s_waitcnt vmcnt(10)
	v_mfma_f32_32x32x16_bf16 v[40:55], a[152:155], a[124:127], v[40:55]
	buffer_load_dwordx4 a[40:43], v5, s[44:47], s56 offen offset:2048 sc1
	v_mfma_f32_32x32x16_bf16 v[56:71], a[156:159], a[124:127], v[56:71]
	s_waitcnt vmcnt(10)
	v_mfma_f32_32x32x16_bf16 v[40:55], a[160:163], a[0:3], v[40:55]
	buffer_load_dwordx4 a[44:47], v5, s[44:47], s56 offen offset:3072 sc1
	v_mfma_f32_32x32x16_bf16 v[56:71], a[164:167], a[0:3], v[56:71]
	s_waitcnt vmcnt(10)
	v_mfma_f32_32x32x16_bf16 v[40:55], a[168:171], a[4:7], v[40:55]
	s_add_u32 s56, s57, 131072
	buffer_load_dwordx4 a[48:51], v5, s[44:47], s56 offen offset:0 sc1
	s_waitcnt lgkmcnt(0)
	s_barrier
	ds_read_b128 v[72:75], v6 offset:32768
	v_mfma_f32_32x32x16_bf16 v[56:71], a[172:175], a[4:7], v[56:71]
	ds_read_b128 v[76:79], v6 offset:33792
	ds_read_b128 v[80:83], v6 offset:34816
	ds_read_b128 v[84:87], v6 offset:35840
	ds_read_b128 v[88:91], v6 offset:36864
	ds_read_b128 v[92:95], v6 offset:37888
	s_waitcnt vmcnt(10)
	v_mfma_f32_32x32x16_bf16 v[40:55], a[176:179], a[8:11], v[40:55]
	buffer_load_dwordx4 a[52:55], v5, s[44:47], s56 offen offset:1024 sc1
	v_mfma_f32_32x32x16_bf16 v[56:71], a[180:183], a[8:11], v[56:71]
	s_waitcnt vmcnt(10)
	v_mfma_f32_32x32x16_bf16 v[40:55], a[184:187], a[12:15], v[40:55]
	buffer_load_dwordx4 a[56:59], v5, s[44:47], s56 offen offset:2048 sc1
	v_add_f32 v128, v128, v112
	v_add_f32 v129, v129, v113
	v_mfma_f32_32x32x16_bf16 v[56:71], a[188:191], a[12:15], v[56:71]
	v_add_f32 v130, v130, v114
	v_add_f32 v131, v131, v115
	v_add_f32 v132, v132, v116
	s_waitcnt vmcnt(10)
	v_mfma_f32_32x32x16_bf16 v[40:55], a[192:195], a[16:19], v[40:55]
	buffer_load_dwordx4 a[60:63], v5, s[44:47], s56 offen offset:3072 sc1
	v_add_f32 v133, v133, v117
	v_add_f32 v134, v134, v118
	v_mfma_f32_32x32x16_bf16 v[56:71], a[196:199], a[16:19], v[56:71]
	v_add_f32 v135, v135, v119
	s_waitcnt lgkmcnt(3)
	v_add_f32 v72, v72, v80
	v_add_f32 v73, v73, v81
	s_waitcnt vmcnt(10)
	v_mfma_f32_32x32x16_bf16 v[40:55], a[200:203], a[20:23], v[40:55]
	s_add_u32 s56, s57, 135168
	buffer_load_dwordx4 a[64:67], v5, s[44:47], s56 offen offset:0 sc1
	v_add_f32 v74, v74, v82
	v_add_f32 v75, v75, v83
	v_mfma_f32_32x32x16_bf16 v[56:71], a[204:207], a[20:23], v[56:71]
	s_waitcnt lgkmcnt(2)
	v_add_f32 v76, v76, v84
	v_add_f32 v77, v77, v85
	v_add_f32 v78, v78, v86
	s_waitcnt vmcnt(10)
	v_mfma_f32_32x32x16_bf16 v[40:55], a[208:211], a[24:27], v[40:55]
	buffer_load_dwordx4 a[68:71], v5, s[44:47], s56 offen offset:1024 sc1
	v_add_f32 v79, v79, v87
	s_waitcnt lgkmcnt(1)
	v_add_f32 v128, v128, v88
	v_mfma_f32_32x32x16_bf16 v[56:71], a[212:215], a[24:27], v[56:71]
	v_add_f32 v129, v129, v89
	v_add_f32 v130, v130, v90
	v_add_f32 v131, v131, v91
	s_waitcnt vmcnt(10)
	v_mfma_f32_32x32x16_bf16 v[40:55], a[216:219], a[28:31], v[40:55]
	buffer_load_dwordx4 a[72:75], v5, s[44:47], s56 offen offset:2048 sc1
	s_waitcnt lgkmcnt(0)
	v_add_f32 v132, v132, v92
	v_add_f32 v133, v133, v93
	v_mfma_f32_32x32x16_bf16 v[56:71], a[220:223], a[28:31], v[56:71]
	v_add_f32 v134, v134, v94
	v_add_f32 v135, v135, v95
	v_add_f32 v128, v128, v72
	s_waitcnt vmcnt(10)
	v_mfma_f32_32x32x16_bf16 v[40:55], a[224:227], a[32:35], v[40:55]
	buffer_load_dwordx4 a[76:79], v5, s[44:47], s56 offen offset:3072 sc1
	v_add_f32 v129, v129, v73
	v_add_f32 v130, v130, v74
	v_mfma_f32_32x32x16_bf16 v[56:71], a[228:231], a[32:35], v[56:71]
	v_add_f32 v131, v131, v75
	v_add_f32 v132, v132, v76
	v_add_f32 v133, v133, v77
	s_waitcnt vmcnt(10)
	v_mfma_f32_32x32x16_bf16 v[40:55], a[232:235], a[36:39], v[40:55]
	s_add_u32 s56, s57, 139264
	buffer_load_dwordx4 a[80:83], v5, s[44:47], s56 offen offset:0 sc1
	v_add_f32 v134, v134, v78
	v_add_f32 v135, v135, v79
	v_mfma_f32_32x32x16_bf16 v[56:71], a[236:239], a[36:39], v[56:71]
	v_fma_f32 v128, v128, v96, v24
	v_fma_f32 v129, v129, v97, v25
	v_fma_f32 v130, v130, v98, v26
	s_waitcnt vmcnt(10)
	v_mfma_f32_32x32x16_bf16 v[40:55], a[240:243], a[40:43], v[40:55]
	buffer_load_dwordx4 a[84:87], v5, s[44:47], s56 offen offset:1024 sc1
	v_fma_f32 v131, v131, v99, v27
	v_fma_f32 v132, v132, v100, v28
	v_mfma_f32_32x32x16_bf16 v[56:71], a[244:247], a[40:43], v[56:71]
	v_fma_f32 v133, v133, v101, v29
	v_fma_f32 v134, v134, v102, v30
	v_fma_f32 v135, v135, v103, v31
	s_waitcnt vmcnt(10)
	v_mfma_f32_32x32x16_bf16 v[40:55], a[248:251], a[44:47], v[40:55]
	buffer_load_dwordx4 a[88:91], v5, s[44:47], s56 offen offset:2048 sc1
	v_cvt_pk_bf16_f32 v128, v128, v129
	v_cvt_pk_bf16_f32 v129, v130, v131
	v_mfma_f32_32x32x16_bf16 v[56:71], a[252:255], a[44:47], v[56:71]
	v_cvt_pk_bf16_f32 v130, v132, v133
	v_cvt_pk_bf16_f32 v131, v134, v135
	s_nop 0
	v_permlane32_swap_b32 v128, v130
	s_waitcnt vmcnt(10)
	v_mfma_f32_32x32x16_bf16 v[40:55], v[160:163], a[48:51], v[40:55]
	buffer_load_dwordx4 a[92:95], v5, s[44:47], s56 offen offset:3072 sc1
	v_permlane32_swap_b32 v129, v131
	v_mfma_f32_32x32x16_bf16 v[56:71], v[164:167], a[48:51], v[56:71]
	buffer_store_dwordx4 v[128:131], v9, s[40:43], 0 offen offset:0
	s_waitcnt vmcnt(11)
	v_mfma_f32_32x32x16_bf16 v[40:55], v[168:171], a[52:55], v[40:55]
	v_mfma_f32_32x32x16_bf16 v[56:71], v[172:175], a[52:55], v[56:71]
	s_waitcnt vmcnt(10)
	v_mfma_f32_32x32x16_bf16 v[40:55], v[176:179], a[56:59], v[40:55]
	v_mfma_f32_32x32x16_bf16 v[56:71], v[180:183], a[56:59], v[56:71]
	s_waitcnt vmcnt(9)
	v_mfma_f32_32x32x16_bf16 v[40:55], v[184:187], a[60:63], v[40:55]
	v_mfma_f32_32x32x16_bf16 v[56:71], v[188:191], a[60:63], v[56:71]
	s_waitcnt vmcnt(8)
	v_mfma_f32_32x32x16_bf16 v[40:55], v[192:195], a[64:67], v[40:55]
	v_mfma_f32_32x32x16_bf16 v[56:71], v[196:199], a[64:67], v[56:71]
	s_waitcnt vmcnt(7)
	v_mfma_f32_32x32x16_bf16 v[40:55], v[200:203], a[68:71], v[40:55]
	v_mfma_f32_32x32x16_bf16 v[56:71], v[204:207], a[68:71], v[56:71]
	s_waitcnt vmcnt(6)
	v_mfma_f32_32x32x16_bf16 v[40:55], v[208:211], a[72:75], v[40:55]
	v_mfma_f32_32x32x16_bf16 v[56:71], v[212:215], a[72:75], v[56:71]
	s_waitcnt vmcnt(5)
	v_mfma_f32_32x32x16_bf16 v[40:55], v[216:219], a[76:79], v[40:55]
	v_mfma_f32_32x32x16_bf16 v[56:71], v[220:223], a[76:79], v[56:71]
	s_waitcnt vmcnt(4)
	v_mfma_f32_32x32x16_bf16 v[40:55], v[224:227], a[80:83], v[40:55]
	v_mfma_f32_32x32x16_bf16 v[56:71], v[228:231], a[80:83], v[56:71]
	s_waitcnt vmcnt(3)
	v_mfma_f32_32x32x16_bf16 v[40:55], v[232:235], a[84:87], v[40:55]
	v_mfma_f32_32x32x16_bf16 v[56:71], v[236:239], a[84:87], v[56:71]
	s_waitcnt vmcnt(2)
	v_mfma_f32_32x32x16_bf16 v[40:55], v[240:243], a[88:91], v[40:55]
	v_mfma_f32_32x32x16_bf16 v[56:71], v[244:247], a[88:91], v[56:71]
	s_waitcnt vmcnt(1)
	v_mfma_f32_32x32x16_bf16 v[40:55], v[248:251], a[92:95], v[40:55]
	v_mfma_f32_32x32x16_bf16 v[56:71], v[252:255], a[92:95], v[56:71]
	s_nop 4
	ds_write_b128 v16, v[48:51] offset:0
	ds_write_b128 v16, v[52:55] offset:1024
	s_nop 4
	ds_write_b128 v17, v[56:59] offset:0
	ds_write_b128 v17, v[60:63] offset:1024
	ds_write_b128 v18, v[64:67] offset:0
	ds_write_b128 v18, v[68:71] offset:1024
	s_waitcnt lgkmcnt(0)
	s_barrier
	ds_read_b128 v[72:75], v6 offset:0
	ds_read_b128 v[76:79], v6 offset:1024
	ds_read_b128 v[80:83], v6 offset:2048
	ds_read_b128 v[84:87], v6 offset:3072
	ds_read_b128 v[88:91], v6 offset:4096
	ds_read_b128 v[92:95], v6 offset:5120
	v_pk_add_f32 v[40:41], v[40:41], v[112:113]
	v_pk_add_f32 v[42:43], v[42:43], v[114:115]
	v_pk_add_f32 v[44:45], v[44:45], v[116:117]
	v_pk_add_f32 v[46:47], v[46:47], v[118:119]
	s_waitcnt lgkmcnt(3)
	v_pk_add_f32 v[72:73], v[72:73], v[80:81]
	v_pk_add_f32 v[74:75], v[74:75], v[82:83]
	s_waitcnt lgkmcnt(2)
	v_pk_add_f32 v[76:77], v[76:77], v[84:85]
	v_pk_add_f32 v[78:79], v[78:79], v[86:87]
	s_waitcnt lgkmcnt(1)
	v_pk_add_f32 v[40:41], v[40:41], v[88:89]
	v_pk_add_f32 v[42:43], v[42:43], v[90:91]
	s_waitcnt lgkmcnt(0)
	v_pk_add_f32 v[44:45], v[44:45], v[92:93]
	v_pk_add_f32 v[46:47], v[46:47], v[94:95]
	v_pk_add_f32 v[40:41], v[40:41], v[72:73]
	v_pk_add_f32 v[42:43], v[42:43], v[74:75]
	v_pk_add_f32 v[44:45], v[44:45], v[76:77]
	v_pk_add_f32 v[46:47], v[46:47], v[78:79]
	v_pk_fma_f32 v[40:41], v[40:41], v[96:97], v[32:33]
	v_pk_fma_f32 v[42:43], v[42:43], v[98:99], v[34:35]
	v_pk_fma_f32 v[44:45], v[44:45], v[100:101], v[36:37]
	v_pk_fma_f32 v[46:47], v[46:47], v[102:103], v[38:39]
	v_cvt_pk_bf16_f32 v40, v40, v41
	v_cvt_pk_bf16_f32 v41, v42, v43
	v_cvt_pk_bf16_f32 v42, v44, v45
	v_cvt_pk_bf16_f32 v43, v46, v47
	s_nop 0
	v_permlane32_swap_b32 v40, v42
	v_permlane32_swap_b32 v41, v43
	buffer_store_dwordx4 v[40:43], v9, s[40:43], 0 offen offset:1024
FINS:
	s_endpgm
IDLES:
	s_waitcnt lgkmcnt(4)
	s_add_u32 m0, s0, 48576
	s_mov_b32 s1, 196608
	buffer_load_dwordx4 v10, s[24:27], s1 offen lds
	buffer_load_dwordx4 v23, s[24:27], s1 offen offset:1056 lds
	s_waitcnt vmcnt(9)
	ds_read_b64_tr_b16 a[192:193], v11 offset:50688
	ds_read_b64_tr_b16 a[194:195], v11 offset:51744
	ds_read_b64_tr_b16 a[196:197], v12 offset:50688
	ds_read_b64_tr_b16 a[198:199], v12 offset:51744
	s_waitcnt vmcnt(7)
	ds_read_b64_tr_b16 a[200:201], v11 offset:42240
	ds_read_b64_tr_b16 a[202:203], v11 offset:43296
	ds_read_b64_tr_b16 a[204:205], v12 offset:42240
	ds_read_b64_tr_b16 a[206:207], v12 offset:43296
	s_waitcnt lgkmcnt(4)
	s_add_u32 m0, s0, 50688
	s_mov_b32 s1, 212992
	buffer_load_dwordx4 v10, s[24:27], s1 offen lds
	buffer_load_dwordx4 v23, s[24:27], s1 offen offset:1056 lds
	s_waitcnt vmcnt(7)
	ds_read_b64_tr_b16 a[208:209], v11 offset:44352
	ds_read_b64_tr_b16 a[210:211], v11 offset:45408
	ds_read_b64_tr_b16 a[212:213], v12 offset:44352
	ds_read_b64_tr_b16 a[214:215], v12 offset:45408
	s_waitcnt lgkmcnt(4)
	s_add_u32 m0, s0, 42240
	s_mov_b32 s1, 229376
	buffer_load_dwordx4 v10, s[24:27], s1 offen lds
	buffer_load_dwordx4 v23, s[24:27], s1 offen offset:1056 lds
	s_waitcnt vmcnt(7)
	ds_read_b64_tr_b16 a[216:217], v11 offset:46464
	ds_read_b64_tr_b16 a[218:219], v11 offset:47520
	ds_read_b64_tr_b16 a[220:221], v12 offset:46464
	ds_read_b64_tr_b16 a[222:223], v12 offset:47520
	s_waitcnt lgkmcnt(4)
	s_add_u32 m0, s0, 44352
	s_mov_b32 s1, 245760
	buffer_load_dwordx4 v10, s[24:27], s1 offen lds
	buffer_load_dwordx4 v23, s[24:27], s1 offen offset:1056 lds
	s_waitcnt vmcnt(6)
	ds_read_b64_tr_b16 a[224:225], v11 offset:48576
	ds_read_b64_tr_b16 a[226:227], v11 offset:49632
	ds_read_b64_tr_b16 a[228:229], v12 offset:48576
	ds_read_b64_tr_b16 a[230:231], v12 offset:49632
	s_waitcnt lgkmcnt(4)
	s_add_u32 m0, s0, 46464
	s_mov_b32 s1, 262144
	buffer_load_dwordx4 v10, s[24:27], s1 offen lds
	buffer_load_dwordx4 v23, s[24:27], s1 offen offset:1056 lds
	s_waitcnt vmcnt(6)
	ds_read_b64_tr_b16 a[232:233], v11 offset:50688
	ds_read_b64_tr_b16 a[234:235], v11 offset:51744
	ds_read_b64_tr_b16 a[236:237], v12 offset:50688
	ds_read_b64_tr_b16 a[238:239], v12 offset:51744
	s_waitcnt lgkmcnt(4)
	s_add_u32 m0, s0, 48576
	s_mov_b32 s1, 278528
	buffer_load_dwordx4 v10, s[24:27], s1 offen lds
	buffer_load_dwordx4 v23, s[24:27], s1 offen offset:1056 lds
	s_waitcnt vmcnt(6)
	ds_read_b64_tr_b16 a[240:241], v11 offset:42240
	ds_read_b64_tr_b16 a[242:243], v11 offset:43296
	ds_read_b64_tr_b16 a[244:245], v12 offset:42240
	ds_read_b64_tr_b16 a[246:247], v12 offset:43296
	s_waitcnt lgkmcnt(4)
	s_add_u32 m0, s0, 50688
	s_mov_b32 s1, 294912
	buffer_load_dwordx4 v10, s[24:27], s1 offen lds
	buffer_load_dwordx4 v23, s[24:27], s1 offen offset:1056 lds
	s_waitcnt vmcnt(6)
	ds_read_b64_tr_b16 a[248:249], v11 offset:44352
	ds_read_b64_tr_b16 a[250:251], v11 offset:45408
	ds_read_b64_tr_b16 a[252:253], v12 offset:44352
	ds_read_b64_tr_b16 a[254:255], v12 offset:45408
	s_waitcnt lgkmcnt(4)
	s_add_u32 m0, s0, 42240
	s_mov_b32 s1, 311296
	buffer_load_dwordx4 v10, s[24:27], s1 offen lds
	buffer_load_dwordx4 v23, s[24:27], s1 offen offset:1056 lds
	s_waitcnt vmcnt(6)
	ds_read_b64_tr_b16 v[160:161], v11 offset:46464
	ds_read_b64_tr_b16 v[162:163], v11 offset:47520
	ds_read_b64_tr_b16 v[164:165], v12 offset:46464
	ds_read_b64_tr_b16 v[166:167], v12 offset:47520
	s_waitcnt lgkmcnt(4)
	s_add_u32 m0, s0, 44352
	s_mov_b32 s1, 327680
	buffer_load_dwordx4 v10, s[24:27], s1 offen lds
	buffer_load_dwordx4 v23, s[24:27], s1 offen offset:1056 lds
	s_waitcnt vmcnt(6)
	ds_read_b64_tr_b16 v[168:169], v11 offset:48576
	ds_read_b64_tr_b16 v[170:171], v11 offset:49632
	ds_read_b64_tr_b16 v[172:173], v12 offset:48576
	ds_read_b64_tr_b16 v[174:175], v12 offset:49632
	s_waitcnt lgkmcnt(4)
	s_add_u32 m0, s0, 46464
	s_mov_b32 s1, 344064
	buffer_load_dwordx4 v10, s[24:27], s1 offen lds
	buffer_load_dwordx4 v23, s[24:27], s1 offen offset:1056 lds
	s_waitcnt vmcnt(6)
	ds_read_b64_tr_b16 v[176:177], v11 offset:50688
	ds_read_b64_tr_b16 v[178:179], v11 offset:51744
	ds_read_b64_tr_b16 v[180:181], v12 offset:50688
	ds_read_b64_tr_b16 v[182:183], v12 offset:51744
	s_waitcnt lgkmcnt(4)
	s_add_u32 m0, s0, 48576
	s_mov_b32 s1, 360448
	buffer_load_dwordx4 v10, s[24:27], s1 offen lds
	buffer_load_dwordx4 v23, s[24:27], s1 offen offset:1056 lds
	s_waitcnt vmcnt(6)
	ds_read_b64_tr_b16 v[184:185], v11 offset:42240
	ds_read_b64_tr_b16 v[186:187], v11 offset:43296
	ds_read_b64_tr_b16 v[188:189], v12 offset:42240
	ds_read_b64_tr_b16 v[190:191], v12 offset:43296
	s_waitcnt lgkmcnt(4)
	s_add_u32 m0, s0, 50688
	s_mov_b32 s1, 376832
	buffer_load_dwordx4 v10, s[24:27], s1 offen lds
	buffer_load_dwordx4 v23, s[24:27], s1 offen offset:1056 lds
	s_waitcnt vmcnt(6)
	ds_read_b64_tr_b16 v[192:193], v11 offset:44352
	ds_read_b64_tr_b16 v[194:195], v11 offset:45408
	ds_read_b64_tr_b16 v[196:197], v12 offset:44352
	ds_read_b64_tr_b16 v[198:199], v12 offset:45408
	s_waitcnt lgkmcnt(4)
	s_add_u32 m0, s0, 42240
	s_mov_b32 s1, 393216
	buffer_load_dwordx4 v10, s[24:27], s1 offen lds
	buffer_load_dwordx4 v23, s[24:27], s1 offen offset:1056 lds
	s_waitcnt vmcnt(6)
	ds_read_b64_tr_b16 v[200:201], v11 offset:46464
	ds_read_b64_tr_b16 v[202:203], v11 offset:47520
	ds_read_b64_tr_b16 v[204:205], v12 offset:46464
	ds_read_b64_tr_b16 v[206:207], v12 offset:47520
	s_waitcnt lgkmcnt(4)
	s_add_u32 m0, s0, 44352
	s_mov_b32 s1, 409600
	buffer_load_dwordx4 v10, s[24:27], s1 offen lds
	buffer_load_dwordx4 v23, s[24:27], s1 offen offset:1056 lds
	s_waitcnt vmcnt(6)
	ds_read_b64_tr_b16 v[208:209], v11 offset:48576
	ds_read_b64_tr_b16 v[210:211], v11 offset:49632
	ds_read_b64_tr_b16 v[212:213], v12 offset:48576
	ds_read_b64_tr_b16 v[214:215], v12 offset:49632
	s_waitcnt lgkmcnt(4)
	s_add_u32 m0, s0, 46464
	s_mov_b32 s1, 425984
	buffer_load_dwordx4 v10, s[24:27], s1 offen lds
	buffer_load_dwordx4 v23, s[24:27], s1 offen offset:1056 lds
	s_waitcnt vmcnt(6)
	ds_read_b64_tr_b16 v[216:217], v11 offset:50688
	ds_read_b64_tr_b16 v[218:219], v11 offset:51744
	ds_read_b64_tr_b16 v[220:221], v12 offset:50688
	ds_read_b64_tr_b16 v[222:223], v12 offset:51744
	s_waitcnt lgkmcnt(4)
	s_add_u32 m0, s0, 48576
	s_mov_b32 s1, 442368
	buffer_load_dwordx4 v10, s[24:27], s1 offen lds
	buffer_load_dwordx4 v23, s[24:27], s1 offen offset:1056 lds
	s_waitcnt vmcnt(6)
	ds_read_b64_tr_b16 v[224:225], v11 offset:42240
	ds_read_b64_tr_b16 v[226:227], v11 offset:43296
	ds_read_b64_tr_b16 v[228:229], v12 offset:42240
	ds_read_b64_tr_b16 v[230:231], v12 offset:43296
	s_waitcnt vmcnt(4)
	ds_read_b64_tr_b16 v[232:233], v11 offset:44352
	ds_read_b64_tr_b16 v[234:235], v11 offset:45408
	ds_read_b64_tr_b16 v[236:237], v12 offset:44352
	ds_read_b64_tr_b16 v[238:239], v12 offset:45408
	s_waitcnt vmcnt(2)
	ds_read_b64_tr_b16 v[240:241], v11 offset:46464
	ds_read_b64_tr_b16 v[242:243], v11 offset:47520
	ds_read_b64_tr_b16 v[244:245], v12 offset:46464
	ds_read_b64_tr_b16 v[246:247], v12 offset:47520
	s_waitcnt vmcnt(0)
	ds_read_b64_tr_b16 v[248:249], v11 offset:48576
	ds_read_b64_tr_b16 v[250:251], v11 offset:49632
	ds_read_b64_tr_b16 v[252:253], v12 offset:48576
	ds_read_b64_tr_b16 v[254:255], v12 offset:49632
	v_bfrev_b32 v19, 1
	v_bfrev_b32 v20, 1
	s_lshl_b32 s54, s49, 3
	s_add_u32 s54, s54, s48
	s_cmp_eq_u32 s54, 248
	s_cbranch_scc0 noE_42
	s_lshl_b32 s56, s52, 9
	s_add_u32 s56, s56, 4096
	v_lshl_add_u32 v13, v0, 3, s56
	s_mov_b32 s58, 200000
poll_43:
	buffer_load_dwordx2 v[40:41], v13, s[44:47], 0 offen sc1
	s_waitcnt vmcnt(0)
	v_cmp_ne_u32 vcc, s53, v41
	s_cbranch_vccz pdone_44
	s_sub_u32 s58, s58, 1
	s_cbranch_scc0 poll_43
pdone_44:
	s_barrier
	v_mov_b32 v13, 0
	buffer_store_dword v8, v13, s[44:47], 0 offen sc1
noE_42:
	s_mul_i32 s57, s50, 229376
	s_mul_i32 s55, s52, 28672
	s_add_u32 s57, s57, s55
	s_add_u32 s57, s57, 8388608
	s_mov_b32 s58, 200000
poll_45:
	buffer_load_dword v4, v7, s[44:47], 0 offen sc1
	s_waitcnt vmcnt(0)
	v_cmp_ne_u32 vcc, s53, v4
	s_cbranch_vccz pdone_46
	s_sub_u32 s58, s58, 1
	s_cbranch_scc0 poll_45
pdone_46:
	s_waitcnt vmcnt(0) lgkmcnt(0)
	s_branch P4S
END:
	s_endpgm
.section .rodata,"a"
.p2align 6
.amdhsa_kernel adaLN_cond__sliding_local_dilated__mixer_channel_mlp__prompt_kernel
  .amdhsa_next_free_vgpr 512
  .amdhsa_next_free_sgpr 102
  .amdhsa_accum_offset 256
  .amdhsa_group_segment_fixed_size 0
  .amdhsa_kernarg_size 104
  .amdhsa_user_sgpr_count 2
  .amdhsa_user_sgpr_kernarg_segment_ptr 1
  .amdhsa_system_sgpr_workgroup_id_x 1
.end_amdhsa_kernel
```
